```python
import torch

def _softmax(x, axis=-1):
    return torch.softmax(x, dim=axis)
def _gelu(x):
    return torch.nn.functional.gelu(x, approximate="tanh")
def _silu(x):
    return torch.nn.functional.silu(x)
def _sigmoid(x):
    return torch.sigmoid(x)
def _layernorm(x, axis=-1, eps=1e-5):
    m = x.mean(dim=axis, keepdim=True)
    v = x.var(dim=axis, keepdim=True, unbiased=False)
    return (x - m) / torch.sqrt(v + eps)
def _scatter_add(tgt, idx, src, axis=0):
    return tgt.clone().index_add_(axis, idx, src)
def _segment_sum(src, seg, n):
    out = torch.zeros((n,) + src.shape[1:], dtype=src.dtype)
    return out.index_add_(0, seg, src)
def _pad(x, pw):
    flat = tuple(v for pair in reversed(pw) for v in pair)
    return torch.nn.functional.pad(x, flat)

kernel_name = 'interleave_layers__linear_attn_block__sliding_block__prompt'

def setup_inputs():

    _w = (lambda a: (lambda t: t.to(torch.bfloat16) if t.is_floating_point() else t)(torch.as_tensor(a)))
    def _A_setup():
        B, S, D = 1, 2048, 512
        return {
            "x": _w((lambda *s: torch.randn(*s, dtype=torch.bfloat16) * 0.05)(B, S, D)),
            "wqkv": _w((lambda *s: torch.randn(*s, dtype=torch.bfloat16) * 0.05)(D, 3 * D)),
            "wo": _w((lambda *s: torch.randn(*s, dtype=torch.bfloat16) * 0.05)(D, D)),
        }
    _A_in = _A_setup()

    def _B_setup():
        B, S, D = 1, 2048, 512
        return {
            "x": _w((lambda *s: torch.randn(*s, dtype=torch.bfloat16) * 0.05)(B, S, D)),
            "wqkv": _w((lambda *s: torch.randn(*s, dtype=torch.bfloat16) * 0.1)(D, 3 * D)),
            "wo": _w((lambda *s: torch.randn(*s, dtype=torch.bfloat16) * 0.05)(D, D)),
        }
    _B_in = _B_setup()

    return {
        "A_x": _A_in["x"],
        "A_wqkv": _A_in["wqkv"],
        "A_wo": _A_in["wo"],
        "B_x": _B_in["x"],
        "B_wqkv": _B_in["wqkv"],
        "B_wo": _B_in["wo"],
    }

def reference(A_x, A_wqkv, A_wo, B_x, B_wqkv, B_wo):
    def _A_ref(x, wqkv, wo):
        B, S, D = x.shape
        H = 32; Dh = D // H
        qkv = (lambda x, *d: x.permute(*d))((x @ wqkv).reshape(B, S, 3, H, Dh), 2, 0, 3, 1, 4)
        q, k, v = qkv[0], qkv[1], qkv[2]
        phi = lambda t: torch.where(t > 0, t + 1, torch.exp(t)) + 1e-6
        pq, pk = phi(q), phi(k)
        kv = torch.einsum("bhsd,bhse->bhde", pk, v)
        z = torch.einsum("bhsd->bhd", pk)
        num = torch.einsum("bhqd,bhde->bhqe", pq, kv)
        den = torch.einsum("bhqd,bhd->bhq", pq, z)[..., None] + 1e-6
        o = num / den
        return (lambda x, *d: x.permute(*d))(o, 0, 2, 1, 3).reshape(B, S, D) @ wo

    def _B_ref(x, wqkv, wo):
        B, S, D = x.shape
        H = 32; Dh = D // H; W = 256
        qkv = (lambda x, *d: x.permute(*d))((x @ wqkv).reshape(B, S, 3, H, Dh), 2, 0, 3, 1, 4)
        q, k, v = qkv[0], qkv[1], qkv[2]
        scores = torch.einsum("bhqd,bhkd->bhqk", q, k) * (Dh ** -0.5)
        idx = torch.arange(S)
        mask = (idx[:, None] - idx[None, :] >= 0) & (idx[:, None] - idx[None, :] < W)
        scores = torch.where(mask[None, None], scores, -1e9)
        p = _softmax(scores, axis=-1)
        o = torch.einsum("bhqk,bhkd->bhqd", p, v)
        return (lambda x, *d: x.permute(*d))(o, 0, 2, 1, 3).reshape(B, S, D) @ wo

    x = A_x
    x = x + _A_ref(_layernorm(x, axis=-1), A_wqkv, A_wo)
    x = x + _B_ref(_layernorm(x, axis=-1), B_wqkv, B_wo)
    x = x + _A_ref(_layernorm(x, axis=-1), A_wqkv, A_wo)
    x = x + _B_ref(_layernorm(x, axis=-1), B_wqkv, B_wo)
    return x
```

```asm
; @launch grid=(256,1,1) block=(256,1,1) lds=163840
.amdgcn_target "amdgcn-amd-amdhsa--gfx950"
.text
.globl interleave_layers__linear_attn_block__sliding_block__prompt_kernel
.p2align 12
.p2align 8
.type interleave_layers__linear_attn_block__sliding_block__prompt_kernel,@function
interleave_layers__linear_attn_block__sliding_block__prompt_kernel:
    s_cmp_ge_u32 s2, 256
    s_cbranch_scc1 L_end
    s_load_dwordx2 s[8:9], s[0:1], 0
    s_load_dwordx2 s[12:13], s[0:1], 8
    s_load_dwordx2 s[32:33], s[0:1], 64
    s_load_dwordx2 s[16:17], s[0:1], 16
    s_load_dwordx2 s[20:21], s[0:1], 32
    s_load_dwordx2 s[24:25], s[0:1], 40
    s_load_dwordx2 s[28:29], s[0:1], 48
    s_lshr_b32 s4, s2, 3
    s_getpc_b64 s[40:41]
L_pc0:
    v_lshrrev_b32 v2, 6, v0
    v_lshl_add_u32 v1, s4, 2, v2
    v_and_b32 v3, 3, v0
    v_lshl_add_u32 v1, v1, 2, v3
    v_lshlrev_b32 v1, 7, v1
    v_add_u32 v1, L_main-L_pc0, v1
    v_min_u32 v248, L_textend-L_pc0-4, v1
    global_load_dword v127, v248, s[40:41]
    v_readfirstlane_b32 s38, v2
    v_and_b32 v0, 63, v0
    v_lshlrev_b32 v26, 7, v0
    v_subrev_u32 v27, 16, v0
    v_lshlrev_b32 v28, 10, v27
    v_mov_b32 v29, 67108864
    v_cmp_gt_u32 vcc, 16, v0
    s_lshl_b32 s84, s4, 2
    s_add_u32 s84, s84, s38
    s_lshl_b32 s85, s2, 2
    s_add_u32 s85, s85, s38
    v_cndmask_b32 v32, v29, v26, vcc
    s_and_b32 s3, s2, 7
    s_lshl_b32 s88, s3, 18
    s_lshl_b32 s86, s84, 11
    s_add_u32 s88, s88, s86
    v_cmp_gt_u32 vcc, 12, v0
    s_mul_i32 s86, s85, 1536
    v_add_u32 v30, s86, v26
    v_cndmask_b32 v255, v29, v30, vcc
    v_cmp_gt_u32 vcc, 12, v27
    s_mul_i32 s87, s84, 12288
    s_add_u32 s87, s87, 384
    v_add_u32 v31, s87, v28
    v_cndmask_b32 v255, v255, v31, vcc
    s_mov_b32 s10, 0x200000
    s_mov_b32 s11, 0x20000
    s_mov_b32 s14, 0x180000
    s_mov_b32 s15, 0x20000
    s_waitcnt lgkmcnt(0)
    buffer_load_dword v127, v32, s[8:11], s88 offen
    s_load_dword s42, s[32:33], 0
    s_branch L_main
.p2align 12
L_main:
    s_lshr_b32 s5, s4, 3
    s_lshl_b32 s3, s3, 2
    s_add_u32 s36, s3, s5
    s_and_b32 s37, s4, 7
    v_lshlrev_b32 v1, 4, v0
    v_lshrrev_b32 v22, 2, v0
    v_and_b32 v23, 3, v0
    v_lshrrev_b32 v24, 4, v0
    v_and_b32 v24, 2, v24
    v_xor_b32 v23, v23, v24
    v_lshlrev_b32 v22, 10, v22
    v_lshl_add_u32 v118, v23, 4, v22
    s_lshl_b32 s44, s38, 14
    s_lshl_b32 s3, s36, 16
    s_add_u32 s3, s3, s44
    s_add_u32 s5, s44, 65792
    s_add_u32 m0, s5, 0
    s_nop 0
    buffer_load_dwordx4 v118, s[8:11], s3 offen offset:0  lds
    s_add_u32 m0, s5, 960
    s_nop 0
    buffer_load_dwordx4 v118, s[8:11], s3 offen offset:64  lds
    s_add_u32 m0, s5, 1920
    s_nop 0
    buffer_load_dwordx4 v118, s[8:11], s3 offen offset:128  lds
    s_add_u32 m0, s5, 2880
    s_nop 0
    buffer_load_dwordx4 v118, s[8:11], s3 offen offset:192  lds
    buffer_load_dword v127, v255, s[12:15], 0 offen
    s_mov_b32 s34, 0x2300000
    s_mov_b32 s35, 0x20000
    s_mov_b32 s18, 0x80000
    s_mov_b32 s19, 0x20000
    s_mov_b32 s22, 0x180000
    s_mov_b32 s23, 0x20000
    s_mov_b32 s26, 0x80000
    s_mov_b32 s27, 0x20000
    s_mov_b32 s30, 0x200000
    s_mov_b32 s31, 0x20000
    s_mov_b32 s43, 0
    s_mov_b64 exec, 0
    s_cmp_eq_u32 s38, 0
    s_cbranch_scc1 L_pad0
    s_cmp_eq_u32 s38, 1
    s_cbranch_scc1 L_pad1
    s_cmp_eq_u32 s38, 2
    s_cbranch_scc1 L_pad2
    s_branch L_pad3
L_warm0:
    s_mov_b64 exec, -1
    s_mov_b64 exec, 0
    s_cmp_eq_u32 s38, 0
    s_cbranch_scc1 L_pad4
    s_cmp_eq_u32 s38, 1
    s_cbranch_scc1 L_pad5
    s_cmp_eq_u32 s38, 2
    s_cbranch_scc1 L_pad6
    s_branch L_pad7
L_warm1:
    s_mov_b64 exec, -1
    s_mov_b64 exec, 0
    s_cmp_eq_u32 s38, 0
    s_cbranch_scc1 L_pad8
    s_cmp_eq_u32 s38, 1
    s_cbranch_scc1 L_pad9
    s_cmp_eq_u32 s38, 2
    s_cbranch_scc1 L_pad10
    s_branch L_pad11
L_warm2:
    s_mov_b64 exec, -1
    s_add_u32 m0, s5, 3840
    v_cmp_gt_u32 vcc, 4, v0
    buffer_load_dwordx4 v118, s[8:11], s3 offen offset:256  lds
    s_mul_i32 s86, s85, 512
    v_add_u32 v30, s86, v26
    v_cndmask_b32 v254, v29, v30, vcc
    v_cmp_gt_u32 vcc, 4, v27
    s_mul_i32 s87, s84, 4096
    s_add_u32 s87, s87, 384
    v_add_u32 v31, s87, v28
    v_cndmask_b32 v254, v254, v31, vcc
    v_lshrrev_b32 v24, 3, v0
    v_and_b32 v25, 7, v0
    s_add_u32 m0, s5, 4800
    v_and_b32 v26, 2, v24
    buffer_load_dwordx4 v118, s[8:11], s3 offen offset:320  lds
    v_xor_b32 v25, v25, v26
    v_mul_u32_u24 v24, 3072, v24
    v_lshl_add_u32 v124, v25, 4, v24
    v_xor_b32 v125, 64, v124
    v_add_u32 v125, 24576, v125
    v_lshrrev_b32 v24, 4, v0
    v_bfe_u32 v25, v0, 2, 2
    v_lshl_add_u32 v24, v24, 3, v25
    v_and_b32 v25, 3, v0
    v_lshlrev_b32 v25, 3, v25
    s_add_u32 m0, s5, 5760
    v_lshl_add_u32 v24, v24, 7, v25
    buffer_load_dwordx4 v118, s[8:11], s3 offen offset:384  lds
    v_bfe_u32 v25, v0, 3, 2
    v_xor_b32 v25, s38, v25
    v_lshl_add_u32 v126, v25, 5, v24
    s_lshl_b32 s46, s38, 12
    s_lshl_b32 s6, s37, 7
    s_mul_i32 s45, s38, 98304
    s_add_u32 s45, s45, s6
    s_add_u32 s50, s3, s6
    s_lshl_b32 s47, s38, 1
    s_xor_b32 s47, s47, s37
    s_add_u32 m0, s5, 6720
    s_lshl_b32 s47, s47, 16
    buffer_load_dwordx4 v118, s[8:11], s3 offen offset:448  lds
    s_add_u32 s47, s47, s6
    v_add_u32 v123, 131328, v126
    v_and_b32 v20, 15, v0
    v_lshrrev_b32 v21, 4, v0
    v_lshlrev_b32 v3, 4, v21
    v_lshlrev_b32 v4, 2, v20
    s_mul_i32 s6, s38, 192
    s_add_u32 s6, s6, 148608
    v_add_u32 v5, s6, v3
    v_add_u32 v6, s6, v4
    s_barrier
    s_add_u32 m0, s5, 7680
    v_add_u32 v3, 148096, v3
    buffer_load_dwordx4 v118, s[8:11], s3 offen offset:512  lds
    v_add_u32 v4, 148096, v4
    v_lshrrev_b32 v23, 2, v20
    v_and_b32 v23, 2, v23
    v_xor_b32 v24, v21, v23
    v_lshlrev_b32 v24, 4, v24
    v_lshl_add_u32 v24, v20, 6, v24
    v_add_u32 v2, 65792, v24
    v_add_u32 v122, s44, v2
    v_and_b32 v25, 1, v21
    v_lshrrev_b32 v26, 1, v21
    s_add_u32 m0, s5, 8640
    v_lshl_add_u32 v27, v25, 1, v26
    buffer_load_dwordx4 v118, s[8:11], s3 offen offset:576  lds
    v_lshlrev_b32 v28, 4, v20
    v_lshl_add_u32 v11, v27, 8, v28
    v_xor_b32 v27, v27, v23
    v_lshlrev_b32 v27, 4, v27
    v_lshl_add_u32 v27, v20, 6, v27
    s_lshl_b32 s6, s37, 11
    s_add_u32 s7, s6, s5
    v_add_u32 v121, s7, v27
    s_lshl_b32 s41, s36, 16
    s_add_u32 s48, s41, s44
    s_add_u32 m0, s5, 9600
    s_add_u32 s49, s48, s6
    buffer_load_dwordx4 v118, s[8:11], s3 offen offset:640  lds
    s_lshl_b32 s51, s36, 8
    s_add_u32 s51, s51, 4096
    s_lshl_b32 s6, s37, 2
    s_add_u32 s52, s6, s51
    s_add_u32 s6, s6, s38
    s_lshl_b32 s7, s6, 9
    v_lshl_add_u32 v27, v25, 14, v28
    v_lshl_add_u32 v27, v26, 8, v27
    v_add_u32 v7, s7, v27
    s_lshl_b32 s54, s6, 15
    s_add_u32 m0, s5, 10560
    s_add_u32 s54, s54, 1048576
    buffer_load_dwordx4 v118, s[8:11], s3 offen offset:704  lds
    s_lshl_b32 s56, s6, 12
    s_add_u32 s55, s56, 65536
    s_lshl1_add_u32 s56, s41, s56
    s_add_u32 s56, s56, 6291456
    s_lshl_b32 s57, s6, 7
    s_add_u32 s57, s57, 589824
    s_cmp_eq_u32 s38, 0
    s_cselect_b32 s52, s52, 67108864
    s_mul_i32 s58, s38, 8256
    s_add_u32 s58, s58, 65536
    s_mul_i32 s59, s38, 4128
    s_add_u32 m0, s5, 11520
    s_add_u32 s59, s59, 131584
    buffer_load_dwordx4 v118, s[8:11], s3 offen offset:768  lds
    s_sub_u32 s6, s56, 131072
    s_cmp_gt_u32 s36, 0
    s_cselect_b32 s60, s6, 67108864
    s_sub_u32 s6, s56, 262144
    s_cmp_gt_u32 s36, 1
    s_cselect_b32 s61, s6, 67108864
    s_sub_u32 s6, s56, 393216
    s_cmp_gt_u32 s36, 2
    s_cselect_b32 s62, s6, 67108864
    s_sub_u32 s6, s56, 524288
    s_cmp_gt_u32 s36, 3
    s_cselect_b32 s63, s6, 67108864
    s_lshl_b32 s6, s37, 8
    s_lshl_b32 s7, s38, 11
    s_add_u32 m0, s5, 12480
    s_add_u32 s6, s6, s7
    buffer_load_dwordx4 v118, s[8:11], s3 offen offset:832  lds
    s_lshl_b32 s7, s36, 13
    s_add_u32 s6, s6, s7
    s_add_u32 s1, s6, 327680
    v_and_b32 v8, 7, v0
    v_lshlrev_b32 v27, 4, v8
    v_lshlrev_b32 v8, 2, v8
    v_lshrrev_b32 v30, 3, v0
    v_lshl_add_u32 v9, v30, 12, v27
    v_bfe_u32 v27, v0, 2, 2
    v_lshl_add_u32 v30, v26, 2, v25
    s_add_u32 m0, s5, 13440
    v_lshl_add_u32 v30, v27, 3, v30
    buffer_load_dwordx4 v118, s[8:11], s3 offen offset:896  lds
    v_lshlrev_b32 v30, 7, v30
    v_lshl_add_u32 v30, v27, 5, v30
    v_and_b32 v116, 3, v0
    v_lshl_add_u32 v10, v116, 3, v30
    v_cmp_eq_u32 vcc, v27, v21
    s_lshl_b32 s6, s38, 6
    v_add_u32 v253, s6, v4
    v_mov_b32 v31, 162816
    v_cndmask_b32 v253, v31, v253, vcc
    v_cmp_eq_u32 s[98:99], 1, v116
    s_add_u32 m0, s5, 14400
    v_cmp_eq_u32 s[100:101], 2, v116
    buffer_load_dwordx4 v118, s[8:11], s3 offen offset:960  lds
    v_and_b32 v60, 1, v0
    v_lshrrev_b32 v61, 1, v0
    v_sub_u32 v61, 3, v61
    v_lshl_add_u32 v61, v60, 4, v61
    v_cmp_gt_u32 vcc, 8, v0
    v_mov_b32 v62, s58
    v_mov_b32 v63, s59
    v_cndmask_b32 v60, v60, v61, vcc
    v_cndmask_b32 v62, v63, v62, vcc
    v_mul_u32_u24 v60, 2064, v60
    s_barrier
    s_add_u32 m0, s46, 0
    s_add_u32 s0, s45, 1024
    v_lshl_add_u32 v61, s36, 1, v0
    buffer_load_dwordx4 v124, s[12:15], s0 offen lds
    v_cmp_le_u32 vcc, 8, v61
    v_add_u32 v60, v60, v62
    v_mov_b32 v62, 0x3f803f80
    v_cndmask_b32 v17, 0, v62, vcc
    v_cmp_gt_u32 vcc, 10, v0
    v_add_u32 v60, 2048, v60
    v_mov_b32 v63, 161792
    v_cndmask_b32 v16, v63, v60, vcc
    v_lshrrev_b32 v60, 5, v0
    v_and_b32 v61, 15, v0
    s_add_u32 m0, s46, 1024
    v_lshlrev_b32 v61, 4, v61
    buffer_load_dwordx4 v125, s[12:15], s0 offen lds
    v_lshl_add_u32 v60, v60, 8, v61
    v_and_b32 v62, 10, v0
    v_min_u32 v62, 1, v62
    v_and_b32 v63, 16, v0
    v_cmp_eq_u32 vcc, 0, v63
    v_add_u32 v60, 1024, v60
    v_add_u32 v61, 512, v60
    v_mul_u32_u24 v62, 98304, v62
    v_add_u32 v62, 2048, v62
    v_cndmask_b32 v60, v62, v60, vcc
    s_add_u32 m0, s46, 2048
    s_add_u32 s0, s45, 50176
    v_cndmask_b32 v61, v62, v61, vcc
    buffer_load_dwordx4 v124, s[12:15], s0 offen lds
    v_add_u32 v13, s58, v1
    v_add_u32 v14, s59, v60
    v_add_u32 v15, s59, v61
    v_and_b32 v60, 3, v0
    v_sub_u32 v60, s36, v60
    v_subrev_u32 v60, 1, v60
    v_cmp_gt_i32 vcc, 0, v60
    v_mov_b32 v61, s36
    v_mov_b32 v18, 0xf149f2ca
    v_cndmask_b32 v60, v60, v61, vcc
    s_add_u32 m0, s46, 3072
    v_lshlrev_b32 v19, 12, v60
    buffer_load_dwordx4 v125, s[12:15], s0 offen lds
    v_accvgpr_write_b32 a192, v13
    v_accvgpr_write_b32 a193, v14
    v_accvgpr_write_b32 a194, v15
    v_accvgpr_write_b32 a195, v16
    v_accvgpr_write_b32 a196, v17
    v_accvgpr_write_b32 a197, v18
    v_accvgpr_write_b32 a198, v19
    v_accvgpr_write_b32 a199, v124
    v_accvgpr_write_b32 a200, v125
    v_accvgpr_write_b32 a201, v126
    s_add_u32 m0, s46, 16384
    s_add_u32 s0, s45, 2048
    v_accvgpr_write_b32 a202, v123
    buffer_load_dwordx4 v124, s[12:15], s0 offen lds
    v_mov_b32 v14, 0x358637bd
    v_mov_b32 v15, 0x3fb8aa3b
    v_mov_b32 v13, 0xb5c1a2a0
    v_and_b32 v16, 3, v0
    v_subrev_u32 v16, 1, v16
    v_ashrrev_i32 v16, 31, v16
    v_and_b32 v19, 0x3f803f80, v16
    v_and_b32 v18, 0x3f803f80, v16
    v_and_b32 v17, 0x3f803f80, v16
    v_and_b32 v16, 0x3f803f80, v16
    s_add_u32 m0, s46, 17408
    v_and_b32 v28, 31, v0
    buffer_load_dwordx4 v125, s[12:15], s0 offen lds
    v_lshlrev_b32 v30, 2, v26
    v_sub_u32 v28, v28, v30
    v_cmp_le_i32 s[64:65], 0, v28
    v_cmp_le_i32 s[66:67], 1, v28
    v_cmp_le_i32 s[68:69], 2, v28
    v_cmp_le_i32 s[70:71], 3, v28
    v_cmp_le_i32 s[72:73], 8, v28
    v_cmp_le_i32 s[74:75], 9, v28
    v_cmp_le_i32 s[76:77], 10, v28
    v_cmp_le_i32 s[78:79], 11, v28
    s_add_u32 m0, s46, 18432
    s_add_u32 s0, s45, 51200
    v_cmp_le_i32 s[80:81], 16, v28
    buffer_load_dwordx4 v124, s[12:15], s0 offen lds
    v_cmp_le_i32 s[82:83], 17, v28
    v_cmp_le_i32 s[84:85], 18, v28
    v_cmp_le_i32 s[86:87], 19, v28
    v_cmp_le_i32 s[88:89], 24, v28
    v_cmp_le_i32 s[90:91], 25, v28
    v_cmp_le_i32 s[92:93], 26, v28
    v_cmp_le_i32 s[94:95], 27, v28
    v_min_u32 v120, 1, v0
    v_lshlrev_b32 v120, 26, v120
    v_mov_b32 v251, v29
    s_add_u32 m0, s46, 19456
    v_writelane_b32 v251, s1, 0
    buffer_load_dwordx4 v125, s[12:15], s0 offen lds
    s_add_u32 s7, s1, 128
    v_writelane_b32 v251, s7, 1
    v_writelane_b32 v251, s51, 2
    s_waitcnt vmcnt(8)
    ds_read_b128 v[176:179], v122 offset:0
    ds_read_b128 v[180:183], v122 offset:1024
    ds_read_b128 v[184:187], v122 offset:2048
    ds_read_b128 v[188:191], v122 offset:3072
    ds_read_b128 v[192:195], v122 offset:4096
    ds_read_b128 v[196:199], v122 offset:5120
    ds_read_b128 v[200:203], v122 offset:6144
    ds_read_b128 v[204:207], v122 offset:7168
    s_add_u32 m0, s46, 32768
    s_add_u32 s7, s45, 394240
    s_waitcnt lgkmcnt(7)
    v_mfma_f32_16x16x32_bf16 v[84:87], v[176:179], v[176:179], 0
    buffer_load_dwordx4 v124, s[12:15], s7 offen lds
    v_mfma_f32_16x16x32_bf16 v[88:91], v[16:19], v[176:179], 0
    ds_read_b128 v[208:211], v122 offset:8192
    s_waitcnt lgkmcnt(7)
    v_mfma_f32_16x16x32_bf16 v[84:87], v[180:183], v[180:183], v[84:87]
    v_mfma_f32_16x16x32_bf16 v[88:91], v[16:19], v[180:183], v[88:91]
    s_add_u32 m0, s46, 33792
    ds_read_b128 v[212:215], v122 offset:9216
    s_waitcnt lgkmcnt(7)
    v_mfma_f32_16x16x32_bf16 v[84:87], v[184:187], v[184:187], v[84:87]
    buffer_load_dwordx4 v125, s[12:15], s7 offen lds
    v_mfma_f32_16x16x32_bf16 v[88:91], v[16:19], v[184:187], v[88:91]
    ds_read_b128 v[216:219], v122 offset:10240
    s_waitcnt lgkmcnt(7)
    v_mfma_f32_16x16x32_bf16 v[84:87], v[188:191], v[188:191], v[84:87]
    v_mfma_f32_16x16x32_bf16 v[88:91], v[16:19], v[188:191], v[88:91]
    s_add_u32 m0, s46, 34816
    s_add_u32 s7, s45, 443392
    ds_read_b128 v[220:223], v122 offset:11264
    s_waitcnt lgkmcnt(7)
    v_mfma_f32_16x16x32_bf16 v[84:87], v[192:195], v[192:195], v[84:87]
    buffer_load_dwordx4 v124, s[12:15], s7 offen lds
    v_mfma_f32_16x16x32_bf16 v[88:91], v[16:19], v[192:195], v[88:91]
    ds_read_b128 v[224:227], v122 offset:12288
    s_waitcnt lgkmcnt(7)
    v_mfma_f32_16x16x32_bf16 v[84:87], v[196:199], v[196:199], v[84:87]
    v_mfma_f32_16x16x32_bf16 v[88:91], v[16:19], v[196:199], v[88:91]
    s_add_u32 m0, s46, 35840
    ds_read_b128 v[228:231], v122 offset:13312
    s_waitcnt lgkmcnt(7)
    v_mfma_f32_16x16x32_bf16 v[84:87], v[200:203], v[200:203], v[84:87]
    buffer_load_dwordx4 v125, s[12:15], s7 offen lds
    v_mfma_f32_16x16x32_bf16 v[88:91], v[16:19], v[200:203], v[88:91]
    ds_read_b128 v[232:235], v122 offset:14336
    s_waitcnt lgkmcnt(7)
    v_mfma_f32_16x16x32_bf16 v[84:87], v[204:207], v[204:207], v[84:87]
    v_mfma_f32_16x16x32_bf16 v[88:91], v[16:19], v[204:207], v[88:91]
    s_add_u32 m0, s46, 49152
    s_add_u32 s7, s45, 395264
    ds_read_b128 v[236:239], v122 offset:15360
    s_waitcnt lgkmcnt(7)
    v_mfma_f32_16x16x32_bf16 v[84:87], v[208:211], v[208:211], v[84:87]
    buffer_load_dwordx4 v124, s[12:15], s7 offen lds
    v_mfma_f32_16x16x32_bf16 v[88:91], v[16:19], v[208:211], v[88:91]
    ds_read_b128 v[240:243], v121 offset:0
    s_waitcnt lgkmcnt(7)
    v_mfma_f32_16x16x32_bf16 v[84:87], v[212:215], v[212:215], v[84:87]
    v_mfma_f32_16x16x32_bf16 v[88:91], v[16:19], v[212:215], v[88:91]
    s_add_u32 m0, s46, 50176
    ds_read_b128 v[244:247], v121 offset:1024
    s_waitcnt lgkmcnt(7)
    v_mfma_f32_16x16x32_bf16 v[84:87], v[216:219], v[216:219], v[84:87]
    buffer_load_dwordx4 v125, s[12:15], s7 offen lds
    v_mfma_f32_16x16x32_bf16 v[88:91], v[16:19], v[216:219], v[88:91]
    s_waitcnt lgkmcnt(6)
    v_mfma_f32_16x16x32_bf16 v[84:87], v[220:223], v[220:223], v[84:87]
    v_mfma_f32_16x16x32_bf16 v[88:91], v[16:19], v[220:223], v[88:91]
    s_add_u32 m0, s46, 51200
    s_add_u32 s7, s45, 444416
    s_waitcnt lgkmcnt(5)
    v_mfma_f32_16x16x32_bf16 v[84:87], v[224:227], v[224:227], v[84:87]
    buffer_load_dwordx4 v124, s[12:15], s7 offen lds
    v_mfma_f32_16x16x32_bf16 v[88:91], v[16:19], v[224:227], v[88:91]
    s_waitcnt lgkmcnt(4)
    v_mfma_f32_16x16x32_bf16 v[84:87], v[228:231], v[228:231], v[84:87]
    v_mfma_f32_16x16x32_bf16 v[88:91], v[16:19], v[228:231], v[88:91]
    s_add_u32 m0, s46, 52224
    s_waitcnt lgkmcnt(3)
    v_mfma_f32_16x16x32_bf16 v[84:87], v[232:235], v[232:235], v[84:87]
    buffer_load_dwordx4 v125, s[12:15], s7 offen lds
    v_mfma_f32_16x16x32_bf16 v[88:91], v[16:19], v[232:235], v[88:91]
    s_waitcnt lgkmcnt(2)
    v_mfma_f32_16x16x32_bf16 v[84:87], v[236:239], v[236:239], v[84:87]
    v_mfma_f32_16x16x32_bf16 v[88:91], v[16:19], v[236:239], v[88:91]
    s_add_u32 m0, s46, 131328
    s_add_u32 s7, s45, 787456
    buffer_load_dwordx4 v124, s[12:15], s7 offen lds
    s_add_u32 m0, s46, 132352
    s_nop 0
    buffer_load_dwordx4 v125, s[12:15], s7 offen lds
    s_add_u32 m0, s46, 133376
    s_add_u32 s7, s45, 836608
    v_cmp_eq_u32 vcc, 3, v116
    buffer_load_dwordx4 v124, s[12:15], s7 offen lds
    v_cndmask_b32 v84, v84, v85, s[98:99]
    v_cndmask_b32 v84, v84, v86, s[100:101]
    v_cndmask_b32 v84, v84, v87, vcc
    v_mul_f32 v88, 0xbb000000, v88
    v_mul_f32 v84, 0x3b000000, v84
    s_add_u32 m0, s46, 134400
    v_fma_f32 v84, -v88, v88, v84
    buffer_load_dwordx4 v125, s[12:15], s7 offen lds
    v_max_f32 v84, 0, v84
    v_add_f32 v84, 0x3727c5ac, v84
    v_rsq_f32 v116, v84
    s_nop 0
    v_mul_f32 v88, v88, v116
    ds_write2st64_b32 v253, v116, v88 offset0:0 offset1:1
    s_waitcnt vmcnt(12)
    s_barrier
    ds_read_b64_tr_b16 a[0:1], v126 offset:0
    ds_read_b64_tr_b16 a[2:3], v126 offset:512
    ds_read_b64_tr_b16 a[4:5], v126 offset:4096
    ds_read_b64_tr_b16 a[6:7], v126 offset:4608
    ds_read_b64_tr_b16 a[8:9], v126 offset:8192
    ds_read_b64_tr_b16 a[10:11], v126 offset:8704
    ds_read_b64_tr_b16 a[12:13], v126 offset:12288
    ds_read_b64_tr_b16 a[14:15], v126 offset:12800
    ds_read_b64_tr_b16 a[64:65], v126 offset:16384
    ds_read_b64_tr_b16 a[66:67], v126 offset:16896
    ds_read_b64_tr_b16 a[68:69], v126 offset:20480
    ds_read_b64_tr_b16 a[70:71], v126 offset:20992
    s_waitcnt lgkmcnt(10)
    v_mfma_f32_16x16x32_bf16 v[92:95], v[16:19], a[0:3], 0
    ds_read_b64_tr_b16 a[72:73], v126 offset:24576
    ds_read_b64_tr_b16 a[74:75], v126 offset:25088
    s_waitcnt lgkmcnt(10)
    v_mfma_f32_16x16x32_bf16 v[92:95], v[16:19], a[4:7], v[92:95]
    ds_read_b64_tr_b16 a[76:77], v126 offset:28672
    ds_read_b64_tr_b16 a[78:79], v126 offset:29184
    s_waitcnt lgkmcnt(10)
    v_mfma_f32_16x16x32_bf16 v[92:95], v[16:19], a[8:11], v[92:95]
    ds_read_b128 v[52:55], v2 offset:0
    ds_read_b128 v[56:59], v2 offset:16384
    s_waitcnt lgkmcnt(10)
    v_mfma_f32_16x16x32_bf16 v[92:95], v[16:19], a[12:15], v[92:95]
    ds_read_b128 v[60:63], v2 offset:32768
    ds_read_b128 v[64:67], v2 offset:49152
    s_waitcnt lgkmcnt(10)
    v_mfma_f32_16x16x32_bf16 v[96:99], v[16:19], a[64:67], 0
    ds_read_b128 v[68:71], v2 offset:1024
    ds_read_b128 v[72:75], v2 offset:17408
    s_waitcnt lgkmcnt(10)
    v_mfma_f32_16x16x32_bf16 v[96:99], v[16:19], a[68:71], v[96:99]
    ds_read_b128 v[76:79], v2 offset:33792
    s_waitcnt lgkmcnt(9)
    v_mfma_f32_16x16x32_bf16 v[96:99], v[16:19], a[72:75], v[96:99]
    s_waitcnt lgkmcnt(7)
    v_mfma_f32_16x16x32_bf16 v[96:99], v[16:19], a[76:79], v[96:99]
    s_add_u32 m0, s46, 0
    s_add_u32 s7, s45, 788480
    s_barrier
    s_waitcnt lgkmcnt(3)
    v_mfma_f32_16x16x32_bf16 v[20:23], v[52:55], a[0:3], 0
    buffer_load_dwordx4 v124, s[12:15], s7 offen lds
    v_mfma_f32_16x16x32_bf16 v[24:27], v[52:55], a[64:67], 0
    ds_read_b128 v[80:83], v2 offset:50176
    v_mfma_f32_16x16x32_bf16 v[28:31], v[56:59], a[0:3], 0
    v_mfma_f32_16x16x32_bf16 v[32:35], v[56:59], a[64:67], 0
    s_add_u32 m0, s46, 1024
    ds_read_b128 v[52:55], v2 offset:2048
    v_mfma_f32_16x16x32_bf16 v[36:39], v[60:63], a[0:3], 0
    buffer_load_dwordx4 v125, s[12:15], s7 offen lds
    v_mfma_f32_16x16x32_bf16 v[40:43], v[60:63], a[64:67], 0
    ds_read_b128 v[56:59], v2 offset:18432
    v_mfma_f32_16x16x32_bf16 v[44:47], v[64:67], a[0:3], 0
    v_mfma_f32_16x16x32_bf16 v[48:51], v[64:67], a[64:67], 0
    s_add_u32 m0, s46, 2048
    s_add_u32 s7, s45, 837632
    ds_read_b128 v[60:63], v2 offset:34816
    s_waitcnt lgkmcnt(3)
    v_mfma_f32_16x16x32_bf16 v[20:23], v[68:71], a[4:7], v[20:23]
    buffer_load_dwordx4 v124, s[12:15], s7 offen lds
    v_mfma_f32_16x16x32_bf16 v[24:27], v[68:71], a[68:71], v[24:27]
    ds_read_b128 v[64:67], v2 offset:51200
    v_mfma_f32_16x16x32_bf16 v[28:31], v[72:75], a[4:7], v[28:31]
    v_mfma_f32_16x16x32_bf16 v[32:35], v[72:75], a[68:71], v[32:35]
    s_add_u32 m0, s46, 3072
    ds_read_b128 v[68:71], v2 offset:3072
    v_mfma_f32_16x16x32_bf16 v[36:39], v[76:79], a[4:7], v[36:39]
    buffer_load_dwordx4 v125, s[12:15], s7 offen lds
    v_mfma_f32_16x16x32_bf16 v[40:43], v[76:79], a[68:71], v[40:43]
    ds_read_b128 v[72:75], v2 offset:19456
    v_mfma_f32_16x16x32_bf16 v[44:47], v[80:83], a[4:7], v[44:47]
    v_mfma_f32_16x16x32_bf16 v[48:51], v[80:83], a[68:71], v[48:51]
    s_add_u32 m0, s46, 16384
    s_add_u32 s7, s45, 1180672
    ds_read_b128 v[76:79], v2 offset:35840
    s_waitcnt lgkmcnt(3)
    v_mfma_f32_16x16x32_bf16 v[20:23], v[52:55], a[8:11], v[20:23]
    buffer_load_dwordx4 v124, s[12:15], s7 offen lds
    v_mfma_f32_16x16x32_bf16 v[24:27], v[52:55], a[72:75], v[24:27]
    ds_read_b128 v[80:83], v2 offset:52224
    v_mfma_f32_16x16x32_bf16 v[28:31], v[56:59], a[8:11], v[28:31]
    v_mfma_f32_16x16x32_bf16 v[32:35], v[56:59], a[72:75], v[32:35]
    s_add_u32 m0, s46, 17408
    s_waitcnt vmcnt(9)
    s_barrier
    ds_read_b128 v[52:55], v2 offset:4096
    v_mfma_f32_16x16x32_bf16 v[36:39], v[60:63], a[8:11], v[36:39]
    buffer_load_dwordx4 v125, s[12:15], s7 offen lds
    ds_read_b64_tr_b16 a[16:17], v126 offset:32768
    v_mfma_f32_16x16x32_bf16 v[40:43], v[60:63], a[72:75], v[40:43]
    ds_read_b128 v[56:59], v2 offset:20480
    ds_read_b64_tr_b16 a[18:19], v126 offset:33280
    ds_read_b64_tr_b16 a[20:21], v126 offset:36864
    v_mfma_f32_16x16x32_bf16 v[44:47], v[64:67], a[8:11], v[44:47]
    ds_read_b64_tr_b16 a[22:23], v126 offset:37376
    ds_read_b64_tr_b16 a[24:25], v126 offset:40960
    ds_read_b64_tr_b16 a[26:27], v126 offset:41472
    v_mfma_f32_16x16x32_bf16 v[48:51], v[64:67], a[72:75], v[48:51]
    s_add_u32 m0, s46, 18432
    s_add_u32 s7, s45, 1229824
    ds_read_b128 v[60:63], v2 offset:36864
    s_waitcnt lgkmcnt(9)
    v_mfma_f32_16x16x32_bf16 v[20:23], v[68:71], a[12:15], v[20:23]
    buffer_load_dwordx4 v124, s[12:15], s7 offen lds
    v_mfma_f32_16x16x32_bf16 v[24:27], v[68:71], a[76:79], v[24:27]
    ds_read_b128 v[64:67], v2 offset:53248
    ds_read_b64_tr_b16 a[28:29], v126 offset:45056
    v_mfma_f32_16x16x32_bf16 v[28:31], v[72:75], a[12:15], v[28:31]
    ds_read_b64_tr_b16 a[30:31], v126 offset:45568
    ds_read_b64_tr_b16 a[80:81], v126 offset:49152
    v_mfma_f32_16x16x32_bf16 v[32:35], v[72:75], a[76:79], v[32:35]
    s_add_u32 m0, s46, 19456
    ds_read_b128 v[68:71], v2 offset:5120
    v_mfma_f32_16x16x32_bf16 v[36:39], v[76:79], a[12:15], v[36:39]
    buffer_load_dwordx4 v125, s[12:15], s7 offen lds
    v_mfma_f32_16x16x32_bf16 v[40:43], v[76:79], a[76:79], v[40:43]
    ds_read_b128 v[72:75], v2 offset:21504
    ds_read_b64_tr_b16 a[82:83], v126 offset:49664
    v_mfma_f32_16x16x32_bf16 v[44:47], v[80:83], a[12:15], v[44:47]
    ds_read_b64_tr_b16 a[84:85], v126 offset:53248
    ds_read_b64_tr_b16 a[86:87], v126 offset:53760
    v_mfma_f32_16x16x32_bf16 v[48:51], v[80:83], a[76:79], v[48:51]
    ds_read_b128 v[76:79], v2 offset:37888
    s_waitcnt lgkmcnt(14)
    v_mfma_f32_16x16x32_bf16 v[92:95], v[16:19], a[16:19], v[92:95]
    ds_read_b64_tr_b16 a[88:89], v126 offset:57344
    ds_read_b64_tr_b16 a[90:91], v126 offset:57856
    s_waitcnt lgkmcnt(14)
    v_mfma_f32_16x16x32_bf16 v[92:95], v[16:19], a[20:23], v[92:95]
    ds_read_b64_tr_b16 a[92:93], v126 offset:61440
    ds_read_b64_tr_b16 a[94:95], v126 offset:61952
    s_waitcnt lgkmcnt(14)
    v_mfma_f32_16x16x32_bf16 v[92:95], v[16:19], a[24:27], v[92:95]
    s_waitcnt lgkmcnt(11)
    v_mfma_f32_16x16x32_bf16 v[92:95], v[16:19], a[28:31], v[92:95]
    s_waitcnt lgkmcnt(7)
    v_mfma_f32_16x16x32_bf16 v[96:99], v[16:19], a[80:83], v[96:99]
    s_waitcnt lgkmcnt(5)
    v_mfma_f32_16x16x32_bf16 v[96:99], v[16:19], a[84:87], v[96:99]
    s_waitcnt lgkmcnt(2)
    v_mfma_f32_16x16x32_bf16 v[96:99], v[16:19], a[88:91], v[96:99]
    s_waitcnt lgkmcnt(0)
    v_mfma_f32_16x16x32_bf16 v[96:99], v[16:19], a[92:95], v[96:99]
    s_add_u32 m0, s46, 32768
    s_add_u32 s7, s45, 1181696
    s_barrier
    v_mfma_f32_16x16x32_bf16 v[20:23], v[52:55], a[16:19], v[20:23]
    buffer_load_dwordx4 v124, s[12:15], s7 offen lds
    v_mfma_f32_16x16x32_bf16 v[24:27], v[52:55], a[80:83], v[24:27]
    ds_read_b128 v[80:83], v2 offset:54272
    v_mfma_f32_16x16x32_bf16 v[28:31], v[56:59], a[16:19], v[28:31]
    v_mfma_f32_16x16x32_bf16 v[32:35], v[56:59], a[80:83], v[32:35]
    s_add_u32 m0, s46, 33792
    ds_read_b128 v[52:55], v2 offset:6144
    v_mfma_f32_16x16x32_bf16 v[36:39], v[60:63], a[16:19], v[36:39]
    buffer_load_dwordx4 v125, s[12:15], s7 offen lds
    v_mfma_f32_16x16x32_bf16 v[40:43], v[60:63], a[80:83], v[40:43]
    ds_read_b128 v[56:59], v2 offset:22528
    v_mfma_f32_16x16x32_bf16 v[44:47], v[64:67], a[16:19], v[44:47]
    v_mfma_f32_16x16x32_bf16 v[48:51], v[64:67], a[80:83], v[48:51]
    s_add_u32 m0, s46, 34816
    s_add_u32 s7, s45, 1230848
    ds_read_b128 v[60:63], v2 offset:38912
    s_waitcnt lgkmcnt(3)
    v_mfma_f32_16x16x32_bf16 v[20:23], v[68:71], a[20:23], v[20:23]
    buffer_load_dwordx4 v124, s[12:15], s7 offen lds
    v_mfma_f32_16x16x32_bf16 v[24:27], v[68:71], a[84:87], v[24:27]
    ds_read_b128 v[64:67], v2 offset:55296
    v_mfma_f32_16x16x32_bf16 v[28:31], v[72:75], a[20:23], v[28:31]
    v_mfma_f32_16x16x32_bf16 v[32:35], v[72:75], a[84:87], v[32:35]
    s_add_u32 m0, s46, 35840
    ds_read_b128 v[68:71], v2 offset:7168
    v_mfma_f32_16x16x32_bf16 v[36:39], v[76:79], a[20:23], v[36:39]
    buffer_load_dwordx4 v125, s[12:15], s7 offen lds
L_pad0:
    s_cbranch_execz L_warm0
    v_mfma_f32_16x16x32_bf16 v[40:43], v[76:79], a[84:87], v[40:43]
    ds_read_b128 v[72:75], v2 offset:23552
    v_mfma_f32_16x16x32_bf16 v[44:47], v[80:83], a[20:23], v[44:47]
    v_mfma_f32_16x16x32_bf16 v[48:51], v[80:83], a[84:87], v[48:51]
    s_add_u32 m0, s46, 49152
    s_add_u32 s7, s45, 0
    ds_read_b128 v[76:79], v2 offset:39936
    s_waitcnt lgkmcnt(3)
    v_mfma_f32_16x16x32_bf16 v[20:23], v[52:55], a[24:27], v[20:23]
    buffer_load_dwordx4 v124, s[12:15], s7 offen lds
    v_mfma_f32_16x16x32_bf16 v[24:27], v[52:55], a[88:91], v[24:27]
    ds_read_b128 v[80:83], v2 offset:56320
    v_mfma_f32_16x16x32_bf16 v[28:31], v[56:59], a[24:27], v[28:31]
    v_mfma_f32_16x16x32_bf16 v[32:35], v[56:59], a[88:91], v[32:35]
    s_add_u32 m0, s46, 50176
    ds_read_b128 v[52:55], v2 offset:8192
    v_mfma_f32_16x16x32_bf16 v[36:39], v[60:63], a[24:27], v[36:39]
    buffer_load_dwordx4 v125, s[12:15], s7 offen lds
    v_mfma_f32_16x16x32_bf16 v[40:43], v[60:63], a[88:91], v[40:43]
    ds_read_b128 v[56:59], v2 offset:24576
    v_mfma_f32_16x16x32_bf16 v[44:47], v[64:67], a[24:27], v[44:47]
    v_mfma_f32_16x16x32_bf16 v[48:51], v[64:67], a[88:91], v[48:51]
    s_add_u32 m0, s46, 51200
    s_add_u32 s7, s45, 49152
    s_waitcnt vmcnt(6)
    s_barrier
    ds_read_b128 v[60:63], v2 offset:40960
    s_waitcnt lgkmcnt(3)
    v_mfma_f32_16x16x32_bf16 v[20:23], v[68:71], a[28:31], v[20:23]
    buffer_load_dwordx4 v124, s[12:15], s7 offen lds
    ds_read_b64_tr_b16 a[32:33], v123 offset:0
    ds_read_b64_tr_b16 a[34:35], v123 offset:512
    ds_read_b64_tr_b16 a[36:37], v123 offset:4096
    v_mfma_f32_16x16x32_bf16 v[24:27], v[68:71], a[92:95], v[24:27]
    ds_read_b128 v[64:67], v2 offset:57344
    ds_read_b64_tr_b16 a[38:39], v123 offset:4608
    ds_read_b64_tr_b16 a[40:41], v123 offset:8192
    ds_read_b64_tr_b16 a[42:43], v123 offset:8704
    v_mfma_f32_16x16x32_bf16 v[28:31], v[72:75], a[28:31], v[28:31]
    ds_read_b64_tr_b16 a[44:45], v123 offset:12288
    ds_read_b64_tr_b16 a[46:47], v123 offset:12800
    ds_read_b64_tr_b16 a[96:97], v126 offset:0
    ds_read_b64_tr_b16 a[98:99], v126 offset:512
    v_mfma_f32_16x16x32_bf16 v[32:35], v[72:75], a[92:95], v[32:35]
    s_add_u32 m0, s46, 52224
    ds_read_b128 v[68:71], v2 offset:9216
    ds_read_b64_tr_b16 a[100:101], v126 offset:4096
    ds_read_b64_tr_b16 a[102:103], v126 offset:4608
    v_mfma_f32_16x16x32_bf16 v[36:39], v[76:79], a[28:31], v[36:39]
    buffer_load_dwordx4 v125, s[12:15], s7 offen lds
    ds_read_b64_tr_b16 a[104:105], v126 offset:8192
    ds_read_b64_tr_b16 a[106:107], v126 offset:8704
    v_mfma_f32_16x16x32_bf16 v[40:43], v[76:79], a[92:95], v[40:43]
    ds_read_b128 v[72:75], v2 offset:25600
    ds_read_b64_tr_b16 a[108:109], v126 offset:12288
    ds_read_b64_tr_b16 a[110:111], v126 offset:12800
    ds_read_b64_tr_b16 a[48:49], v126 offset:16384
    v_mfma_f32_16x16x32_bf16 v[44:47], v[80:83], a[28:31], v[44:47]
    ds_read_b64_tr_b16 a[50:51], v126 offset:16896
    ds_read_b64_tr_b16 a[52:53], v126 offset:20480
    ds_read_b64_tr_b16 a[54:55], v126 offset:20992
    ds_read_b64_tr_b16 a[56:57], v126 offset:24576
    v_mfma_f32_16x16x32_bf16 v[48:51], v[80:83], a[92:95], v[48:51]
    ds_read_b128 v[76:79], v2 offset:41984
    ds_read_b64_tr_b16 a[58:59], v126 offset:25088
    ds_read_b64_tr_b16 a[60:61], v126 offset:28672
    ds_read_b64_tr_b16 a[62:63], v126 offset:29184
    s_waitcnt lgkmcnt(0)
    s_barrier
    s_add_u32 m0, s46, 131328
    s_add_u32 s7, s45, 393216
    v_mfma_f32_16x16x32_bf16 v[92:95], v[16:19], a[32:35], v[92:95]
    buffer_load_dwordx4 v124, s[12:15], s7 offen lds
    ds_read_b128 v[128:131], v3 offset:0
    v_mfma_f32_16x16x32_bf16 v[92:95], v[16:19], a[36:39], v[92:95]
    ds_read_b128 v[132:135], v3 offset:256
    ds_read_b128 v[136:139], v3 offset:64
    ds_read_b128 v[140:143], v3 offset:320
    v_mfma_f32_16x16x32_bf16 v[92:95], v[16:19], a[40:43], v[92:95]
    s_add_u32 m0, s46, 132352
    ds_read_b128 v[144:147], v3 offset:128
    ds_read_b128 v[148:151], v3 offset:384
    v_mfma_f32_16x16x32_bf16 v[92:95], v[16:19], a[44:47], v[92:95]
    buffer_load_dwordx4 v125, s[12:15], s7 offen lds
    ds_read_b128 v[152:155], v3 offset:192
    v_mfma_f32_16x16x32_bf16 v[96:99], v[16:19], a[96:99], v[96:99]
    ds_read_b128 v[156:159], v3 offset:448
    s_add_u32 s42, s42, 1
    s_mul_i32 s39, s42, 0x9E3779B1
    v_mfma_f32_16x16x32_bf16 v[96:99], v[16:19], a[100:103], v[96:99]
    s_add_u32 m0, s46, 133376
    s_add_u32 s7, s45, 442368
    v_mfma_f32_16x16x32_bf16 v[96:99], v[16:19], a[104:107], v[96:99]
    buffer_load_dwordx4 v124, s[12:15], s7 offen lds
    v_mfma_f32_16x16x32_bf16 v[96:99], v[16:19], a[108:111], v[96:99]
    s_getreg_b32 s6, hwreg(HW_REG_XCC_ID, 0, 4)
    v_mfma_f32_16x16x32_bf16 v[20:23], v[52:55], a[32:35], v[20:23]
    s_add_u32 m0, s46, 134400
    s_add_u32 s6, s6, s39
    v_mfma_f32_16x16x32_bf16 v[24:27], v[52:55], a[96:99], v[24:27]
    buffer_load_dwordx4 v125, s[12:15], s7 offen lds
    ds_read_b128 v[80:83], v2 offset:58368
    v_mfma_f32_16x16x32_bf16 v[28:31], v[56:59], a[32:35], v[28:31]
    v_mov_b32 v117, s6
    v_mfma_f32_16x16x32_bf16 v[32:35], v[56:59], a[96:99], v[32:35]
    s_add_u32 m0, s46, 0
    s_add_u32 s7, s45, 786432
    ds_read_b128 v[52:55], v2 offset:10240
    v_mfma_f32_16x16x32_bf16 v[36:39], v[60:63], a[32:35], v[36:39]
    buffer_load_dwordx4 v124, s[12:15], s7 offen lds
    v_mfma_f32_16x16x32_bf16 v[40:43], v[60:63], a[96:99], v[40:43]
    ds_read_b128 v[56:59], v2 offset:26624
    v_mfma_f32_16x16x32_bf16 v[44:47], v[64:67], a[32:35], v[44:47]
    s_add_u32 m0, s46, 1024
    v_mfma_f32_16x16x32_bf16 v[48:51], v[64:67], a[96:99], v[48:51]
    buffer_load_dwordx4 v125, s[12:15], s7 offen lds
    ds_read_b128 v[60:63], v2 offset:43008
    s_waitcnt lgkmcnt(3)
    v_mfma_f32_16x16x32_bf16 v[20:23], v[68:71], a[36:39], v[20:23]
    v_mfma_f32_16x16x32_bf16 v[24:27], v[68:71], a[100:103], v[24:27]
    s_add_u32 m0, s46, 2048
    s_add_u32 s7, s45, 835584
    ds_read_b128 v[64:67], v2 offset:59392
    v_mfma_f32_16x16x32_bf16 v[28:31], v[72:75], a[36:39], v[28:31]
    buffer_load_dwordx4 v124, s[12:15], s7 offen lds
    v_mfma_f32_16x16x32_bf16 v[32:35], v[72:75], a[100:103], v[32:35]
    ds_read_b128 v[68:71], v2 offset:11264
    v_mfma_f32_16x16x32_bf16 v[36:39], v[76:79], a[36:39], v[36:39]
    s_add_u32 m0, s46, 3072
    v_mfma_f32_16x16x32_bf16 v[40:43], v[76:79], a[100:103], v[40:43]
    buffer_load_dwordx4 v125, s[12:15], s7 offen lds
    s_waitcnt vmcnt(12)
    s_barrier
    ds_read_b128 v[72:75], v2 offset:27648
    v_mfma_f32_16x16x32_bf16 v[44:47], v[80:83], a[36:39], v[44:47]
    ds_read_b64_tr_b16 a[112:113], v126 offset:32768
    ds_read_b64_tr_b16 a[114:115], v126 offset:33280
    v_mfma_f32_16x16x32_bf16 v[48:51], v[80:83], a[100:103], v[48:51]
    s_add_u32 m0, s46, 16384
    s_add_u32 s7, s45, 1179648
    ds_read_b128 v[76:79], v2 offset:44032
    s_waitcnt lgkmcnt(5)
    v_mfma_f32_16x16x32_bf16 v[20:23], v[52:55], a[40:43], v[20:23]
    buffer_load_dwordx4 v124, s[12:15], s7 offen lds
    v_mfma_f32_16x16x32_bf16 v[24:27], v[52:55], a[104:107], v[24:27]
    ds_read_b128 v[80:83], v2 offset:60416
    ds_read_b64_tr_b16 a[116:117], v126 offset:36864
    v_mfma_f32_16x16x32_bf16 v[28:31], v[56:59], a[40:43], v[28:31]
    s_add_u32 m0, s46, 17408
    ds_read_b64_tr_b16 a[118:119], v126 offset:37376
    v_mfma_f32_16x16x32_bf16 v[32:35], v[56:59], a[104:107], v[32:35]
    buffer_load_dwordx4 v125, s[12:15], s7 offen lds
    ds_read_b128 v[52:55], v2 offset:12288
    v_mfma_f32_16x16x32_bf16 v[36:39], v[60:63], a[40:43], v[36:39]
    ds_read_b64_tr_b16 a[120:121], v126 offset:40960
    ds_read_b64_tr_b16 a[122:123], v126 offset:41472
    v_mfma_f32_16x16x32_bf16 v[40:43], v[60:63], a[104:107], v[40:43]
    s_add_u32 m0, s46, 18432
    s_add_u32 s7, s45, 1228800
    ds_read_b128 v[56:59], v2 offset:28672
    v_mfma_f32_16x16x32_bf16 v[44:47], v[64:67], a[40:43], v[44:47]
    buffer_load_dwordx4 v124, s[12:15], s7 offen lds
    v_mfma_f32_16x16x32_bf16 v[48:51], v[64:67], a[104:107], v[48:51]
    ds_read_b128 v[60:63], v2 offset:45056
    s_waitcnt lgkmcnt(7)
    v_mfma_f32_16x16x32_bf16 v[20:23], v[68:71], a[44:47], v[20:23]
    s_add_u32 m0, s46, 19456
    ds_read_b64_tr_b16 a[124:125], v126 offset:45056
    v_mfma_f32_16x16x32_bf16 v[24:27], v[68:71], a[108:111], v[24:27]
    buffer_load_dwordx4 v125, s[12:15], s7 offen lds
    ds_read_b128 v[64:67], v2 offset:61440
    v_mfma_f32_16x16x32_bf16 v[28:31], v[72:75], a[44:47], v[28:31]
    ds_read_b64_tr_b16 a[126:127], v126 offset:45568
    v_mfma_f32_16x16x32_bf16 v[32:35], v[72:75], a[108:111], v[32:35]
    ds_read_b128 v[68:71], v2 offset:13312
    v_mfma_f32_16x16x32_bf16 v[36:39], v[76:79], a[44:47], v[36:39]
    buffer_load_dword v127, v255, s[20:23], 0 offen
    v_mfma_f32_16x16x32_bf16 v[40:43], v[76:79], a[108:111], v[40:43]
    ds_read_b128 v[72:75], v2 offset:29696
    v_mfma_f32_16x16x32_bf16 v[44:47], v[80:83], a[44:47], v[44:47]
    v_mfma_f32_16x16x32_bf16 v[48:51], v[80:83], a[108:111], v[48:51]
    ds_read_b128 v[76:79], v2 offset:46080
    v_mfma_f32_16x16x32_bf16 v[92:95], v[16:19], a[48:51], v[92:95]
    buffer_load_dword v127, v254, s[16:19], 0 offen
    v_mfma_f32_16x16x32_bf16 v[92:95], v[16:19], a[52:55], v[92:95]
    v_mfma_f32_16x16x32_bf16 v[92:95], v[16:19], a[56:59], v[92:95]
    buffer_load_dword v127, v254, s[24:27], 0 offen
    v_mfma_f32_16x16x32_bf16 v[92:95], v[16:19], a[60:63], v[92:95]
    v_mfma_f32_16x16x32_bf16 v[96:99], v[16:19], a[112:115], v[96:99]
    buffer_load_dword v127, v251, s[32:35], 0 offen sc1
    s_waitcnt lgkmcnt(11)
    v_mfma_f32_16x16x32_bf16 v[96:99], v[16:19], a[116:119], v[96:99]
    s_waitcnt lgkmcnt(8)
    v_mfma_f32_16x16x32_bf16 v[96:99], v[16:19], a[120:123], v[96:99]
    buffer_store_dword v117, v120, s[32:35], s52 offen offset:128 sc1
    s_waitcnt lgkmcnt(3)
    v_mfma_f32_16x16x32_bf16 v[96:99], v[16:19], a[124:127], v[96:99]
    v_mfma_f32_16x16x32_bf16 v[20:23], v[52:55], a[48:51], v[20:23]
    v_mfma_f32_16x16x32_bf16 v[24:27], v[52:55], a[112:115], v[24:27]
    ds_read_b128 v[80:83], v2 offset:62464
    v_mfma_f32_16x16x32_bf16 v[28:31], v[56:59], a[48:51], v[28:31]
    v_mfma_f32_16x16x32_bf16 v[32:35], v[56:59], a[112:115], v[32:35]
    ds_read_b128 v[52:55], v2 offset:14336
    v_mfma_f32_16x16x32_bf16 v[36:39], v[60:63], a[48:51], v[36:39]
    ds_write_b32 v6, v92 offset:64
    ds_write_b32 v6, v96 offset:128
    v_mfma_f32_16x16x32_bf16 v[40:43], v[60:63], a[112:115], v[40:43]
    ds_read_b128 v[56:59], v2 offset:30720
    v_fma_f32 v160, v132, v92, v14
    v_mfma_f32_16x16x32_bf16 v[44:47], v[64:67], a[48:51], v[44:47]
    v_fma_f32 v161, v133, v92, v14
    v_fma_f32 v162, v134, v92, v14
    v_mfma_f32_16x16x32_bf16 v[48:51], v[64:67], a[112:115], v[48:51]
    ds_read_b128 v[60:63], v2 offset:47104
    s_waitcnt lgkmcnt(5)
    v_mfma_f32_16x16x32_bf16 v[20:23], v[68:71], a[52:55], v[20:23]
    v_fma_f32 v163, v135, v92, v14
    v_mul_f32 v132, v132, v96
    v_mfma_f32_16x16x32_bf16 v[24:27], v[68:71], a[116:119], v[24:27]
    ds_read_b128 v[64:67], v2 offset:63488
    v_mul_f32 v133, v133, v96
    v_mfma_f32_16x16x32_bf16 v[28:31], v[72:75], a[52:55], v[28:31]
    v_mul_f32 v134, v134, v96
    v_mul_f32 v135, v135, v96
    v_mfma_f32_16x16x32_bf16 v[32:35], v[72:75], a[116:119], v[32:35]
    ds_read_b128 v[68:71], v2 offset:15360
    v_fma_f32 v164, v140, v92, v14
    v_mfma_f32_16x16x32_bf16 v[36:39], v[76:79], a[52:55], v[36:39]
    v_fma_f32 v165, v141, v92, v14
    v_fma_f32 v166, v142, v92, v14
    v_mfma_f32_16x16x32_bf16 v[40:43], v[76:79], a[116:119], v[40:43]
    ds_read_b128 v[72:75], v2 offset:31744
    v_fma_f32 v167, v143, v92, v14
    v_mfma_f32_16x16x32_bf16 v[44:47], v[80:83], a[52:55], v[44:47]
    v_mul_f32 v140, v140, v96
    v_mul_f32 v141, v141, v96
    v_mfma_f32_16x16x32_bf16 v[48:51], v[80:83], a[116:119], v[48:51]
    ds_read_b128 v[76:79], v2 offset:48128
    s_waitcnt lgkmcnt(3)
    v_mfma_f32_16x16x32_bf16 v[20:23], v[52:55], a[56:59], v[20:23]
    v_mul_f32 v142, v142, v96
    v_mul_f32 v143, v143, v96
    v_mfma_f32_16x16x32_bf16 v[24:27], v[52:55], a[120:123], v[24:27]
    ds_read_b128 v[80:83], v2 offset:64512
    v_fma_f32 v168, v148, v92, v14
    v_mfma_f32_16x16x32_bf16 v[28:31], v[56:59], a[56:59], v[28:31]
    v_fma_f32 v169, v149, v92, v14
    v_fma_f32 v170, v150, v92, v14
    v_mfma_f32_16x16x32_bf16 v[32:35], v[56:59], a[120:123], v[32:35]
    v_fma_f32 v171, v151, v92, v14
    v_mul_f32 v148, v148, v96
    v_mfma_f32_16x16x32_bf16 v[36:39], v[60:63], a[56:59], v[36:39]
    v_mul_f32 v149, v149, v96
    v_mul_f32 v150, v150, v96
    v_mfma_f32_16x16x32_bf16 v[40:43], v[60:63], a[120:123], v[40:43]
    v_mul_f32 v151, v151, v96
    v_fma_f32 v172, v156, v92, v14
    v_mfma_f32_16x16x32_bf16 v[44:47], v[64:67], a[56:59], v[44:47]
    v_fma_f32 v173, v157, v92, v14
    v_fma_f32 v174, v158, v92, v14
    v_mfma_f32_16x16x32_bf16 v[48:51], v[64:67], a[120:123], v[48:51]
    v_fma_f32 v175, v159, v92, v14
    s_waitcnt lgkmcnt(0)
    v_mfma_f32_16x16x32_bf16 v[20:23], v[68:71], a[60:63], v[20:23]
    v_mul_f32 v156, v156, v96
    v_mul_f32 v157, v157, v96
    v_mfma_f32_16x16x32_bf16 v[24:27], v[68:71], a[124:127], v[24:27]
    v_mul_f32 v158, v158, v96
    v_mul_f32 v159, v159, v96
    v_mfma_f32_16x16x32_bf16 v[28:31], v[72:75], a[60:63], v[28:31]
    v_mfma_f32_16x16x32_bf16 v[32:35], v[72:75], a[124:127], v[32:35]
    v_mfma_f32_16x16x32_bf16 v[36:39], v[76:79], a[60:63], v[36:39]
    v_mfma_f32_16x16x32_bf16 v[40:43], v[76:79], a[124:127], v[40:43]
    v_mfma_f32_16x16x32_bf16 v[44:47], v[80:83], a[60:63], v[44:47]
    v_mfma_f32_16x16x32_bf16 v[48:51], v[80:83], a[124:127], v[48:51]
    v_pk_fma_f32 v[20:21], v[20:21], v[128:129], v[160:161] op_sel:[0,0,0] op_sel_hi:[1,1,1]
    v_pk_fma_f32 v[22:23], v[22:23], v[130:131], v[162:163] op_sel:[0,0,0] op_sel_hi:[1,1,1]
    v_pk_fma_f32 v[24:25], v[24:25], v[128:129], v[132:133] op_sel:[0,0,0] op_sel_hi:[1,1,1]
    v_pk_fma_f32 v[26:27], v[26:27], v[130:131], v[134:135] op_sel:[0,0,0] op_sel_hi:[1,1,1]
    v_pk_fma_f32 v[160:161], v[20:21], v[14:15], v[12:13] op_sel:[0,1,1] op_sel_hi:[1,1,1]
    v_pk_fma_f32 v[162:163], v[22:23], v[14:15], v[12:13] op_sel:[0,1,1] op_sel_hi:[1,1,1]
    v_exp_f32_e64 v160, v160 clamp
    v_exp_f32_e64 v161, v161 clamp
    v_exp_f32_e64 v162, v162 clamp
    v_exp_f32_e64 v163, v163 clamp
    v_max_f32 v20, v20, v14
    v_max_f32 v21, v21, v14
    v_max_f32 v22, v22, v14
    v_max_f32 v23, v23, v14
    v_cvt_pk_bf16_f32 v88, v24, v25
    v_cvt_pk_bf16_f32 v89, v26, v27
    v_pk_add_f32 v[20:21], v[20:21], v[160:161] op_sel:[0,0] op_sel_hi:[1,1]
    v_pk_add_f32 v[22:23], v[22:23], v[162:163] op_sel:[0,0] op_sel_hi:[1,1]
    v_cvt_pk_bf16_f32 v80, v20, v21
    v_cvt_pk_bf16_f32 v81, v22, v23
    v_pk_fma_f32 v[28:29], v[28:29], v[136:137], v[164:165] op_sel:[0,0,0] op_sel_hi:[1,1,1]
    v_pk_fma_f32 v[30:31], v[30:31], v[138:139], v[166:167] op_sel:[0,0,0] op_sel_hi:[1,1,1]
    v_pk_fma_f32 v[32:33], v[32:33], v[136:137], v[140:141] op_sel:[0,0,0] op_sel_hi:[1,1,1]
    v_pk_fma_f32 v[34:35], v[34:35], v[138:139], v[142:143] op_sel:[0,0,0] op_sel_hi:[1,1,1]
    v_pk_fma_f32 v[164:165], v[28:29], v[14:15], v[12:13] op_sel:[0,1,1] op_sel_hi:[1,1,1]
    v_pk_fma_f32 v[166:167], v[30:31], v[14:15], v[12:13] op_sel:[0,1,1] op_sel_hi:[1,1,1]
    v_exp_f32_e64 v164, v164 clamp
    v_exp_f32_e64 v165, v165 clamp
    v_exp_f32_e64 v166, v166 clamp
    v_exp_f32_e64 v167, v167 clamp
    v_max_f32 v28, v28, v14
    v_max_f32 v29, v29, v14
    v_max_f32 v30, v30, v14
    v_max_f32 v31, v31, v14
    v_cvt_pk_bf16_f32 v90, v32, v33
    v_cvt_pk_bf16_f32 v91, v34, v35
    v_pk_add_f32 v[28:29], v[28:29], v[164:165] op_sel:[0,0] op_sel_hi:[1,1]
    v_pk_add_f32 v[30:31], v[30:31], v[166:167] op_sel:[0,0] op_sel_hi:[1,1]
    v_cvt_pk_bf16_f32 v82, v28, v29
    v_cvt_pk_bf16_f32 v83, v30, v31
    v_pk_fma_f32 v[36:37], v[36:37], v[144:145], v[168:169] op_sel:[0,0,0] op_sel_hi:[1,1,1]
    v_pk_fma_f32 v[38:39], v[38:39], v[146:147], v[170:171] op_sel:[0,0,0] op_sel_hi:[1,1,1]
    v_pk_fma_f32 v[40:41], v[40:41], v[144:145], v[148:149] op_sel:[0,0,0] op_sel_hi:[1,1,1]
    v_pk_fma_f32 v[42:43], v[42:43], v[146:147], v[150:151] op_sel:[0,0,0] op_sel_hi:[1,1,1]
    v_pk_fma_f32 v[168:169], v[36:37], v[14:15], v[12:13] op_sel:[0,1,1] op_sel_hi:[1,1,1]
    v_pk_fma_f32 v[170:171], v[38:39], v[14:15], v[12:13] op_sel:[0,1,1] op_sel_hi:[1,1,1]
    v_exp_f32_e64 v168, v168 clamp
    v_exp_f32_e64 v169, v169 clamp
    v_exp_f32_e64 v170, v170 clamp
    v_exp_f32_e64 v171, v171 clamp
    v_max_f32 v36, v36, v14
    v_max_f32 v37, v37, v14
    v_max_f32 v38, v38, v14
    v_max_f32 v39, v39, v14
    v_cvt_pk_bf16_f32 v92, v40, v41
    v_cvt_pk_bf16_f32 v93, v42, v43
    v_pk_add_f32 v[36:37], v[36:37], v[168:169] op_sel:[0,0] op_sel_hi:[1,1]
    v_pk_add_f32 v[38:39], v[38:39], v[170:171] op_sel:[0,0] op_sel_hi:[1,1]
    v_cvt_pk_bf16_f32 v84, v36, v37
    v_cvt_pk_bf16_f32 v85, v38, v39
    v_pk_fma_f32 v[44:45], v[44:45], v[152:153], v[172:173] op_sel:[0,0,0] op_sel_hi:[1,1,1]
    v_pk_fma_f32 v[46:47], v[46:47], v[154:155], v[174:175] op_sel:[0,0,0] op_sel_hi:[1,1,1]
    v_pk_fma_f32 v[48:49], v[48:49], v[152:153], v[156:157] op_sel:[0,0,0] op_sel_hi:[1,1,1]
    v_pk_fma_f32 v[50:51], v[50:51], v[154:155], v[158:159] op_sel:[0,0,0] op_sel_hi:[1,1,1]
    v_pk_fma_f32 v[172:173], v[44:45], v[14:15], v[12:13] op_sel:[0,1,1] op_sel_hi:[1,1,1]
    v_pk_fma_f32 v[174:175], v[46:47], v[14:15], v[12:13] op_sel:[0,1,1] op_sel_hi:[1,1,1]
    v_exp_f32_e64 v172, v172 clamp
    v_exp_f32_e64 v173, v173 clamp
    v_exp_f32_e64 v174, v174 clamp
    v_exp_f32_e64 v175, v175 clamp
    v_max_f32 v44, v44, v14
    v_max_f32 v45, v45, v14
    v_max_f32 v46, v46, v14
    v_max_f32 v47, v47, v14
    v_cvt_pk_bf16_f32 v94, v48, v49
    v_cvt_pk_bf16_f32 v95, v50, v51
    v_pk_add_f32 v[44:45], v[44:45], v[172:173] op_sel:[0,0] op_sel_hi:[1,1]
    v_pk_add_f32 v[46:47], v[46:47], v[174:175] op_sel:[0,0] op_sel_hi:[1,1]
    v_cvt_pk_bf16_f32 v86, v44, v45
    v_cvt_pk_bf16_f32 v87, v46, v47
    v_mfma_f32_16x16x32_bf16 v[96:99], v[80:83], v[88:91], 0
    v_mfma_f32_16x16x32_bf16 v[100:103], v[80:83], v[16:19], 0
    v_mfma_f32_16x16x32_bf16 v[96:99], v[84:87], v[92:95], v[96:99]
    v_mfma_f32_16x16x32_bf16 v[100:103], v[84:87], v[16:19], v[100:103]
    s_lshl_b32 s3, s36, 10
    s_add_u32 s5, s54, s3
    s_lshl_b32 s3, s36, 5
    s_add_u32 s4, s54, s3
    s_lshl_b32 s3, s36, 7
    s_and_b32 s7, s3, 0x380
    v_xor_b32 v110, s7, v1
    s_nop 0
    v_mov_b32_dpp v100, v101 quad_perm:[0,1,2,3] row_mask:0xf bank_mask:0x2
    v_cvt_pk_bf16_f32 v99, v98, v99
    v_cvt_pk_bf16_f32 v98, v96, v97
    v_mov_b32_dpp v100, v102 quad_perm:[0,1,2,3] row_mask:0xf bank_mask:0x4
    v_mov_b32 v101, s39
    s_add_u32 s3, s55, s3
    v_mov_b32_dpp v100, v103 quad_perm:[0,1,2,3] row_mask:0xf bank_mask:0x8
    buffer_store_dwordx4 v[98:101], v110, s[32:35], s5 offen sc1
    v_xor_b32 v113, 32, v9
    v_xor_b32 v114, 64, v9
    v_xor_b32 v115, 96, v9
    s_lshr_b32 s3, s36, 2
    v_lshrrev_b32 v112, 3, v0
    v_xor_b32 v116, s3, v112
    v_lshlrev_b32 v116, 7, v116
    v_lshl_add_u32 v116, v112, 10, v116
    v_lshl_add_u32 v116, v8, 2, v116
    s_and_b32 s5, s36, 3
    s_lshl2_add_u32 s5, s37, s5
    s_lshl_b32 s4, s5, 15
    s_lshl1_add_u32 s4, s46, s4
    s_add_u32 s4, s4, 1048576
    s_lshl3_add_u32 s3, s5, s3
    s_lshl_b32 s3, s3, 7
    s_add_u32 s3, s3, 65536
    s_cmp_eq_u32 s38, 0
    s_cselect_b32 s3, s3, 67108864
    s_lshl2_add_u32 s98, s37, s38
    s_lshl_b32 s98, s98, 10
    s_add_u32 s98, s98, 65536
    v_lshlrev_b32 v117, 2, v0
    v_add_u32 v117, 159744, v117
    v_lshl_add_u32 v119, s38, 9, v117
    v_lshrrev_b32 v112, 3, v0
    v_min_u32 v112, 1, v112
    v_lshl_add_u32 v112, v112, 26, v1
    v_bfe_u32 v248, v0, 3, 2
    v_lshl_add_u32 v248, v248, 8, v8
    s_and_b32 s99, s51, 0xfffffc00
    s_waitcnt vmcnt(6)
    s_barrier
    ds_read_b64_tr_b16 a[128:129], v126 offset:49152
    ds_read_b64_tr_b16 a[130:131], v126 offset:49664
    ds_read_b64_tr_b16 a[132:133], v126 offset:53248
    ds_read_b64_tr_b16 a[134:135], v126 offset:53760
    ds_read_b64_tr_b16 a[136:137], v126 offset:57344
    ds_read_b64_tr_b16 a[138:139], v126 offset:57856
    ds_read_b64_tr_b16 a[140:141], v126 offset:61440
    ds_read_b64_tr_b16 a[142:143], v126 offset:61952
    ds_read_b64_tr_b16 a[144:145], v123 offset:0
    ds_read_b64_tr_b16 a[146:147], v123 offset:512
    s_waitcnt lgkmcnt(6)
    v_mfma_f32_16x16x32_bf16 v[92:95], v[16:19], a[128:131], 0
    ds_read_b64_tr_b16 a[148:149], v123 offset:4096
    ds_read_b64_tr_b16 a[150:151], v123 offset:4608
    v_mfma_f32_16x16x32_bf16 v[92:95], v[16:19], a[132:135], v[92:95]
    ds_read_b64_tr_b16 a[152:153], v123 offset:8192
    ds_read_b64_tr_b16 a[154:155], v123 offset:8704
    s_waitcnt lgkmcnt(6)
    v_mfma_f32_16x16x32_bf16 v[92:95], v[16:19], a[136:139], v[92:95]
    ds_read_b64_tr_b16 a[156:157], v123 offset:12288
    ds_read_b64_tr_b16 a[158:159], v123 offset:12800
    v_mfma_f32_16x16x32_bf16 v[92:95], v[16:19], a[140:143], v[92:95]
    ds_read_b64_tr_b16 a[160:161], v126 offset:0
    ds_read_b64_tr_b16 a[162:163], v126 offset:512
    s_waitcnt lgkmcnt(6)
    v_mfma_f32_16x16x32_bf16 v[92:95], v[16:19], a[144:147], v[92:95]
    ds_read_b64_tr_b16 a[164:165], v126 offset:4096
    ds_read_b64_tr_b16 a[166:167], v126 offset:4608
    v_mfma_f32_16x16x32_bf16 v[92:95], v[16:19], a[148:151], v[92:95]
    ds_read_b64_tr_b16 a[168:169], v126 offset:8192
    ds_read_b64_tr_b16 a[170:171], v126 offset:8704
    s_waitcnt lgkmcnt(6)
    v_mfma_f32_16x16x32_bf16 v[92:95], v[16:19], a[152:155], v[92:95]
    ds_read_b64_tr_b16 a[172:173], v126 offset:12288
    ds_read_b64_tr_b16 a[174:175], v126 offset:12800
    v_mfma_f32_16x16x32_bf16 v[92:95], v[16:19], a[156:159], v[92:95]
    ds_read_b64_tr_b16 a[176:177], v126 offset:16384
    ds_read_b64_tr_b16 a[178:179], v126 offset:16896
    s_waitcnt lgkmcnt(6)
    v_mfma_f32_16x16x32_bf16 v[92:95], v[16:19], a[160:163], v[92:95]
    ds_read_b64_tr_b16 a[180:181], v126 offset:20480
    ds_read_b64_tr_b16 a[182:183], v126 offset:20992
    v_mfma_f32_16x16x32_bf16 v[92:95], v[16:19], a[164:167], v[92:95]
    ds_read_b64_tr_b16 a[184:185], v126 offset:24576
    ds_read_b64_tr_b16 a[186:187], v126 offset:25088
    s_waitcnt lgkmcnt(6)
    v_mfma_f32_16x16x32_bf16 v[92:95], v[16:19], a[168:171], v[92:95]
    ds_read_b64_tr_b16 a[188:189], v126 offset:28672
    ds_read_b64_tr_b16 a[190:191], v126 offset:29184
    v_mfma_f32_16x16x32_bf16 v[92:95], v[16:19], a[172:175], v[92:95]
    ds_read_b128 v[44:47], v2 offset:0
    ds_read_b128 v[48:51], v2 offset:1024
    s_waitcnt lgkmcnt(6)
    v_mfma_f32_16x16x32_bf16 v[92:95], v[16:19], a[176:179], v[92:95]
    ds_read_b128 v[52:55], v2 offset:2048
    ds_read_b128 v[56:59], v2 offset:3072
    v_mfma_f32_16x16x32_bf16 v[92:95], v[16:19], a[180:183], v[92:95]
    ds_read_b128 v[60:63], v2 offset:4096
    ds_read_b128 v[64:67], v2 offset:5120
    s_waitcnt lgkmcnt(6)
    v_mfma_f32_16x16x32_bf16 v[92:95], v[16:19], a[184:187], v[92:95]
    ds_read_b128 v[68:71], v2 offset:6144
    ds_read_b128 v[72:75], v2 offset:7168
    v_mfma_f32_16x16x32_bf16 v[92:95], v[16:19], a[188:191], v[92:95]
    ds_read_b128 v[76:79], v2 offset:8192
    ds_read_b128 v[80:83], v2 offset:9216
    ds_read_b128 v[84:87], v2 offset:10240
    s_barrier
    s_waitcnt lgkmcnt(10)
    v_mfma_f32_16x16x32_bf16 v[28:31], a[128:131], v[44:47], 0
    ds_read_b128 v[88:91], v2 offset:11264
    s_waitcnt lgkmcnt(10)
    v_mfma_f32_16x16x32_bf16 v[28:31], a[132:135], v[48:51], v[28:31]
    ds_read_b128 v[44:47], v2 offset:12288
    s_waitcnt lgkmcnt(10)
    v_mfma_f32_16x16x32_bf16 v[28:31], a[136:139], v[52:55], v[28:31]
    ds_read_b128 v[48:51], v2 offset:13312
    ds_write_b32 v6, v92 offset:0
    s_waitcnt lgkmcnt(11)
    v_mfma_f32_16x16x32_bf16 v[28:31], a[140:143], v[56:59], v[28:31]
    ds_read_b128 v[52:55], v2 offset:14336
    s_waitcnt lgkmcnt(8)
    v_mfma_f32_16x16x32_bf16 v[28:31], a[144:147], v[60:63], v[28:31]
    ds_read_b128 v[56:59], v2 offset:15360
    v_mfma_f32_16x16x32_bf16 v[28:31], a[148:151], v[64:67], v[28:31]
    ds_read_b128 v[60:63], v2 offset:16384
    v_mfma_f32_16x16x32_bf16 v[28:31], a[152:155], v[68:71], v[28:31]
    ds_read_b128 v[64:67], v2 offset:17408
    v_mfma_f32_16x16x32_bf16 v[28:31], a[156:159], v[72:75], v[28:31]
    ds_read_b128 v[68:71], v2 offset:18432
    s_waitcnt lgkmcnt(8)
    v_mfma_f32_16x16x32_bf16 v[28:31], a[160:163], v[76:79], v[28:31]
    ds_read_b128 v[72:75], v2 offset:19456
    v_mfma_f32_16x16x32_bf16 v[28:31], a[164:167], v[80:83], v[28:31]
    ds_read_b128 v[76:79], v2 offset:20480
    s_waitcnt vmcnt(0)
    buffer_load_dwordx4 v[104:107], v116, s[32:35], s4 offen offset:0 sc1
    v_mfma_f32_16x16x32_bf16 v[28:31], a[168:171], v[84:87], v[28:31]
    ds_read_b128 v[80:83], v2 offset:21504
    v_mfma_f32_16x16x32_bf16 v[28:31], a[172:175], v[88:91], v[28:31]
    ds_read_b128 v[84:87], v2 offset:22528
    buffer_load_dword v252, v248, s[32:35], s99 offen offset:128 sc1
    s_waitcnt lgkmcnt(7)
    v_mfma_f32_16x16x32_bf16 v[28:31], a[176:179], v[44:47], v[28:31]
    s_add_u32 m0, s44, 0
    s_xor_b32 s7, s47, 0
    ds_read_b128 v[88:91], v2 offset:23552
    v_mfma_f32_16x16x32_bf16 v[28:31], a[180:183], v[48:51], v[28:31]
    buffer_load_dwordx4 v9, s[16:19], s7 offen offset:0 lds
    ds_read_b128 v[44:47], v2 offset:24576
    v_mfma_f32_16x16x32_bf16 v[28:31], a[184:187], v[52:55], v[28:31]
    ds_read_b128 v[48:51], v2 offset:25600
    v_mfma_f32_16x16x32_bf16 v[28:31], a[188:191], v[56:59], v[28:31]
    ds_read_b128 v[52:55], v2 offset:26624
    s_waitcnt lgkmcnt(7)
    v_mfma_f32_16x16x32_bf16 v[32:35], a[128:131], v[60:63], 0
    ds_read_b128 v[56:59], v2 offset:27648
    v_mfma_f32_16x16x32_bf16 v[32:35], a[132:135], v[64:67], v[32:35]
    buffer_load_dwordx4 v113, s[16:19], s7 offen offset:1024 lds
    ds_read_b128 v[60:63], v2 offset:28672
    v_mfma_f32_16x16x32_bf16 v[32:35], a[136:139], v[68:71], v[32:35]
    ds_read_b128 v[64:67], v2 offset:29696
    v_mfma_f32_16x16x32_bf16 v[32:35], a[140:143], v[72:75], v[32:35]
    ds_read_b128 v[68:71], v2 offset:30720
    s_waitcnt lgkmcnt(7)
    v_mfma_f32_16x16x32_bf16 v[32:35], a[144:147], v[76:79], v[32:35]
    ds_read_b128 v[72:75], v2 offset:31744
    v_mfma_f32_16x16x32_bf16 v[32:35], a[148:151], v[80:83], v[32:35]
    buffer_load_dwordx4 v114, s[16:19], s7 offen offset:2048 lds
    ds_read_b128 v[76:79], v2 offset:32768
    v_mfma_f32_16x16x32_bf16 v[32:35], a[152:155], v[84:87], v[32:35]
    ds_read_b128 v[80:83], v2 offset:33792
    v_mfma_f32_16x16x32_bf16 v[32:35], a[156:159], v[88:91], v[32:35]
    ds_read_b128 v[84:87], v2 offset:34816
    s_waitcnt lgkmcnt(7)
    v_mfma_f32_16x16x32_bf16 v[32:35], a[160:163], v[44:47], v[32:35]
    ds_read_b128 v[88:91], v2 offset:35840
    v_mfma_f32_16x16x32_bf16 v[32:35], a[164:167], v[48:51], v[32:35]
    buffer_load_dwordx4 v115, s[16:19], s7 offen offset:3072 lds
    ds_read_b128 v[44:47], v2 offset:36864
    v_mfma_f32_16x16x32_bf16 v[32:35], a[168:171], v[52:55], v[32:35]
    ds_read_b128 v[48:51], v2 offset:37888
    v_mfma_f32_16x16x32_bf16 v[32:35], a[172:175], v[56:59], v[32:35]
    ds_read_b128 v[52:55], v2 offset:38912
    s_waitcnt lgkmcnt(7)
    v_mfma_f32_16x16x32_bf16 v[32:35], a[176:179], v[60:63], v[32:35]
    s_add_u32 m0, s44, 4096
    s_xor_b32 s7, s47, 32768
    ds_read_b128 v[56:59], v2 offset:39936
    v_mfma_f32_16x16x32_bf16 v[32:35], a[180:183], v[64:67], v[32:35]
    buffer_load_dwordx4 v9, s[16:19], s7 offen offset:0 lds
    ds_read_b128 v[60:63], v2 offset:40960
    s_waitcnt vmcnt(6)
    v_cmp_ne_u32 vcc, s39, v107
    s_cbranch_vccnz L_retry_1
L_back_2:
    v_lshlrev_b32 v108, 16, v104
    v_and_b32 v109, 0xffff0000, v104
    v_lshlrev_b32 v110, 16, v105
    v_and_b32 v111, 0xffff0000, v105
    v_mov_b32 v104, v106
L_pad1:
    s_cbranch_execz L_warm0
    v_permlane32_swap_b32 v108, v109
    v_permlane32_swap_b32 v110, v111
    v_permlane32_swap_b32 v106, v104
    v_add_f32 v108, v108, v109
    v_add_f32 v110, v110, v111
    v_add_f32 v106, v106, v104
    v_mov_b32 v104, v106
    v_permlane16_swap_b32 v108, v110
    v_add_f32 v108, v108, v110
    v_permlane16_swap_b32 v106, v104
    v_add_f32 v106, v106, v104
    v_add_f32_dpp v108, v108, v108 row_ror:8 row_mask:0xf bank_mask:0xf
    s_nop 0
    v_add_f32_dpp v106, v106, v106 row_ror:8 row_mask:0xf bank_mask:0xf
    ds_write2st64_b32 v119, v108, v106 offset0:0 offset1:1
    s_waitcnt lgkmcnt(0)
    s_barrier
    ds_read2st64_b32 v[108:109], v117 offset0:0 offset1:1
    ds_read2st64_b32 v[110:111], v117 offset0:2 offset1:3
    ds_read2st64_b32 v[100:101], v117 offset0:4 offset1:5
    ds_read2st64_b32 v[102:103], v117 offset0:6 offset1:7
    s_waitcnt lgkmcnt(2)
    v_add_f32 v108, v108, v110
    v_add_f32 v109, v109, v111
    s_waitcnt lgkmcnt(0)
    v_add_f32 v100, v100, v102
    v_add_f32 v101, v101, v103
    v_add_f32 v108, v108, v100
    v_add_f32 v106, v109, v101
    v_mov_b32 v109, v108
    s_nop 1
    v_permlane32_swap_b32 v108, v109
    v_cvt_pk_bf16_f32 v104, v108, v109
    v_mov_b32 v105, v104
    s_nop 1
    v_permlane16_swap_b32 v104, v105
    buffer_store_dwordx4 v[104:107], v112, s[32:35], s3 offen sc1
    v_mfma_f32_16x16x32_bf16 v[32:35], a[184:187], v[68:71], v[32:35]
    ds_read_b128 v[64:67], v2 offset:41984
    v_mfma_f32_16x16x32_bf16 v[32:35], a[188:191], v[72:75], v[32:35]
    ds_read_b128 v[68:71], v2 offset:43008
    v_mfma_f32_16x16x32_bf16 v[36:39], a[128:131], v[76:79], 0
    ds_read_b128 v[72:75], v2 offset:44032
    v_mfma_f32_16x16x32_bf16 v[36:39], a[132:135], v[80:83], v[36:39]
    buffer_load_dwordx4 v113, s[16:19], s7 offen offset:1024 lds
    ds_read_b128 v[76:79], v2 offset:45056
    v_mfma_f32_16x16x32_bf16 v[36:39], a[136:139], v[84:87], v[36:39]
    ds_read_b128 v[80:83], v2 offset:46080
    v_mfma_f32_16x16x32_bf16 v[36:39], a[140:143], v[88:91], v[36:39]
    ds_read_b128 v[84:87], v2 offset:47104
    v_mfma_f32_16x16x32_bf16 v[36:39], a[144:147], v[44:47], v[36:39]
    ds_read_b128 v[88:91], v2 offset:48128
    v_mfma_f32_16x16x32_bf16 v[36:39], a[148:151], v[48:51], v[36:39]
    buffer_load_dwordx4 v114, s[16:19], s7 offen offset:2048 lds
    ds_read_b128 v[44:47], v2 offset:49152
    v_mfma_f32_16x16x32_bf16 v[36:39], a[152:155], v[52:55], v[36:39]
    ds_read_b128 v[48:51], v2 offset:50176
    v_mfma_f32_16x16x32_bf16 v[36:39], a[156:159], v[56:59], v[36:39]
    ds_read_b128 v[52:55], v2 offset:51200
    s_waitcnt lgkmcnt(7)
    v_mfma_f32_16x16x32_bf16 v[36:39], a[160:163], v[60:63], v[36:39]
    ds_read_b128 v[56:59], v2 offset:52224
    v_mfma_f32_16x16x32_bf16 v[36:39], a[164:167], v[64:67], v[36:39]
    buffer_load_dwordx4 v115, s[16:19], s7 offen offset:3072 lds
    ds_read_b128 v[60:63], v2 offset:53248
    v_mfma_f32_16x16x32_bf16 v[36:39], a[168:171], v[68:71], v[36:39]
    ds_read_b128 v[64:67], v2 offset:54272
    v_mfma_f32_16x16x32_bf16 v[36:39], a[172:175], v[72:75], v[36:39]
    ds_read_b128 v[68:71], v2 offset:55296
    s_waitcnt lgkmcnt(7)
    v_mfma_f32_16x16x32_bf16 v[36:39], a[176:179], v[76:79], v[36:39]
    s_add_u32 m0, s44, 8192
    s_xor_b32 s7, s47, 65536
    ds_read_b128 v[72:75], v2 offset:56320
    v_mfma_f32_16x16x32_bf16 v[36:39], a[180:183], v[80:83], v[36:39]
    buffer_load_dwordx4 v9, s[16:19], s7 offen offset:0 lds
    ds_read_b128 v[76:79], v2 offset:57344
    v_mfma_f32_16x16x32_bf16 v[36:39], a[184:187], v[84:87], v[36:39]
    ds_read_b128 v[80:83], v2 offset:58368
    v_mfma_f32_16x16x32_bf16 v[36:39], a[188:191], v[88:91], v[36:39]
    ds_read_b128 v[84:87], v2 offset:59392
    s_waitcnt lgkmcnt(7)
    v_mfma_f32_16x16x32_bf16 v[40:43], a[128:131], v[44:47], 0
    ds_read_b128 v[88:91], v2 offset:60416
    v_mfma_f32_16x16x32_bf16 v[40:43], a[132:135], v[48:51], v[40:43]
    buffer_load_dwordx4 v113, s[16:19], s7 offen offset:1024 lds
    ds_read_b128 v[44:47], v2 offset:61440
    v_mfma_f32_16x16x32_bf16 v[40:43], a[136:139], v[52:55], v[40:43]
    ds_read_b128 v[48:51], v2 offset:62464
    v_mfma_f32_16x16x32_bf16 v[40:43], a[140:143], v[56:59], v[40:43]
    ds_read_b128 v[52:55], v2 offset:63488
    s_waitcnt lgkmcnt(7)
    v_mfma_f32_16x16x32_bf16 v[40:43], a[144:147], v[60:63], v[40:43]
    ds_read_b128 v[56:59], v2 offset:64512
    v_mfma_f32_16x16x32_bf16 v[40:43], a[148:151], v[64:67], v[40:43]
    buffer_load_dwordx4 v114, s[16:19], s7 offen offset:2048 lds
    v_mfma_f32_16x16x32_bf16 v[40:43], a[152:155], v[68:71], v[40:43]
    v_mfma_f32_16x16x32_bf16 v[40:43], a[156:159], v[72:75], v[40:43]
    s_waitcnt lgkmcnt(4)
    v_mfma_f32_16x16x32_bf16 v[40:43], a[160:163], v[76:79], v[40:43]
    v_mfma_f32_16x16x32_bf16 v[40:43], a[164:167], v[80:83], v[40:43]
    buffer_load_dwordx4 v115, s[16:19], s7 offen offset:3072 lds
    v_mfma_f32_16x16x32_bf16 v[40:43], a[168:171], v[84:87], v[40:43]
    v_mfma_f32_16x16x32_bf16 v[40:43], a[172:175], v[88:91], v[40:43]
    s_waitcnt lgkmcnt(0)
    v_mfma_f32_16x16x32_bf16 v[40:43], a[176:179], v[44:47], v[40:43]
    s_add_u32 m0, s44, 12288
    s_xor_b32 s7, s47, 98304
    v_mfma_f32_16x16x32_bf16 v[40:43], a[180:183], v[48:51], v[40:43]
    buffer_load_dwordx4 v9, s[16:19], s7 offen offset:0 lds
    v_mfma_f32_16x16x32_bf16 v[40:43], a[184:187], v[52:55], v[40:43]
    v_mfma_f32_16x16x32_bf16 v[40:43], a[188:191], v[56:59], v[40:43]
    ds_read_b128 v[76:79], v5
    ds_read2_b32 v[80:81], v4 offset0:0 offset1:64
    ds_read2_b32 v[82:83], v4 offset0:16 offset1:80
    ds_read2_b32 v[84:85], v4 offset0:32 offset1:96
    ds_read2_b32 v[86:87], v4 offset0:48 offset1:112
    s_waitcnt vmcnt(14)
    v_subrev_u32 v120, s39, v252
    v_cmp_lt_u32 vcc, 15, v120
    s_cbranch_vccnz L_retry_4
L_back_5:
    v_readfirstlane_b32 s6, v252
    s_nop 1
    v_cmp_ne_u32 vcc, s6, v252
    s_cmp_eq_u64 vcc, 0
    s_cselect_b32 s53, 1, 0
    v_add_u32 v122, 65792, v126
    s_barrier
    s_waitcnt lgkmcnt(3)
    v_pk_fma_f32 v[88:89], v[76:77], v[80:81], v[14:15] op_sel:[0,1,0] op_sel_hi:[1,1,0]
    buffer_load_dwordx4 v113, s[16:19], s7 offen offset:1024 lds
    v_pk_fma_f32 v[90:91], v[78:79], v[80:81], v[14:15] op_sel:[0,1,0] op_sel_hi:[1,1,0]
    v_pk_fma_f32 v[28:29], v[28:29], v[80:81], v[88:89] op_sel:[0,0,0] op_sel_hi:[1,0,1]
    v_pk_fma_f32 v[30:31], v[30:31], v[80:81], v[90:91] op_sel:[0,0,0] op_sel_hi:[1,0,1]
    v_pk_fma_f32 v[88:89], v[28:29], v[14:15], v[12:13] op_sel:[0,1,1] op_sel_hi:[1,1,1]
    v_pk_fma_f32 v[90:91], v[30:31], v[14:15], v[12:13] op_sel:[0,1,1] op_sel_hi:[1,1,1]
    v_exp_f32_e64 v88, v88 clamp
    v_exp_f32_e64 v89, v89 clamp
    v_exp_f32_e64 v90, v90 clamp
    v_exp_f32_e64 v91, v91 clamp
    buffer_load_dwordx4 v114, s[16:19], s7 offen offset:2048 lds
    v_max_f32 v28, v28, v14
    v_max_f32 v29, v29, v14
    v_max_f32 v30, v30, v14
    v_max_f32 v31, v31, v14
    v_pk_add_f32 v[28:29], v[28:29], v[88:89] op_sel:[0,0] op_sel_hi:[1,1]
    v_pk_add_f32 v[30:31], v[30:31], v[90:91] op_sel:[0,0] op_sel_hi:[1,1]
    v_cvt_pk_bf16_f32 v20, v28, v29
    v_cvt_pk_bf16_f32 v21, v30, v31
    s_waitcnt lgkmcnt(2)
    v_pk_fma_f32 v[88:89], v[76:77], v[82:83], v[14:15] op_sel:[0,1,0] op_sel_hi:[1,1,0]
    buffer_load_dwordx4 v115, s[16:19], s7 offen offset:3072 lds
    v_pk_fma_f32 v[90:91], v[78:79], v[82:83], v[14:15] op_sel:[0,1,0] op_sel_hi:[1,1,0]
    v_pk_fma_f32 v[32:33], v[32:33], v[82:83], v[88:89] op_sel:[0,0,0] op_sel_hi:[1,0,1]
    v_pk_fma_f32 v[34:35], v[34:35], v[82:83], v[90:91] op_sel:[0,0,0] op_sel_hi:[1,0,1]
    v_pk_fma_f32 v[88:89], v[32:33], v[14:15], v[12:13] op_sel:[0,1,1] op_sel_hi:[1,1,1]
    v_pk_fma_f32 v[90:91], v[34:35], v[14:15], v[12:13] op_sel:[0,1,1] op_sel_hi:[1,1,1]
    v_exp_f32_e64 v88, v88 clamp
    v_exp_f32_e64 v89, v89 clamp
    v_exp_f32_e64 v90, v90 clamp
    s_add_u32 m0, s46, 131328
    s_add_u32 s7, s45, 1024
    v_exp_f32_e64 v91, v91 clamp
    buffer_load_dwordx4 v124, s[20:23], s7 offen lds
    v_max_f32 v32, v32, v14
    v_max_f32 v33, v33, v14
    v_max_f32 v34, v34, v14
    v_max_f32 v35, v35, v14
    v_pk_add_f32 v[32:33], v[32:33], v[88:89] op_sel:[0,0] op_sel_hi:[1,1]
    v_pk_add_f32 v[34:35], v[34:35], v[90:91] op_sel:[0,0] op_sel_hi:[1,1]
    v_cvt_pk_bf16_f32 v22, v32, v33
    v_cvt_pk_bf16_f32 v23, v34, v35
    s_add_u32 m0, s46, 132352
    s_waitcnt lgkmcnt(1)
    v_pk_fma_f32 v[88:89], v[76:77], v[84:85], v[14:15] op_sel:[0,1,0] op_sel_hi:[1,1,0]
    buffer_load_dwordx4 v125, s[20:23], s7 offen lds
    v_pk_fma_f32 v[90:91], v[78:79], v[84:85], v[14:15] op_sel:[0,1,0] op_sel_hi:[1,1,0]
    v_pk_fma_f32 v[36:37], v[36:37], v[84:85], v[88:89] op_sel:[0,0,0] op_sel_hi:[1,0,1]
    v_pk_fma_f32 v[38:39], v[38:39], v[84:85], v[90:91] op_sel:[0,0,0] op_sel_hi:[1,0,1]
    v_pk_fma_f32 v[88:89], v[36:37], v[14:15], v[12:13] op_sel:[0,1,1] op_sel_hi:[1,1,1]
    v_pk_fma_f32 v[90:91], v[38:39], v[14:15], v[12:13] op_sel:[0,1,1] op_sel_hi:[1,1,1]
    v_exp_f32_e64 v88, v88 clamp
    v_exp_f32_e64 v89, v89 clamp
    v_exp_f32_e64 v90, v90 clamp
    s_add_u32 m0, s46, 133376
    s_add_u32 s7, s45, 50176
    v_exp_f32_e64 v91, v91 clamp
    buffer_load_dwordx4 v124, s[20:23], s7 offen lds
    v_max_f32 v36, v36, v14
    v_max_f32 v37, v37, v14
    v_max_f32 v38, v38, v14
    v_max_f32 v39, v39, v14
    v_pk_add_f32 v[36:37], v[36:37], v[88:89] op_sel:[0,0] op_sel_hi:[1,1]
    v_pk_add_f32 v[38:39], v[38:39], v[90:91] op_sel:[0,0] op_sel_hi:[1,1]
    v_cvt_pk_bf16_f32 v24, v36, v37
    v_cvt_pk_bf16_f32 v25, v38, v39
    s_waitcnt vmcnt(14)
    s_waitcnt lgkmcnt(0)
    v_pk_fma_f32 v[88:89], v[76:77], v[86:87], v[14:15] op_sel:[0,1,0] op_sel_hi:[1,1,0]
    buffer_load_dwordx4 v[96:99], v1, s[32:35], s98 offen offset:0 sc1
    v_pk_fma_f32 v[90:91], v[78:79], v[86:87], v[14:15] op_sel:[0,1,0] op_sel_hi:[1,1,0]
    v_pk_fma_f32 v[40:41], v[40:41], v[86:87], v[88:89] op_sel:[0,0,0] op_sel_hi:[1,0,1]
    v_pk_fma_f32 v[42:43], v[42:43], v[86:87], v[90:91] op_sel:[0,0,0] op_sel_hi:[1,0,1]
    v_pk_fma_f32 v[88:89], v[40:41], v[14:15], v[12:13] op_sel:[0,1,1] op_sel_hi:[1,1,1]
    v_pk_fma_f32 v[90:91], v[42:43], v[14:15], v[12:13] op_sel:[0,1,1] op_sel_hi:[1,1,1]
    v_exp_f32_e64 v88, v88 clamp
    v_exp_f32_e64 v89, v89 clamp
    v_exp_f32_e64 v90, v90 clamp
    s_add_u32 m0, s46, 134400
    v_exp_f32_e64 v91, v91 clamp
    buffer_load_dwordx4 v125, s[20:23], s7 offen lds
    v_max_f32 v40, v40, v14
    v_max_f32 v41, v41, v14
    v_max_f32 v42, v42, v14
    v_max_f32 v43, v43, v14
    v_pk_add_f32 v[40:41], v[40:41], v[88:89] op_sel:[0,0] op_sel_hi:[1,1]
    v_pk_add_f32 v[42:43], v[42:43], v[90:91] op_sel:[0,0] op_sel_hi:[1,1]
    v_cvt_pk_bf16_f32 v26, v40, v41
    v_cvt_pk_bf16_f32 v27, v42, v43
    s_add_u32 m0, s46, 65792
    s_add_u32 s7, s45, 394240
    s_add_u32 s4, s41, 2097152
    buffer_load_dwordx4 v124, s[20:23], s7 offen lds
    v_permlane16_swap_b32 v20, v22
    v_permlane16_swap_b32 v21, v23
    s_add_u32 s5, s4, 32768
    v_permlane16_swap_b32 v24, v26
    v_permlane16_swap_b32 v25, v27
    s_add_u32 m0, s46, 66816
    s_nop 0
    buffer_load_dwordx4 v125, s[20:23], s7 offen lds
    s_add_u32 m0, s46, 67840
    s_add_u32 s7, s45, 443392
    buffer_load_dwordx4 v124, s[20:23], s7 offen lds
    s_add_u32 m0, s46, 68864
    s_nop 0
    buffer_load_dwordx4 v125, s[20:23], s7 offen lds
    s_add_u32 m0, s46, 82176
    s_add_u32 s7, s45, 787456
    buffer_load_dwordx4 v124, s[20:23], s7 offen lds
    s_add_u32 m0, s46, 83200
    s_nop 0
    buffer_load_dwordx4 v125, s[20:23], s7 offen lds
    s_add_u32 m0, s46, 84224
    s_add_u32 s7, s45, 836608
    buffer_load_dwordx4 v124, s[20:23], s7 offen lds
    s_add_u32 m0, s46, 85248
    s_nop 0
    buffer_load_dwordx4 v125, s[20:23], s7 offen lds
    s_waitcnt vmcnt(9)
    v_cmp_ne_u32 vcc, s39, v99
    s_cbranch_vccnz L_retry_7
L_back_8:
    v_mov_b32_dpp v108, v98 row_newbcast:0 row_mask:0xf bank_mask:0xf
    v_mov_b32_dpp v109, v98 row_newbcast:4 row_mask:0xf bank_mask:0xf
    v_mov_b32_dpp v110, v98 row_newbcast:8 row_mask:0xf bank_mask:0xf
    v_mov_b32_dpp v111, v98 row_newbcast:12 row_mask:0xf bank_mask:0xf
    v_cvt_pk_bf16_f32 v98, v108, v109
    v_cvt_pk_bf16_f32 v99, v110, v111
    s_nop 0
    v_permlane16_swap_b32 v96, v98
    v_permlane16_swap_b32 v97, v99
    s_nop 1
    v_mfma_f32_32x32x16_bf16 v[28:43], v[96:99], v[20:23], 0
    v_mfma_f32_32x32x16_bf16 v[44:59], v[96:99], v[24:27], 0
    s_cmp_eq_u32 s53, 0
    v_mov_b32 v70, s39
    v_min_u32 v71, 1, v0
    v_lshlrev_b32 v71, 26, v71
    s_nop 6
    v_add_f32 v36, 0x358637bd, v36
    v_add_f32 v52, 0x358637bd, v52
    v_rcp_f32 v36, v36
    v_rcp_f32 v52, v52
    v_pk_mul_f32 v[28:29], v[28:29], v[36:37] op_sel:[0,0] op_sel_hi:[1,0]
    v_pk_mul_f32 v[30:31], v[30:31], v[36:37] op_sel:[0,0] op_sel_hi:[1,0]
    v_pk_mul_f32 v[32:33], v[32:33], v[36:37] op_sel:[0,0] op_sel_hi:[1,0]
    v_pk_mul_f32 v[34:35], v[34:35], v[36:37] op_sel:[0,0] op_sel_hi:[1,0]
    v_cvt_pk_bf16_f32 v38, v28, v29
    v_cvt_pk_bf16_f32 v39, v30, v31
    v_cvt_pk_bf16_f32 v40, v32, v33
    v_cvt_pk_bf16_f32 v41, v34, v35
    buffer_store_dwordx4 v[38:41], v7, s[32:35], s4 offen sc1
    v_pk_mul_f32 v[44:45], v[44:45], v[52:53] op_sel:[0,0] op_sel_hi:[1,0]
    v_pk_mul_f32 v[46:47], v[46:47], v[52:53] op_sel:[0,0] op_sel_hi:[1,0]
    v_pk_mul_f32 v[48:49], v[48:49], v[52:53] op_sel:[0,0] op_sel_hi:[1,0]
    v_pk_mul_f32 v[50:51], v[50:51], v[52:53] op_sel:[0,0] op_sel_hi:[1,0]
    v_cvt_pk_bf16_f32 v54, v44, v45
    v_cvt_pk_bf16_f32 v55, v46, v47
    v_cvt_pk_bf16_f32 v56, v48, v49
    v_cvt_pk_bf16_f32 v57, v50, v51
    buffer_store_dwordx4 v[54:57], v7, s[32:35], s5 offen sc1
    v_mov_b32 v13, v122
    v_mov_b32 v253, v123
    v_mov_b32 v254, v124
    v_mov_b32 v255, v125
    s_add_u32 m0, s46, 98560
    s_add_u32 s7, s45, 1180672
    buffer_load_dwordx4 v254, s[20:23], s7 offen lds
    s_add_u32 m0, s46, 99584
    s_nop 0
    buffer_load_dwordx4 v255, s[20:23], s7 offen lds
    s_add_u32 m0, s46, 100608
    s_add_u32 s7, s45, 1229824
    buffer_load_dwordx4 v254, s[20:23], s7 offen lds
    s_add_u32 m0, s46, 101632
    s_nop 0
    buffer_load_dwordx4 v255, s[20:23], s7 offen lds
    s_add_u32 m0, s46, 114944
    s_add_u32 s7, s45, 2048
    buffer_load_dwordx4 v254, s[20:23], s7 offen lds
    s_add_u32 m0, s46, 115968
    s_nop 0
    buffer_load_dwordx4 v255, s[20:23], s7 offen lds
    s_add_u32 m0, s46, 116992
    s_add_u32 s7, s45, 51200
    buffer_load_dwordx4 v254, s[20:23], s7 offen lds
    s_add_u32 m0, s46, 118016
    s_nop 0
    buffer_load_dwordx4 v255, s[20:23], s7 offen lds
    s_lshl_b32 s6, s38, 11
    s_add_u32 s6, s6, 150144
    v_add_u32 v14, s6, v1
    v_xor_b32 v124, 32, v10
    v_xor_b32 v125, 64, v10
    v_xor_b32 v126, 96, v10
    s_add_u32 s6, s49, 2097152
    v_mov_b32 v15, v71
    v_mov_b32 v16, 0x3f803f80
    v_lshrrev_b32 v18, 4, v0
    v_min_u32 v18, 1, v18
    v_lshl_add_u32 v18, v18, 26, v1
    s_add_u32 s0, s39, 2
    v_permlane16_swap_b32 v240, v242
    v_permlane16_swap_b32 v241, v243
    v_permlane16_swap_b32 v244, v246
    v_permlane16_swap_b32 v245, v247
    v_lshlrev_b32 v20, 16, v240
    v_and_b32 v21, 0xffff0000, v240
    v_lshlrev_b32 v22, 16, v241
    v_and_b32 v23, 0xffff0000, v241
    v_lshlrev_b32 v24, 16, v242
    v_and_b32 v25, 0xffff0000, v242
    v_lshlrev_b32 v26, 16, v243
    v_and_b32 v27, 0xffff0000, v243
    v_lshlrev_b32 v28, 16, v244
    v_and_b32 v29, 0xffff0000, v244
    v_lshlrev_b32 v30, 16, v245
    v_and_b32 v31, 0xffff0000, v245
    v_lshlrev_b32 v32, 16, v246
    v_and_b32 v33, 0xffff0000, v246
    v_lshlrev_b32 v34, 16, v247
    v_and_b32 v35, 0xffff0000, v247
    s_cmp_eq_u32 s53, 0
    s_waitcnt vmcnt(8)
    s_barrier
    s_cbranch_scc1 L_slow_10
    buffer_store_dword v70, v71, s[32:35], s52 offen offset:0
L_back_11:
    s_xor_b32 s5, s6, 0
    buffer_load_dwordx4 v[36:39], v1, s[32:35], s5 offen offset:0 sc1
    buffer_load_dwordx4 v[40:43], v1, s[32:35], s5 offen offset:1024 sc1
    ds_read_b64_tr_b16 v[120:121], v124 offset:12288
    ds_read_b64_tr_b16 v[122:123], v124 offset:12544
    ds_read_b64_tr_b16 v[116:117], v10 offset:12288
    ds_read_b64_tr_b16 v[118:119], v10 offset:12544
    ds_read_b64_tr_b16 v[112:113], v126 offset:8192
    ds_read_b64_tr_b16 v[114:115], v126 offset:8448
    ds_read_b64_tr_b16 v[108:109], v125 offset:8192
    ds_read_b64_tr_b16 v[110:111], v125 offset:8448
    ds_read_b64_tr_b16 v[104:105], v124 offset:8192
    ds_read_b64_tr_b16 v[106:107], v124 offset:8448
    ds_read_b64_tr_b16 v[100:101], v10 offset:8192
    ds_read_b64_tr_b16 v[102:103], v10 offset:8448
    ds_read_b64_tr_b16 v[96:97], v126 offset:4096
    ds_read_b64_tr_b16 v[98:99], v126 offset:4352
    ds_read_b64_tr_b16 v[92:93], v125 offset:4096
    ds_read_b64_tr_b16 v[94:95], v125 offset:4352
    ds_read_b64_tr_b16 v[88:89], v124 offset:4096
    ds_read_b64_tr_b16 v[90:91], v124 offset:4352
    ds_read_b64_tr_b16 v[84:85], v10 offset:4096
    ds_read_b64_tr_b16 v[86:87], v10 offset:4352
    ds_read_b64_tr_b16 v[80:81], v126 offset:0
    ds_read_b64_tr_b16 v[82:83], v126 offset:256
    ds_read_b64_tr_b16 v[76:77], v125 offset:0
    ds_read_b64_tr_b16 v[78:79], v125 offset:256
    ds_read_b64_tr_b16 v[72:73], v124 offset:0
    ds_read_b64_tr_b16 v[74:75], v124 offset:256
    buffer_load_dword v127, v8, s[32:35], s51 offen offset:0 sc1
    ds_read_b64_tr_b16 v[68:69], v10 offset:0
    ds_read_b64_tr_b16 v[70:71], v10 offset:256
    ds_read_b64_tr_b16 v[128:129], v253 offset:0
    ds_read_b64_tr_b16 v[130:131], v253 offset:512
    ds_read_b64_tr_b16 v[132:133], v253 offset:4096
    ds_read_b64_tr_b16 v[134:135], v253 offset:4608
    ds_read_b64_tr_b16 v[136:137], v253 offset:8192
    ds_read_b64_tr_b16 v[138:139], v253 offset:8704
    ds_read_b64_tr_b16 v[140:141], v253 offset:12288
    ds_read_b64_tr_b16 v[142:143], v253 offset:12800
    ds_read_b64_tr_b16 v[144:145], v13 offset:0
    ds_read_b64_tr_b16 v[146:147], v13 offset:512
    ds_read_b64_tr_b16 v[148:149], v13 offset:4096
    ds_read_b64_tr_b16 v[150:151], v13 offset:4608
    ds_read_b64_tr_b16 v[152:153], v13 offset:8192
    ds_read_b64_tr_b16 v[154:155], v13 offset:8704
    ds_read_b64_tr_b16 v[156:157], v13 offset:12288
    ds_read_b64_tr_b16 v[158:159], v13 offset:12800
    ds_read_b64_tr_b16 v[160:161], v13 offset:16384
    ds_read_b64_tr_b16 v[162:163], v13 offset:16896
    ds_read_b64_tr_b16 v[164:165], v13 offset:20480
    ds_read_b64_tr_b16 v[166:167], v13 offset:20992
    ds_read_b64_tr_b16 v[168:169], v13 offset:24576
    ds_read_b64_tr_b16 v[170:171], v13 offset:25088
    ds_read_b64_tr_b16 v[172:173], v13 offset:28672
    ds_read_b64_tr_b16 v[174:175], v13 offset:29184
    buffer_load_dword v17, v8, s[32:35], s51 offen offset:0 sc1
L_mp_12:
    s_waitcnt vmcnt(1)
    v_cmp_ne_u32 vcc, s39, v127
    s_cbranch_vccz L_md_13
    buffer_load_dword v127, v8, s[32:35], s51 offen offset:0 sc1
    s_waitcnt vmcnt(1)
    v_cmp_ne_u32 vcc, s39, v17
    s_cbranch_vccz L_md_14
    buffer_load_dword v17, v8, s[32:35], s51 offen offset:0 sc1
    s_add_u32 s43, s43, 1
    s_cmp_lt_u32 s43, 0x20000
    s_cbranch_scc1 L_mp_12
    s_endpgm
L_md_13:
L_md_14:
    s_xor_b32 s5, s6, 2048
    buffer_load_dwordx4 v[44:47], v1, s[32:35], s5 offen offset:0 sc1
    buffer_load_dwordx4 v[48:51], v1, s[32:35], s5 offen offset:1024 sc1
    s_barrier
    s_xor_b32 s5, s6, 4096
    buffer_load_dwordx4 v[52:55], v1, s[32:35], s5 offen offset:0 sc1
    buffer_load_dwordx4 v[56:59], v1, s[32:35], s5 offen offset:1024 sc1
    s_barrier
    s_xor_b32 s5, s6, 6144
    buffer_load_dwordx4 v[60:63], v1, s[32:35], s5 offen offset:0 sc1
    buffer_load_dwordx4 v[64:67], v1, s[32:35], s5 offen offset:1024 sc1
    ds_read_b64_tr_b16 v[176:177], v13 offset:32768
    ds_read_b64_tr_b16 v[178:179], v13 offset:33280
    ds_read_b64_tr_b16 v[180:181], v13 offset:36864
    ds_read_b64_tr_b16 v[182:183], v13 offset:37376
    ds_read_b64_tr_b16 v[184:185], v13 offset:40960
    ds_read_b64_tr_b16 v[186:187], v13 offset:41472
    ds_read_b64_tr_b16 v[188:189], v13 offset:45056
    ds_read_b64_tr_b16 v[190:191], v13 offset:45568
    ds_read_b64_tr_b16 v[192:193], v13 offset:49152
    ds_read_b64_tr_b16 v[194:195], v13 offset:49664
    ds_read_b64_tr_b16 v[196:197], v13 offset:53248
    ds_read_b64_tr_b16 v[198:199], v13 offset:53760
    ds_read_b64_tr_b16 v[200:201], v13 offset:57344
    ds_read_b64_tr_b16 v[202:203], v13 offset:57856
    ds_read_b64_tr_b16 v[204:205], v13 offset:61440
    ds_read_b64_tr_b16 v[206:207], v13 offset:61952
    s_waitcnt lgkmcnt(14)
    v_mfma_f32_16x16x32_bf16 v[20:23], v[68:71], v[36:39], v[20:23]
    ds_read_b64_tr_b16 v[68:69], v125 offset:12288
    ds_read_b64_tr_b16 v[70:71], v125 offset:12544
    v_mfma_f32_16x16x32_bf16 v[24:27], v[72:75], v[36:39], v[24:27]
    ds_read_b64_tr_b16 v[72:73], v126 offset:12288
    ds_read_b64_tr_b16 v[74:75], v126 offset:12544
    v_mfma_f32_16x16x32_bf16 v[28:31], v[76:79], v[36:39], v[28:31]
    ds_read_b64_tr_b16 v[76:77], v10 offset:16384
    ds_read_b64_tr_b16 v[78:79], v10 offset:16640
    v_mfma_f32_16x16x32_bf16 v[32:35], v[80:83], v[36:39], v[32:35]
    ds_read_b64_tr_b16 v[80:81], v124 offset:16384
    ds_read_b64_tr_b16 v[82:83], v124 offset:16640
    s_xor_b32 s5, s6, 8192
    buffer_load_dwordx4 v[36:39], v1, s[32:35], s5 offen offset:0 sc1
    v_mfma_f32_16x16x32_bf16 v[20:23], v[84:87], v[40:43], v[20:23]
    ds_read_b64_tr_b16 v[84:85], v125 offset:16384
    ds_read_b64_tr_b16 v[86:87], v125 offset:16640
    v_mfma_f32_16x16x32_bf16 v[24:27], v[88:91], v[40:43], v[24:27]
    ds_read_b64_tr_b16 v[88:89], v126 offset:16384
    ds_read_b64_tr_b16 v[90:91], v126 offset:16640
    v_mfma_f32_16x16x32_bf16 v[28:31], v[92:95], v[40:43], v[28:31]
    ds_read_b64_tr_b16 v[92:93], v10 offset:20480
    ds_read_b64_tr_b16 v[94:95], v10 offset:20736
    v_mfma_f32_16x16x32_bf16 v[32:35], v[96:99], v[40:43], v[32:35]
    ds_read_b64_tr_b16 v[96:97], v124 offset:20480
    ds_read_b64_tr_b16 v[98:99], v124 offset:20736
    buffer_load_dwordx4 v[40:43], v1, s[32:35], s5 offen offset:1024 sc1
    s_waitcnt vmcnt(7)
    v_mfma_f32_16x16x32_bf16 v[20:23], v[100:103], v[44:47], v[20:23]
    ds_read_b64_tr_b16 v[100:101], v125 offset:20480
    ds_read_b64_tr_b16 v[102:103], v125 offset:20736
    v_mfma_f32_16x16x32_bf16 v[24:27], v[104:107], v[44:47], v[24:27]
    ds_read_b64_tr_b16 v[104:105], v126 offset:20480
    ds_read_b64_tr_b16 v[106:107], v126 offset:20736
    v_mfma_f32_16x16x32_bf16 v[28:31], v[108:111], v[44:47], v[28:31]
    ds_read_b64_tr_b16 v[108:109], v10 offset:24576
    ds_read_b64_tr_b16 v[110:111], v10 offset:24832
    v_mfma_f32_16x16x32_bf16 v[32:35], v[112:115], v[44:47], v[32:35]
    ds_read_b64_tr_b16 v[112:113], v124 offset:24576
    ds_read_b64_tr_b16 v[114:115], v124 offset:24832
    s_xor_b32 s5, s6, 10240
    buffer_load_dwordx4 v[44:47], v1, s[32:35], s5 offen offset:0 sc1
    s_waitcnt vmcnt(7) lgkmcnt(14)
    v_mfma_f32_16x16x32_bf16 v[20:23], v[116:119], v[48:51], v[20:23]
    ds_read_b64_tr_b16 v[116:117], v125 offset:24576
    ds_read_b64_tr_b16 v[118:119], v125 offset:24832
    v_mfma_f32_16x16x32_bf16 v[24:27], v[120:123], v[48:51], v[24:27]
    ds_read_b64_tr_b16 v[120:121], v126 offset:24576
    ds_read_b64_tr_b16 v[122:123], v126 offset:24832
    v_mfma_f32_16x16x32_bf16 v[28:31], v[68:71], v[48:51], v[28:31]
    ds_read_b64_tr_b16 v[68:69], v10 offset:28672
    ds_read_b64_tr_b16 v[70:71], v10 offset:28928
    v_mfma_f32_16x16x32_bf16 v[32:35], v[72:75], v[48:51], v[32:35]
    ds_read_b64_tr_b16 v[72:73], v124 offset:28672
    ds_read_b64_tr_b16 v[74:75], v124 offset:28928
    buffer_load_dwordx4 v[48:51], v1, s[32:35], s5 offen offset:1024 sc1
    s_waitcnt vmcnt(7) lgkmcnt(14)
    v_mfma_f32_16x16x32_bf16 v[20:23], v[76:79], v[52:55], v[20:23]
    ds_read_b64_tr_b16 v[76:77], v125 offset:28672
    ds_read_b64_tr_b16 v[78:79], v125 offset:28928
    v_mfma_f32_16x16x32_bf16 v[24:27], v[80:83], v[52:55], v[24:27]
    ds_read_b64_tr_b16 v[80:81], v126 offset:28672
    ds_read_b64_tr_b16 v[82:83], v126 offset:28928
    v_mfma_f32_16x16x32_bf16 v[28:31], v[84:87], v[52:55], v[28:31]
    ds_read_b64_tr_b16 v[84:85], v10 offset:32768
    ds_read_b64_tr_b16 v[86:87], v10 offset:33024
    v_mfma_f32_16x16x32_bf16 v[32:35], v[88:91], v[52:55], v[32:35]
    ds_read_b64_tr_b16 v[88:89], v124 offset:32768
    ds_read_b64_tr_b16 v[90:91], v124 offset:33024
    s_xor_b32 s5, s6, 12288
    buffer_load_dwordx4 v[52:55], v1, s[32:35], s5 offen offset:0 sc1
    s_barrier
    s_waitcnt vmcnt(7) lgkmcnt(14)
    v_mfma_f32_16x16x32_bf16 v[20:23], v[92:95], v[56:59], v[20:23]
    ds_read_b64_tr_b16 v[92:93], v125 offset:32768
    ds_read_b64_tr_b16 v[94:95], v125 offset:33024
    v_mfma_f32_16x16x32_bf16 v[24:27], v[96:99], v[56:59], v[24:27]
    ds_read_b64_tr_b16 v[96:97], v126 offset:32768
    ds_read_b64_tr_b16 v[98:99], v126 offset:33024
    v_mfma_f32_16x16x32_bf16 v[28:31], v[100:103], v[56:59], v[28:31]
    ds_read_b64_tr_b16 v[100:101], v10 offset:36864
    ds_read_b64_tr_b16 v[102:103], v10 offset:37120
    v_mfma_f32_16x16x32_bf16 v[32:35], v[104:107], v[56:59], v[32:35]
    ds_read_b64_tr_b16 v[104:105], v124 offset:36864
    ds_read_b64_tr_b16 v[106:107], v124 offset:37120
    buffer_load_dwordx4 v[56:59], v1, s[32:35], s5 offen offset:1024 sc1
    s_waitcnt vmcnt(7) lgkmcnt(14)
    v_mfma_f32_16x16x32_bf16 v[20:23], v[108:111], v[60:63], v[20:23]
    ds_read_b64_tr_b16 v[108:109], v125 offset:36864
    ds_read_b64_tr_b16 v[110:111], v125 offset:37120
    s_add_u32 m0, s46, 65792
    s_add_u32 s7, s45, 395264
    v_mfma_f32_16x16x32_bf16 v[24:27], v[112:115], v[60:63], v[24:27]
    buffer_load_dwordx4 v254, s[20:23], s7 offen lds
    ds_read_b64_tr_b16 v[112:113], v126 offset:36864
    ds_read_b64_tr_b16 v[114:115], v126 offset:37120
    v_mfma_f32_16x16x32_bf16 v[28:31], v[116:119], v[60:63], v[28:31]
    ds_read_b64_tr_b16 v[116:117], v10 offset:40960
    ds_read_b64_tr_b16 v[118:119], v10 offset:41216
    v_mfma_f32_16x16x32_bf16 v[32:35], v[120:123], v[60:63], v[32:35]
    ds_read_b64_tr_b16 v[120:121], v124 offset:40960
    ds_read_b64_tr_b16 v[122:123], v124 offset:41216
    s_xor_b32 s5, s6, 14336
    buffer_load_dwordx4 v[60:63], v1, s[32:35], s5 offen offset:0 sc1
    s_waitcnt vmcnt(8) lgkmcnt(14)
    v_mfma_f32_16x16x32_bf16 v[20:23], v[68:71], v[64:67], v[20:23]
    ds_read_b64_tr_b16 v[68:69], v125 offset:40960
    ds_read_b64_tr_b16 v[70:71], v125 offset:41216
    s_add_u32 m0, s46, 66816
    v_mfma_f32_16x16x32_bf16 v[24:27], v[72:75], v[64:67], v[24:27]
    buffer_load_dwordx4 v255, s[20:23], s7 offen lds
    ds_read_b64_tr_b16 v[72:73], v126 offset:40960
    ds_read_b64_tr_b16 v[74:75], v126 offset:41216
    v_mfma_f32_16x16x32_bf16 v[28:31], v[76:79], v[64:67], v[28:31]
    ds_read_b64_tr_b16 v[76:77], v10 offset:45056
    ds_read_b64_tr_b16 v[78:79], v10 offset:45312
    v_mfma_f32_16x16x32_bf16 v[32:35], v[80:83], v[64:67], v[32:35]
    ds_read_b64_tr_b16 v[80:81], v124 offset:45056
    ds_read_b64_tr_b16 v[82:83], v124 offset:45312
    buffer_load_dwordx4 v[64:67], v1, s[32:35], s5 offen offset:1024 sc1
    s_waitcnt vmcnt(9) lgkmcnt(14)
    v_mfma_f32_16x16x32_bf16 v[20:23], v[84:87], v[36:39], v[20:23]
    ds_read_b64_tr_b16 v[84:85], v125 offset:45056
    ds_read_b64_tr_b16 v[86:87], v125 offset:45312
    s_add_u32 m0, s46, 67840
    s_add_u32 s7, s45, 444416
    v_mfma_f32_16x16x32_bf16 v[24:27], v[88:91], v[36:39], v[24:27]
    buffer_load_dwordx4 v254, s[20:23], s7 offen lds
L_pad2:
    s_cbranch_execz L_warm0
    ds_read_b64_tr_b16 v[88:89], v126 offset:45056
    ds_read_b64_tr_b16 v[90:91], v126 offset:45312
    v_mfma_f32_16x16x32_bf16 v[28:31], v[92:95], v[36:39], v[28:31]
    ds_read_b64_tr_b16 v[92:93], v10 offset:49152
    ds_read_b64_tr_b16 v[94:95], v10 offset:49408
    v_mfma_f32_16x16x32_bf16 v[32:35], v[96:99], v[36:39], v[32:35]
    ds_read_b64_tr_b16 v[96:97], v124 offset:49152
    ds_read_b64_tr_b16 v[98:99], v124 offset:49408
    s_waitcnt vmcnt(9) lgkmcnt(14)
    v_mfma_f32_16x16x32_bf16 v[20:23], v[100:103], v[40:43], v[20:23]
    ds_read_b64_tr_b16 v[100:101], v10 offset:53248
    ds_read_b64_tr_b16 v[102:103], v10 offset:53504
    s_add_u32 m0, s46, 68864
    v_mfma_f32_16x16x32_bf16 v[24:27], v[104:107], v[40:43], v[24:27]
    buffer_load_dwordx4 v255, s[20:23], s7 offen lds
    ds_read_b64_tr_b16 v[104:105], v124 offset:53248
    ds_read_b64_tr_b16 v[106:107], v124 offset:53504
    v_mfma_f32_16x16x32_bf16 v[28:31], v[108:111], v[40:43], v[28:31]
    ds_read_b64_tr_b16 v[108:109], v10 offset:57344
    ds_read_b64_tr_b16 v[110:111], v10 offset:57600
    v_mfma_f32_16x16x32_bf16 v[32:35], v[112:115], v[40:43], v[32:35]
    ds_read_b64_tr_b16 v[112:113], v124 offset:57344
    ds_read_b64_tr_b16 v[114:115], v124 offset:57600
    s_waitcnt vmcnt(9) lgkmcnt(14)
    v_mfma_f32_16x16x32_bf16 v[20:23], v[116:119], v[44:47], v[20:23]
    ds_read_b64_tr_b16 v[116:117], v10 offset:61440
    ds_read_b64_tr_b16 v[118:119], v10 offset:61696
    s_add_u32 m0, s46, 82176
    s_add_u32 s7, s45, 788480
    v_mfma_f32_16x16x32_bf16 v[24:27], v[120:123], v[44:47], v[24:27]
    buffer_load_dwordx4 v254, s[20:23], s7 offen lds
    ds_read_b64_tr_b16 v[120:121], v124 offset:61440
    ds_read_b64_tr_b16 v[122:123], v124 offset:61696
    v_mfma_f32_16x16x32_bf16 v[28:31], v[68:71], v[44:47], v[28:31]
    ds_read_b64_tr_b16 v[68:69], v125 offset:49152
    ds_read_b64_tr_b16 v[70:71], v125 offset:49408
    v_mfma_f32_16x16x32_bf16 v[32:35], v[72:75], v[44:47], v[32:35]
    ds_read_b64_tr_b16 v[72:73], v126 offset:49152
    ds_read_b64_tr_b16 v[74:75], v126 offset:49408
    s_waitcnt vmcnt(9) lgkmcnt(14)
    v_mfma_f32_16x16x32_bf16 v[20:23], v[76:79], v[48:51], v[20:23]
    ds_read_b64_tr_b16 v[76:77], v125 offset:53248
    ds_read_b64_tr_b16 v[78:79], v125 offset:53504
    s_add_u32 m0, s46, 83200
    v_mfma_f32_16x16x32_bf16 v[24:27], v[80:83], v[48:51], v[24:27]
    buffer_load_dwordx4 v255, s[20:23], s7 offen lds
    ds_read_b64_tr_b16 v[80:81], v126 offset:53248
    ds_read_b64_tr_b16 v[82:83], v126 offset:53504
    v_mfma_f32_16x16x32_bf16 v[28:31], v[84:87], v[48:51], v[28:31]
    ds_read_b64_tr_b16 v[84:85], v125 offset:57344
    ds_read_b64_tr_b16 v[86:87], v125 offset:57600
    v_mfma_f32_16x16x32_bf16 v[32:35], v[88:91], v[48:51], v[32:35]
    ds_read_b64_tr_b16 v[88:89], v126 offset:57344
    ds_read_b64_tr_b16 v[90:91], v126 offset:57600
    s_waitcnt vmcnt(8) lgkmcnt(14)
    v_mfma_f32_16x16x32_bf16 v[20:23], v[92:95], v[52:55], v[20:23]
    ds_read_b64_tr_b16 v[92:93], v125 offset:61440
    ds_read_b64_tr_b16 v[94:95], v125 offset:61696
    s_add_u32 m0, s46, 84224
    s_add_u32 s7, s45, 837632
    v_mfma_f32_16x16x32_bf16 v[24:27], v[96:99], v[52:55], v[24:27]
    buffer_load_dwordx4 v254, s[20:23], s7 offen lds
    ds_read_b64_tr_b16 v[96:97], v126 offset:61440
    ds_read_b64_tr_b16 v[98:99], v126 offset:61696
    v_mfma_f32_16x16x32_bf16 v[20:23], v[100:103], v[56:59], v[20:23]
    s_add_u32 s4, s49, 4194304
    v_mfma_f32_16x16x32_bf16 v[24:27], v[104:107], v[56:59], v[24:27]
    s_waitcnt vmcnt(5) lgkmcnt(14)
    v_mfma_f32_16x16x32_bf16 v[20:23], v[108:111], v[60:63], v[20:23]
    s_add_u32 m0, s46, 85248
    v_mfma_f32_16x16x32_bf16 v[24:27], v[112:115], v[60:63], v[24:27]
    buffer_load_dwordx4 v255, s[20:23], s7 offen lds
    v_mfma_f32_16x16x32_bf16 v[20:23], v[116:119], v[64:67], v[20:23]
    v_mfma_f32_16x16x32_bf16 v[24:27], v[120:123], v[64:67], v[24:27]
    s_waitcnt lgkmcnt(8)
    v_mfma_f32_16x16x32_bf16 v[28:31], v[68:71], v[52:55], v[28:31]
    v_mfma_f32_16x16x32_bf16 v[32:35], v[72:75], v[52:55], v[32:35]
    v_mfma_f32_16x16x32_bf16 v[28:31], v[76:79], v[56:59], v[28:31]
    s_nop 2
    v_cvt_pk_bf16_f32 v36, v20, v21
    v_cvt_pk_bf16_f32 v37, v22, v23
    v_mfma_f32_16x16x32_bf16 v[32:35], v[80:83], v[56:59], v[32:35]
    v_cvt_pk_bf16_f32 v38, v24, v25
    v_cvt_pk_bf16_f32 v39, v26, v27
    s_waitcnt lgkmcnt(0)
    v_mfma_f32_16x16x32_bf16 v[28:31], v[84:87], v[60:63], v[28:31]
    s_cmp_eq_u32 s53, 0
    v_permlane16_swap_b32 v36, v38
    v_mfma_f32_16x16x32_bf16 v[32:35], v[88:91], v[60:63], v[32:35]
    v_permlane16_swap_b32 v37, v39
    buffer_store_dwordx4 v[36:39], v11, s[32:35], s4 offen offset:0 sc1
    v_mfma_f32_16x16x32_bf16 v[28:31], v[92:95], v[64:67], v[28:31]
    v_mfma_f32_16x16x32_bf16 v[32:35], v[96:99], v[64:67], v[32:35]
    v_dot2_f32_bf16 v44, v36, v16, 0
    v_dot2_f32_bf16 v45, v36, v36, 0
    v_dot2_f32_bf16 v44, v37, v16, v44
    v_dot2_f32_bf16 v45, v37, v37, v45
    v_dot2_f32_bf16 v44, v38, v16, v44
    v_dot2_f32_bf16 v45, v38, v38, v45
    v_dot2_f32_bf16 v44, v39, v16, v44
    v_cvt_pk_bf16_f32 v40, v28, v29
    v_cvt_pk_bf16_f32 v41, v30, v31
    v_cvt_pk_bf16_f32 v42, v32, v33
    v_cvt_pk_bf16_f32 v43, v34, v35
    s_cmp_eq_u32 s53, 0
    v_permlane16_swap_b32 v40, v42
    v_permlane16_swap_b32 v41, v43
    buffer_store_dwordx4 v[40:43], v11, s[32:35], s4 offen offset:1024 sc1
    v_dot2_f32_bf16 v45, v39, v39, v45
    v_dot2_f32_bf16 v44, v40, v16, v44
    v_dot2_f32_bf16 v45, v40, v40, v45
    v_dot2_f32_bf16 v44, v41, v16, v44
    v_dot2_f32_bf16 v45, v41, v41, v45
    v_dot2_f32_bf16 v44, v42, v16, v44
    v_dot2_f32_bf16 v45, v42, v42, v45
    v_dot2_f32_bf16 v44, v43, v16, v44
    v_dot2_f32_bf16 v45, v43, v43, v45
    v_mov_b32 v46, s0
    v_mov_b32 v47, s0
    v_add_u32 v2, 65792, v1
    v_permlane32_swap_b32 v44, v45
    v_add_f32 v44, v44, v45
    v_mov_b32 v45, v44
    s_nop 1
    v_permlane16_swap_b32 v44, v45
    v_add_f32 v44, v44, v45
    v_mov_b32 v45, v44
    s_nop 1
    v_permlane32_swap_b32 v44, v45
    s_add_u32 m0, s46, 131328
    s_add_u32 s7, s45, 1181696
    buffer_load_dwordx4 v254, s[20:23], s7 offen lds
    s_add_u32 m0, s46, 132352
    s_nop 0
    buffer_load_dwordx4 v255, s[20:23], s7 offen lds
    s_add_u32 m0, s46, 133376
    s_add_u32 s7, s45, 1230848
    buffer_load_dwordx4 v254, s[20:23], s7 offen lds
    s_add_u32 m0, s46, 134400
    s_nop 0
    buffer_load_dwordx4 v255, s[20:23], s7 offen lds
    v_and_b32 v76, 3, v0
    v_subrev_u32 v76, 1, v76
    v_ashrrev_i32 v76, 31, v76
    v_and_b32 v79, 0x3f803f80, v76
    v_and_b32 v78, 0x3f803f80, v76
    v_and_b32 v77, 0x3f803f80, v76
    v_and_b32 v76, 0x3f803f80, v76
    s_nop 1
    v_mfma_f32_16x16x32_bf16 v[88:91], v[76:79], v[128:131], 0
    ds_write_b128 v14, v[36:39]
    ds_write_b128 v14, v[40:43] offset:1024
    v_mfma_f32_16x16x32_bf16 v[88:91], v[76:79], v[132:135], v[88:91]
    s_lshl_b32 s6, s38, 11
    s_add_u32 s4, s41, 4194304
    v_mfma_f32_16x16x32_bf16 v[88:91], v[76:79], v[136:139], v[88:91]
    s_add_u32 s3, s4, s6
    s_add_u32 m0, s6, 65792
    v_mfma_f32_16x16x32_bf16 v[88:91], v[76:79], v[140:143], v[88:91]
    s_add_u32 s4, s4, s46
    s_add_u32 s5, s46, 65792
    v_mfma_f32_16x16x32_bf16 v[88:91], v[76:79], v[144:147], v[88:91]
    s_and_b32 s6, s1, 0xfffff800
    v_lshlrev_b32 v119, 6, s38
    v_mfma_f32_16x16x32_bf16 v[88:91], v[76:79], v[148:151], v[88:91]
    v_add_u32 v119, v119, v4
    v_accvgpr_read_b32 v124, a199
    v_mfma_f32_16x16x32_bf16 v[88:91], v[76:79], v[152:155], v[88:91]
    v_accvgpr_read_b32 v125, a200
    v_accvgpr_read_b32 v126, a201
    v_mfma_f32_16x16x32_bf16 v[88:91], v[76:79], v[156:159], v[88:91]
    v_accvgpr_read_b32 v123, a202
    v_mfma_f32_16x16x32_bf16 v[88:91], v[76:79], v[160:163], v[88:91]
    v_mfma_f32_16x16x32_bf16 v[88:91], v[76:79], v[164:167], v[88:91]
    v_mfma_f32_16x16x32_bf16 v[88:91], v[76:79], v[168:171], v[88:91]
    v_mfma_f32_16x16x32_bf16 v[88:91], v[76:79], v[172:175], v[88:91]
    v_mfma_f32_16x16x32_bf16 v[88:91], v[76:79], v[176:179], v[88:91]
    v_mfma_f32_16x16x32_bf16 v[88:91], v[76:79], v[180:183], v[88:91]
    v_mfma_f32_16x16x32_bf16 v[88:91], v[76:79], v[184:187], v[88:91]
    v_mfma_f32_16x16x32_bf16 v[88:91], v[76:79], v[188:191], v[88:91]
    v_mfma_f32_16x16x32_bf16 v[92:95], v[76:79], v[192:195], 0
    v_mfma_f32_16x16x32_bf16 v[92:95], v[76:79], v[196:199], v[92:95]
    v_mfma_f32_16x16x32_bf16 v[92:95], v[76:79], v[200:203], v[92:95]
    v_mfma_f32_16x16x32_bf16 v[92:95], v[76:79], v[204:207], v[92:95]
    s_cmp_eq_u32 s53, 0
    s_waitcnt vmcnt(4)
    s_cbranch_scc1 L_slow_15
    buffer_store_dwordx4 v[44:47], v18, s[32:35], s1 offen
L_back_16:
    s_barrier
    ds_write_b32 v6, v88 offset:832
    ds_read_b64_tr_b16 v[208:209], v13 offset:0
    ds_read_b64_tr_b16 v[210:211], v13 offset:512
    ds_read_b64_tr_b16 v[212:213], v13 offset:4096
    ds_read_b64_tr_b16 v[214:215], v13 offset:4608
    ds_read_b64_tr_b16 v[216:217], v13 offset:8192
    ds_read_b64_tr_b16 v[218:219], v13 offset:8704
    ds_read_b64_tr_b16 v[220:221], v13 offset:12288
    ds_read_b64_tr_b16 v[222:223], v13 offset:12800
    ds_read_b64_tr_b16 v[224:225], v13 offset:16384
    ds_read_b64_tr_b16 v[226:227], v13 offset:16896
    ds_read_b64_tr_b16 v[228:229], v13 offset:20480
    ds_read_b64_tr_b16 v[230:231], v13 offset:20992
    ds_read_b64_tr_b16 v[232:233], v13 offset:24576
    ds_read_b64_tr_b16 v[234:235], v13 offset:25088
    ds_read_b64_tr_b16 v[236:237], v13 offset:28672
    ds_read_b64_tr_b16 v[238:239], v13 offset:29184
    s_waitcnt lgkmcnt(14)
    v_mfma_f32_16x16x32_bf16 v[92:95], v[76:79], v[208:211], v[92:95]
    v_accvgpr_read_b32 v13, a192
    v_accvgpr_read_b32 v14, a193
    s_waitcnt lgkmcnt(12)
    v_mfma_f32_16x16x32_bf16 v[92:95], v[76:79], v[212:215], v[92:95]
    v_accvgpr_read_b32 v15, a194
    v_accvgpr_read_b32 v16, a195
    s_waitcnt lgkmcnt(10)
    v_mfma_f32_16x16x32_bf16 v[92:95], v[76:79], v[216:219], v[92:95]
    s_waitcnt vmcnt(0)
    buffer_load_dwordx4 v[20:23], v1, s[32:35], s6 offen offset:0 sc1
    buffer_load_dwordx4 v[24:27], v1, s[32:35], s6 offen offset:1024 sc1
    v_accvgpr_read_b32 v17, a196
    v_accvgpr_read_b32 v18, a197
    s_waitcnt lgkmcnt(8)
    v_mfma_f32_16x16x32_bf16 v[92:95], v[76:79], v[220:223], v[92:95]
    v_accvgpr_read_b32 v19, a198
    s_waitcnt lgkmcnt(6)
    v_mfma_f32_16x16x32_bf16 v[92:95], v[76:79], v[224:227], v[92:95]
    s_waitcnt lgkmcnt(4)
    v_mfma_f32_16x16x32_bf16 v[92:95], v[76:79], v[228:231], v[92:95]
    s_waitcnt lgkmcnt(2)
    v_mfma_f32_16x16x32_bf16 v[92:95], v[76:79], v[232:235], v[92:95]
    s_waitcnt lgkmcnt(0)
    v_mfma_f32_16x16x32_bf16 v[92:95], v[76:79], v[236:239], v[92:95]
    s_branch L_xc_18
L_xp_17:
    buffer_load_dwordx4 v[20:23], v1, s[32:35], s6 offen offset:0 sc1
    buffer_load_dwordx4 v[24:27], v1, s[32:35], s6 offen offset:1024 sc1
    s_add_u32 s43, s43, 1
    s_cmp_ge_u32 s43, 0x20000
    s_cbranch_scc1 L_end
L_xc_18:
    s_waitcnt vmcnt(0)
    v_cmp_ne_u32 vcc, s0, v22
    v_cmp_ne_u32 s[96:97], s0, v26
    s_or_b64 exec, vcc, s[96:97]
    s_cbranch_scc1 L_xp_17
    s_mov_b64 exec, -1
    s_barrier
    v_add_f32 v112, v20, v24
    v_add_f32 v113, v21, v25
L_entry1:
    buffer_load_dwordx4 v1, s[32:35], s3 offen offset:0 sc1 lds
    buffer_load_dwordx4 v1, s[32:35], s3 offen offset:1024 sc1 lds
    s_add_u32 m0, m0, 8192
    s_add_u32 s3, s3, 8192
    v_permlane32_swap_b32 v112, v113
    v_add_f32 v112, v112, v113
    v_mov_b32 v113, v112
    s_barrier
    buffer_load_dwordx4 v1, s[32:35], s3 offen offset:0 sc1 lds
    buffer_load_dwordx4 v1, s[32:35], s3 offen offset:1024 sc1 lds
    s_add_u32 m0, s5, 16384
    s_add_u32 s3, s4, 16384
    v_permlane16_swap_b32 v112, v113
    v_add_f32 v112, v112, v113
    v_mov_b32 v113, v112
    s_barrier
    s_nop 0
    v_permlane32_swap_b32 v112, v113
    buffer_load_dwordx4 v1, s[32:35], s3 offen offset:0 sc1 lds
    v_mul_f32 v112, 0xbb000000, v112
    v_mul_f32 v113, 0x3b000000, v113
    v_fma_f32 v113, -v112, v112, v113
    buffer_load_dwordx4 v1, s[32:35], s3 offen offset:1024 sc1 lds
    v_max_f32 v113, 0, v113
    v_add_f32 v113, 0x3727c5ac, v113
    v_rsq_f32 v114, v113
    buffer_load_dwordx4 v1, s[32:35], s3 offen offset:2048 sc1 lds
    v_mul_f32 v112, v112, v114
    ds_write2st64_b32 v119, v114, v112 offset0:0 offset1:1
    ds_read_b64_tr_b16 v[240:241], v123 offset:0
    ds_read_b64_tr_b16 v[242:243], v123 offset:512
    ds_read_b64_tr_b16 v[244:245], v123 offset:4096
    ds_read_b64_tr_b16 v[246:247], v123 offset:4608
    ds_read_b64_tr_b16 v[248:249], v123 offset:8192
    ds_read_b64_tr_b16 v[250:251], v123 offset:8704
    ds_read_b64_tr_b16 v[252:253], v123 offset:12288
    ds_read_b64_tr_b16 v[254:255], v123 offset:12800
    s_waitcnt lgkmcnt(6)
    v_mfma_f32_16x16x32_bf16 v[92:95], v[76:79], v[240:243], v[92:95]
    s_waitcnt lgkmcnt(4)
    v_mfma_f32_16x16x32_bf16 v[92:95], v[76:79], v[244:247], v[92:95]
    s_waitcnt lgkmcnt(2)
    v_mfma_f32_16x16x32_bf16 v[92:95], v[76:79], v[248:251], v[92:95]
    s_waitcnt lgkmcnt(0)
    v_mfma_f32_16x16x32_bf16 v[92:95], v[76:79], v[252:255], v[92:95]
    s_waitcnt vmcnt(5)
    s_barrier
    ds_read_b128 v[36:39], v2 offset:0
    ds_read_b128 v[40:43], v2 offset:1024
    ds_read_b128 v[44:47], v2 offset:2048
    ds_read_b128 v[48:51], v2 offset:3072
    ds_read_b128 v[52:55], v2 offset:4096
    ds_read_b128 v[56:59], v2 offset:5120
    ds_read_b128 v[60:63], v2 offset:6144
    s_waitcnt lgkmcnt(6)
    v_mfma_f32_16x16x32_bf16 v[20:23], v[128:131], v[36:39], 0
    buffer_load_dwordx4 v1, s[32:35], s3 offen offset:3072 sc1 lds
    ds_write_b32 v6, v92 offset:896
    v_mfma_f32_16x16x32_bf16 v[24:27], v[36:39], v[192:195], 0
    ds_read_b128 v[64:67], v2 offset:7168
    ds_read_b128 v[104:107], v5 offset:832
    ds_read_b32 v108, v6 offset:896
    s_waitcnt lgkmcnt(9)
    v_mfma_f32_16x16x32_bf16 v[20:23], v[132:135], v[40:43], v[20:23]
    ds_read_b128 v[68:71], v3 offset:0
    ds_read_b128 v[72:75], v3 offset:256
    ds_read2_b32 v[110:111], v4 offset0:0 offset1:64
    v_mfma_f32_16x16x32_bf16 v[24:27], v[40:43], v[196:199], v[24:27]
    s_add_u32 m0, s5, 32768
    s_add_u32 s3, s4, 32768
    v_add_u32 v122, s59, v1
    s_waitcnt lgkmcnt(11)
    v_mfma_f32_16x16x32_bf16 v[20:23], v[136:139], v[44:47], v[20:23]
    buffer_load_dwordx4 v1, s[32:35], s3 offen offset:0 sc1 lds
    s_lshl_b32 s99, s36, 12
    v_mfma_f32_16x16x32_bf16 v[24:27], v[44:47], v[200:203], v[24:27]
    s_add_u32 s99, s99, s57
    s_add_u32 s98, s99, 0x20000
    s_waitcnt lgkmcnt(10)
    v_mfma_f32_16x16x32_bf16 v[20:23], v[140:143], v[48:51], v[20:23]
    v_lshrrev_b32 v100, 3, v0
    v_min_u32 v100, 1, v100
    v_mfma_f32_16x16x32_bf16 v[24:27], v[48:51], v[204:207], v[24:27]
    s_waitcnt vmcnt(5)
    s_barrier
    ds_read_b128 v[36:39], v2 offset:8192
    ds_read_b128 v[40:43], v2 offset:9216
    ds_read_b128 v[44:47], v2 offset:10240
    s_waitcnt lgkmcnt(8)
    v_mfma_f32_16x16x32_bf16 v[20:23], v[144:147], v[52:55], v[20:23]
    buffer_load_dwordx4 v1, s[32:35], s3 offen offset:1024 sc1 lds
    v_mfma_f32_16x16x32_bf16 v[24:27], v[52:55], v[208:211], v[24:27]
    ds_read_b128 v[48:51], v2 offset:11264
    v_lshl_add_u32 v100, v100, 26, v1
    v_mfma_f32_16x16x32_bf16 v[20:23], v[148:151], v[56:59], v[20:23]
    v_mov_b32 v96, s39
    v_mov_b32 v97, s39
    v_mfma_f32_16x16x32_bf16 v[24:27], v[56:59], v[212:215], v[24:27]
    ds_read_b128 v[52:55], v2 offset:12288
    v_mov_b32 v98, s39
    v_mfma_f32_16x16x32_bf16 v[20:23], v[152:155], v[60:63], v[20:23]
    buffer_load_dwordx4 v1, s[32:35], s3 offen offset:2048 sc1 lds
    v_mfma_f32_16x16x32_bf16 v[24:27], v[60:63], v[216:219], v[24:27]
    ds_read_b128 v[56:59], v2 offset:13312
    v_mov_b32 v99, s39
    v_mfma_f32_16x16x32_bf16 v[20:23], v[156:159], v[64:67], v[20:23]
    s_waitcnt lgkmcnt(6)
    v_mul_f32 v76, v111, v104
    v_mfma_f32_16x16x32_bf16 v[24:27], v[64:67], v[220:223], v[24:27]
    ds_read_b128 v[60:63], v2 offset:14336
    s_waitcnt lgkmcnt(3)
    v_mfma_f32_16x16x32_bf16 v[20:23], v[160:163], v[36:39], v[20:23]
    buffer_load_dwordx4 v1, s[32:35], s3 offen offset:3072 sc1 lds
    v_mfma_f32_16x16x32_bf16 v[24:27], v[36:39], v[224:227], v[24:27]
    ds_read_b128 v[64:67], v2 offset:15360
    v_mul_f32 v77, v111, v105
    v_mfma_f32_16x16x32_bf16 v[20:23], v[164:167], v[40:43], v[20:23]
    v_mul_f32 v78, v111, v106
    v_mul_f32 v79, v111, v107
    v_mfma_f32_16x16x32_bf16 v[24:27], v[40:43], v[228:231], v[24:27]
    s_add_u32 m0, s5, 49152
    s_add_u32 s3, s4, 49152
    v_mfma_f32_16x16x32_bf16 v[20:23], v[168:171], v[44:47], v[20:23]
    buffer_load_dwordx4 v1, s[32:35], s3 offen offset:0 sc1 lds
    v_mfma_f32_16x16x32_bf16 v[24:27], v[44:47], v[232:235], v[24:27]
    v_mul_f32 v72, v72, v108
    v_mul_f32 v73, v73, v108
    v_mfma_f32_16x16x32_bf16 v[20:23], v[172:175], v[48:51], v[20:23]
    v_mul_f32 v74, v74, v108
    v_mul_f32 v75, v75, v108
    v_mfma_f32_16x16x32_bf16 v[24:27], v[48:51], v[236:239], v[24:27]
    s_waitcnt vmcnt(5)
    s_barrier
    ds_read_b128 v[36:39], v2 offset:16384
    ds_read_b128 v[40:43], v2 offset:17408
    ds_read_b128 v[44:47], v2 offset:18432
    s_waitcnt lgkmcnt(3)
    v_mfma_f32_16x16x32_bf16 v[20:23], v[176:179], v[52:55], v[20:23]
    buffer_load_dwordx4 v1, s[32:35], s3 offen offset:1024 sc1 lds
    v_mfma_f32_16x16x32_bf16 v[24:27], v[52:55], v[240:243], v[24:27]
    ds_read_b128 v[48:51], v2 offset:19456
    v_mfma_f32_16x16x32_bf16 v[20:23], v[180:183], v[56:59], v[20:23]
    v_mfma_f32_16x16x32_bf16 v[24:27], v[56:59], v[244:247], v[24:27]
    ds_read_b128 v[52:55], v2 offset:20480
    v_mfma_f32_16x16x32_bf16 v[20:23], v[184:187], v[60:63], v[20:23]
    buffer_load_dwordx4 v1, s[32:35], s3 offen offset:2048 sc1 lds
    v_mfma_f32_16x16x32_bf16 v[24:27], v[60:63], v[248:251], v[24:27]
    ds_read_b128 v[56:59], v2 offset:21504
    v_mfma_f32_16x16x32_bf16 v[20:23], v[188:191], v[64:67], v[20:23]
    v_mfma_f32_16x16x32_bf16 v[24:27], v[64:67], v[252:255], v[24:27]
    ds_read_b128 v[60:63], v2 offset:22528
    s_waitcnt lgkmcnt(3)
    v_mfma_f32_16x16x32_bf16 v[28:31], v[128:131], v[36:39], 0
    buffer_load_dwordx4 v1, s[32:35], s3 offen offset:3072 sc1 lds
    v_mfma_f32_16x16x32_bf16 v[32:35], v[36:39], v[192:195], 0
    ds_read_b128 v[64:67], v2 offset:23552
    v_mfma_f32_16x16x32_bf16 v[28:31], v[132:135], v[40:43], v[28:31]
    v_fma_f32 v20, v20, v110, v76
    v_fma_f32 v21, v21, v110, v77
    v_fma_f32 v22, v22, v110, v78
    v_mfma_f32_16x16x32_bf16 v[32:35], v[40:43], v[196:199], v[32:35]
    s_add_u32 m0, s46, 0
    s_add_u32 s7, s45, 0
    ds_read_b128 v[36:39], v2 offset:24576
    v_mfma_f32_16x16x32_bf16 v[28:31], v[136:139], v[44:47], v[28:31]
    buffer_load_dwordx4 v124, s[20:23], s7 offen lds
    v_fma_f32 v23, v23, v110, v79
    v_mfma_f32_16x16x32_bf16 v[32:35], v[44:47], v[200:203], v[32:35]
    ds_read_b128 v[40:43], v2 offset:25600
    v_fma_f32 v24, v24, v68, v72
    v_fma_f32 v25, v25, v69, v73
    v_mfma_f32_16x16x32_bf16 v[28:31], v[140:143], v[48:51], v[28:31]
    v_fma_f32 v26, v26, v70, v74
    v_fma_f32 v27, v27, v71, v75
    v_cvt_pk_bf16_f32 v80, v20, v21
    v_mfma_f32_16x16x32_bf16 v[32:35], v[48:51], v[204:207], v[32:35]
    s_add_u32 m0, s46, 1024
    ds_read_b128 v[44:47], v2 offset:26624
    s_waitcnt lgkmcnt(3)
    v_mfma_f32_16x16x32_bf16 v[28:31], v[144:147], v[52:55], v[28:31]
    buffer_load_dwordx4 v125, s[20:23], s7 offen lds
    v_cvt_pk_bf16_f32 v81, v22, v23
    v_mfma_f32_16x16x32_bf16 v[32:35], v[52:55], v[208:211], v[32:35]
    ds_read_b128 v[48:51], v2 offset:27648
    v_cvt_pk_bf16_f32 v88, v24, v25
    v_cvt_pk_bf16_f32 v89, v26, v27
    v_mfma_f32_16x16x32_bf16 v[28:31], v[148:151], v[56:59], v[28:31]
    ds_read_b128 v[68:71], v3 offset:64
    ds_read_b128 v[72:75], v3 offset:320
    ds_read2_b32 v[110:111], v4 offset0:16 offset1:80
    v_mfma_f32_16x16x32_bf16 v[32:35], v[56:59], v[212:215], v[32:35]
    s_add_u32 m0, s46, 2048
    s_add_u32 s7, s45, 49152
    ds_read_b128 v[52:55], v2 offset:28672
    v_mfma_f32_16x16x32_bf16 v[28:31], v[152:155], v[60:63], v[28:31]
    buffer_load_dwordx4 v124, s[20:23], s7 offen lds
    v_mfma_f32_16x16x32_bf16 v[32:35], v[60:63], v[216:219], v[32:35]
    ds_read_b128 v[56:59], v2 offset:29696
    v_mfma_f32_16x16x32_bf16 v[28:31], v[156:159], v[64:67], v[28:31]
    v_mfma_f32_16x16x32_bf16 v[32:35], v[64:67], v[220:223], v[32:35]
    s_add_u32 m0, s46, 3072
    ds_read_b128 v[60:63], v2 offset:30720
    s_waitcnt lgkmcnt(6)
    v_mfma_f32_16x16x32_bf16 v[28:31], v[160:163], v[36:39], v[28:31]
    buffer_load_dwordx4 v125, s[20:23], s7 offen lds
    v_mfma_f32_16x16x32_bf16 v[32:35], v[36:39], v[224:227], v[32:35]
    ds_read_b128 v[64:67], v2 offset:31744
    v_mfma_f32_16x16x32_bf16 v[28:31], v[164:167], v[40:43], v[28:31]
    v_mfma_f32_16x16x32_bf16 v[32:35], v[40:43], v[228:231], v[32:35]
    s_add_u32 m0, s46, 16384
    s_add_u32 s7, s45, 393216
    s_waitcnt vmcnt(8)
    s_barrier
    ds_read_b128 v[36:39], v2 offset:32768
    v_mfma_f32_16x16x32_bf16 v[28:31], v[168:171], v[44:47], v[28:31]
    buffer_load_dwordx4 v124, s[20:23], s7 offen lds
    v_mfma_f32_16x16x32_bf16 v[32:35], v[44:47], v[232:235], v[32:35]
    ds_read_b128 v[40:43], v2 offset:33792
    s_waitcnt lgkmcnt(6)
    v_mul_f32 v76, v111, v104
    v_mfma_f32_16x16x32_bf16 v[28:31], v[172:175], v[48:51], v[28:31]
    v_mul_f32 v77, v111, v105
    v_mul_f32 v78, v111, v106
    v_mfma_f32_16x16x32_bf16 v[32:35], v[48:51], v[236:239], v[32:35]
    s_add_u32 m0, s46, 17408
    ds_read_b128 v[44:47], v2 offset:34816
    s_waitcnt lgkmcnt(3)
    v_mfma_f32_16x16x32_bf16 v[28:31], v[176:179], v[52:55], v[28:31]
    buffer_load_dwordx4 v125, s[20:23], s7 offen lds
    v_mfma_f32_16x16x32_bf16 v[32:35], v[52:55], v[240:243], v[32:35]
    ds_read_b128 v[48:51], v2 offset:35840
    v_mul_f32 v79, v111, v107
    v_mfma_f32_16x16x32_bf16 v[28:31], v[180:183], v[56:59], v[28:31]
    v_mul_f32 v72, v72, v108
    v_mul_f32 v73, v73, v108
    v_mfma_f32_16x16x32_bf16 v[32:35], v[56:59], v[244:247], v[32:35]
    s_add_u32 m0, s46, 18432
    s_add_u32 s7, s45, 442368
    ds_read_b128 v[52:55], v2 offset:36864
    v_mfma_f32_16x16x32_bf16 v[28:31], v[184:187], v[60:63], v[28:31]
    buffer_load_dwordx4 v124, s[20:23], s7 offen lds
    v_mfma_f32_16x16x32_bf16 v[32:35], v[60:63], v[248:251], v[32:35]
    ds_read_b128 v[56:59], v2 offset:37888
    v_mul_f32 v74, v74, v108
    v_mfma_f32_16x16x32_bf16 v[28:31], v[188:191], v[64:67], v[28:31]
    v_mul_f32 v75, v75, v108
    v_mfma_f32_16x16x32_bf16 v[32:35], v[64:67], v[252:255], v[32:35]
    ds_read_b128 v[60:63], v2 offset:38912
    s_add_u32 m0, s46, 19456
    s_waitcnt lgkmcnt(3)
    v_mfma_f32_16x16x32_bf16 v[20:23], v[128:131], v[36:39], 0
    buffer_load_dwordx4 v125, s[20:23], s7 offen lds
    v_mfma_f32_16x16x32_bf16 v[24:27], v[36:39], v[192:195], 0
    ds_read_b128 v[64:67], v2 offset:39936
    v_mfma_f32_16x16x32_bf16 v[20:23], v[132:135], v[40:43], v[20:23]
    v_fma_f32 v28, v28, v110, v76
    v_fma_f32 v29, v29, v110, v77
    v_fma_f32 v30, v30, v110, v78
    v_mfma_f32_16x16x32_bf16 v[24:27], v[40:43], v[196:199], v[24:27]
    s_add_u32 m0, s46, 32768
    s_add_u32 s7, s45, 786432
    ds_read_b128 v[36:39], v2 offset:40960
    v_mfma_f32_16x16x32_bf16 v[20:23], v[136:139], v[44:47], v[20:23]
    buffer_load_dwordx4 v124, s[20:23], s7 offen lds
    v_fma_f32 v31, v31, v110, v79
    v_mfma_f32_16x16x32_bf16 v[24:27], v[44:47], v[200:203], v[24:27]
    ds_read_b128 v[40:43], v2 offset:41984
    v_cvt_pk_bf16_f32 v82, v28, v29
    v_cvt_pk_bf16_f32 v83, v30, v31
    v_mfma_f32_16x16x32_bf16 v[20:23], v[140:143], v[48:51], v[20:23]
    v_fma_f32 v32, v32, v68, v72
    v_fma_f32 v33, v33, v69, v73
    v_permlane16_swap_b32 v80, v82
    v_mfma_f32_16x16x32_bf16 v[24:27], v[48:51], v[204:207], v[24:27]
    s_add_u32 m0, s46, 33792
    ds_read_b128 v[44:47], v2 offset:43008
    s_waitcnt lgkmcnt(3)
    v_mfma_f32_16x16x32_bf16 v[20:23], v[144:147], v[52:55], v[20:23]
    buffer_load_dwordx4 v125, s[20:23], s7 offen lds
    v_permlane16_swap_b32 v81, v83
    v_mfma_f32_16x16x32_bf16 v[24:27], v[52:55], v[208:211], v[24:27]
    ds_read_b128 v[48:51], v2 offset:44032
    buffer_store_dwordx4 v[80:83], v1, s[32:35], s56 offen offset:0 sc1
    v_mfma_f32_16x16x32_bf16 v[20:23], v[148:151], v[56:59], v[20:23]
    v_fma_f32 v34, v34, v70, v74
    v_fma_f32 v35, v35, v71, v75
    v_cvt_pk_bf16_f32 v90, v32, v33
    v_mfma_f32_16x16x32_bf16 v[24:27], v[56:59], v[212:215], v[24:27]
    s_add_u32 m0, s46, 34816
    s_add_u32 s7, s45, 835584
    ds_read_b128 v[52:55], v2 offset:45056
    v_mfma_f32_16x16x32_bf16 v[20:23], v[152:155], v[60:63], v[20:23]
    buffer_load_dwordx4 v124, s[20:23], s7 offen lds
    v_cvt_pk_bf16_f32 v91, v34, v35
    v_mfma_f32_16x16x32_bf16 v[24:27], v[60:63], v[216:219], v[24:27]
    ds_read_b128 v[56:59], v2 offset:46080
    ds_read_b128 v[68:71], v3 offset:128
    ds_read_b128 v[72:75], v3 offset:384
    v_mfma_f32_16x16x32_bf16 v[20:23], v[156:159], v[64:67], v[20:23]
    ds_read2_b32 v[110:111], v4 offset0:32 offset1:96
    v_permlane32_swap_b32 v88, v90
    v_permlane32_swap_b32 v89, v91
    v_mfma_f32_16x16x32_bf16 v[24:27], v[64:67], v[220:223], v[24:27]
    s_add_u32 m0, s46, 35840
    ds_read_b128 v[60:63], v2 offset:47104
    s_waitcnt lgkmcnt(6)
    v_mfma_f32_16x16x32_bf16 v[20:23], v[160:163], v[36:39], v[20:23]
    buffer_load_dwordx4 v125, s[20:23], s7 offen lds
    v_mfma_f32_16x16x32_bf16 v[24:27], v[36:39], v[224:227], v[24:27]
    ds_read_b128 v[64:67], v2 offset:48128
    buffer_store_dwordx4 v[88:91], v1, s[32:35], s56 offen offset:1024 sc1
    v_mfma_f32_16x16x32_bf16 v[20:23], v[164:167], v[40:43], v[20:23]
    s_waitcnt lgkmcnt(2)
    v_mul_f32 v76, v111, v104
    v_mul_f32 v77, v111, v105
    v_mfma_f32_16x16x32_bf16 v[24:27], v[40:43], v[228:231], v[24:27]
    s_add_u32 m0, s46, 49152
    s_add_u32 s7, s45, 1179648
    s_waitcnt vmcnt(14)
    s_barrier
    ds_read_b128 v[36:39], v2 offset:49152
    v_mfma_f32_16x16x32_bf16 v[20:23], v[168:171], v[44:47], v[20:23]
    buffer_load_dwordx4 v124, s[20:23], s7 offen lds
    v_mfma_f32_16x16x32_bf16 v[24:27], v[44:47], v[232:235], v[24:27]
    ds_read_b128 v[40:43], v2 offset:50176
    v_mul_f32 v78, v111, v106
    v_mfma_f32_16x16x32_bf16 v[20:23], v[172:175], v[48:51], v[20:23]
    v_mul_f32 v79, v111, v107
    v_mul_f32 v72, v72, v108
    v_mfma_f32_16x16x32_bf16 v[24:27], v[48:51], v[236:239], v[24:27]
    s_add_u32 m0, s46, 50176
    ds_read_b128 v[44:47], v2 offset:51200
    s_waitcnt lgkmcnt(3)
    v_mfma_f32_16x16x32_bf16 v[20:23], v[176:179], v[52:55], v[20:23]
L_pad3:
    s_cbranch_execz L_warm0
    buffer_load_dwordx4 v125, s[20:23], s7 offen lds
    v_mfma_f32_16x16x32_bf16 v[24:27], v[52:55], v[240:243], v[24:27]
    ds_read_b128 v[48:51], v2 offset:52224
    v_mul_f32 v73, v73, v108
    v_mfma_f32_16x16x32_bf16 v[20:23], v[180:183], v[56:59], v[20:23]
    v_mul_f32 v74, v74, v108
    v_mul_f32 v75, v75, v108
    v_mfma_f32_16x16x32_bf16 v[24:27], v[56:59], v[244:247], v[24:27]
    s_add_u32 m0, s46, 51200
    s_add_u32 s7, s45, 1228800
    ds_read_b128 v[52:55], v2 offset:53248
    v_mfma_f32_16x16x32_bf16 v[20:23], v[184:187], v[60:63], v[20:23]
    buffer_load_dwordx4 v124, s[20:23], s7 offen lds
    v_mfma_f32_16x16x32_bf16 v[24:27], v[60:63], v[248:251], v[24:27]
    ds_read_b128 v[56:59], v2 offset:54272
    v_mfma_f32_16x16x32_bf16 v[20:23], v[188:191], v[64:67], v[20:23]
    v_mfma_f32_16x16x32_bf16 v[24:27], v[64:67], v[252:255], v[24:27]
    ds_read_b128 v[60:63], v2 offset:55296
    s_add_u32 m0, s46, 52224
    s_waitcnt lgkmcnt(3)
    v_mfma_f32_16x16x32_bf16 v[28:31], v[128:131], v[36:39], 0
    buffer_load_dwordx4 v125, s[20:23], s7 offen lds
    v_mfma_f32_16x16x32_bf16 v[32:35], v[36:39], v[192:195], 0
    ds_read_b128 v[64:67], v2 offset:56320
    v_mfma_f32_16x16x32_bf16 v[28:31], v[132:135], v[40:43], v[28:31]
    v_fma_f32 v20, v20, v110, v76
    v_fma_f32 v21, v21, v110, v77
    v_mfma_f32_16x16x32_bf16 v[32:35], v[40:43], v[196:199], v[32:35]
    ds_read_b128 v[36:39], v2 offset:57344
    v_fma_f32 v22, v22, v110, v78
    v_mfma_f32_16x16x32_bf16 v[28:31], v[136:139], v[44:47], v[28:31]
    v_fma_f32 v23, v23, v110, v79
    v_fma_f32 v24, v24, v68, v72
    v_mfma_f32_16x16x32_bf16 v[32:35], v[44:47], v[200:203], v[32:35]
    ds_read_b128 v[40:43], v2 offset:58368
    v_fma_f32 v25, v25, v69, v73
    v_mfma_f32_16x16x32_bf16 v[28:31], v[140:143], v[48:51], v[28:31]
    v_fma_f32 v26, v26, v70, v74
    v_fma_f32 v27, v27, v71, v75
    v_mfma_f32_16x16x32_bf16 v[32:35], v[48:51], v[204:207], v[32:35]
    ds_read_b128 v[44:47], v2 offset:59392
    s_waitcnt lgkmcnt(3)
    v_mfma_f32_16x16x32_bf16 v[28:31], v[144:147], v[52:55], v[28:31]
    v_cvt_pk_bf16_f32 v84, v20, v21
    v_cvt_pk_bf16_f32 v85, v22, v23
    v_mfma_f32_16x16x32_bf16 v[32:35], v[52:55], v[208:211], v[32:35]
    ds_read_b128 v[48:51], v2 offset:60416
    v_cvt_pk_bf16_f32 v92, v24, v25
    v_mfma_f32_16x16x32_bf16 v[28:31], v[148:151], v[56:59], v[28:31]
    v_cvt_pk_bf16_f32 v93, v26, v27
    ds_read_b128 v[68:71], v3 offset:192
    v_mfma_f32_16x16x32_bf16 v[32:35], v[56:59], v[212:215], v[32:35]
    ds_read_b128 v[52:55], v2 offset:61440
    ds_read_b128 v[72:75], v3 offset:448
    v_mfma_f32_16x16x32_bf16 v[28:31], v[152:155], v[60:63], v[28:31]
    ds_read2_b32 v[110:111], v4 offset0:48 offset1:112
    ds_write_b128 v122, v[88:91] offset:1024
    v_mfma_f32_16x16x32_bf16 v[32:35], v[60:63], v[216:219], v[32:35]
    ds_read_b128 v[56:59], v2 offset:62464
    v_mfma_f32_16x16x32_bf16 v[28:31], v[156:159], v[64:67], v[28:31]
    v_mfma_f32_16x16x32_bf16 v[32:35], v[64:67], v[220:223], v[32:35]
    ds_read_b128 v[60:63], v2 offset:63488
    s_waitcnt lgkmcnt(7)
    v_mfma_f32_16x16x32_bf16 v[28:31], v[160:163], v[36:39], v[28:31]
    v_mfma_f32_16x16x32_bf16 v[32:35], v[36:39], v[224:227], v[32:35]
    ds_read_b128 v[64:67], v2 offset:64512
    v_mfma_f32_16x16x32_bf16 v[28:31], v[164:167], v[40:43], v[28:31]
    v_mfma_f32_16x16x32_bf16 v[32:35], v[40:43], v[228:231], v[32:35]
    v_mfma_f32_16x16x32_bf16 v[28:31], v[168:171], v[44:47], v[28:31]
    v_mfma_f32_16x16x32_bf16 v[32:35], v[44:47], v[232:235], v[32:35]
    s_waitcnt lgkmcnt(4)
    v_mul_f32 v76, v111, v104
    v_mfma_f32_16x16x32_bf16 v[28:31], v[172:175], v[48:51], v[28:31]
    v_mul_f32 v77, v111, v105
    v_mul_f32 v78, v111, v106
    v_mfma_f32_16x16x32_bf16 v[32:35], v[48:51], v[236:239], v[32:35]
    v_mul_f32 v79, v111, v107
    s_waitcnt lgkmcnt(0)
    v_mfma_f32_16x16x32_bf16 v[28:31], v[176:179], v[52:55], v[28:31]
    v_mul_f32 v72, v72, v108
    v_mul_f32 v73, v73, v108
    v_mfma_f32_16x16x32_bf16 v[32:35], v[52:55], v[240:243], v[32:35]
    v_mul_f32 v74, v74, v108
    v_mul_f32 v75, v75, v108
    v_mfma_f32_16x16x32_bf16 v[28:31], v[180:183], v[56:59], v[28:31]
    v_mfma_f32_16x16x32_bf16 v[32:35], v[56:59], v[244:247], v[32:35]
    v_mfma_f32_16x16x32_bf16 v[28:31], v[184:187], v[60:63], v[28:31]
    v_mfma_f32_16x16x32_bf16 v[32:35], v[60:63], v[248:251], v[32:35]
    v_mfma_f32_16x16x32_bf16 v[28:31], v[188:191], v[64:67], v[28:31]
    v_mfma_f32_16x16x32_bf16 v[32:35], v[64:67], v[252:255], v[32:35]
    s_add_u32 s5, s57, 0x20000
    s_sub_u32 s4, s58, s59
    s_add_u32 s3, s99, 0x40000
    s_nop 3
    v_pk_fma_f32 v[28:29], v[28:29], v[110:111], v[76:77] op_sel:[0,0,0] op_sel_hi:[1,0,1]
    v_pk_fma_f32 v[30:31], v[30:31], v[110:111], v[78:79] op_sel:[0,0,0] op_sel_hi:[1,0,1]
    v_pk_fma_f32 v[32:33], v[32:33], v[68:69], v[72:73] op_sel:[0,0,0] op_sel_hi:[1,1,1]
    v_pk_fma_f32 v[34:35], v[34:35], v[70:71], v[74:75] op_sel:[0,0,0] op_sel_hi:[1,1,1]
    v_cvt_pk_bf16_f32 v86, v28, v29
    v_cvt_pk_bf16_f32 v87, v30, v31
    v_cvt_pk_bf16_f32 v94, v32, v33
    v_cvt_pk_bf16_f32 v95, v34, v35
    v_permlane16_swap_b32 v84, v86
    v_permlane16_swap_b32 v85, v87
    buffer_store_dwordx4 v[84:87], v1, s[32:35], s56 offen offset:2048 sc1
    v_permlane32_swap_b32 v92, v94
    v_permlane32_swap_b32 v93, v95
    ds_write_b128 v122, v[92:95] offset:3088
    buffer_store_dwordx4 v[92:95], v1, s[32:35], s56 offen offset:3072 sc1
    s_waitcnt vmcnt(6)
    buffer_store_dwordx4 v[96:99], v100, s[32:35], s99 offen sc1
    v_and_b32 v60, 3, v0
    v_subrev_u32 v60, 1, v60
    v_ashrrev_i32 v60, 31, v60
    v_and_b32 v63, 0x3f803f80, v60
    v_and_b32 v62, 0x3f803f80, v60
    v_and_b32 v61, 0x3f803f80, v60
    v_and_b32 v60, 0x3f803f80, v60
    s_waitcnt vmcnt(3)
    s_barrier
    ds_read_b64_tr_b16 a[192:193], v126 offset:0
    ds_read_b64_tr_b16 a[194:195], v126 offset:512
    ds_read_b64_tr_b16 a[196:197], v126 offset:4096
    ds_read_b64_tr_b16 a[198:199], v126 offset:4608
    ds_read_b64_tr_b16 a[200:201], v126 offset:8192
    ds_read_b64_tr_b16 a[202:203], v126 offset:8704
    ds_read_b64_tr_b16 a[204:205], v126 offset:12288
    ds_read_b64_tr_b16 a[206:207], v126 offset:12800
    ds_read_b64_tr_b16 a[208:209], v126 offset:16384
    ds_read_b64_tr_b16 a[210:211], v126 offset:16896
    s_waitcnt lgkmcnt(6)
    v_mfma_f32_16x16x32_bf16 v[92:95], v[60:63], a[192:195], 0
    ds_read_b64_tr_b16 a[212:213], v126 offset:20480
    ds_read_b64_tr_b16 a[214:215], v126 offset:20992
    v_mfma_f32_16x16x32_bf16 v[92:95], v[60:63], a[196:199], v[92:95]
    ds_read_b64_tr_b16 a[216:217], v126 offset:24576
    ds_read_b64_tr_b16 a[218:219], v126 offset:25088
    s_waitcnt lgkmcnt(6)
    v_mfma_f32_16x16x32_bf16 v[92:95], v[60:63], a[200:203], v[92:95]
    ds_read_b64_tr_b16 a[220:221], v126 offset:28672
    ds_read_b64_tr_b16 a[222:223], v126 offset:29184
    v_mfma_f32_16x16x32_bf16 v[92:95], v[60:63], a[204:207], v[92:95]
    ds_read_b64_tr_b16 a[224:225], v126 offset:32768
    ds_read_b64_tr_b16 a[226:227], v126 offset:33280
    s_waitcnt lgkmcnt(6)
    v_mfma_f32_16x16x32_bf16 v[92:95], v[60:63], a[208:211], v[92:95]
    ds_read_b64_tr_b16 a[228:229], v126 offset:36864
    ds_read_b64_tr_b16 a[230:231], v126 offset:37376
    v_mfma_f32_16x16x32_bf16 v[92:95], v[60:63], a[212:215], v[92:95]
    ds_read_b64_tr_b16 a[232:233], v126 offset:40960
    ds_read_b64_tr_b16 a[234:235], v126 offset:41472
    s_waitcnt lgkmcnt(6)
    v_mfma_f32_16x16x32_bf16 v[92:95], v[60:63], a[216:219], v[92:95]
    ds_read_b64_tr_b16 a[236:237], v126 offset:45056
    ds_read_b64_tr_b16 a[238:239], v126 offset:45568
    v_mfma_f32_16x16x32_bf16 v[92:95], v[60:63], a[220:223], v[92:95]
    ds_read_b64_tr_b16 a[240:241], v126 offset:49152
    ds_read_b64_tr_b16 a[242:243], v126 offset:49664
    s_waitcnt lgkmcnt(6)
    v_mfma_f32_16x16x32_bf16 v[92:95], v[60:63], a[224:227], v[92:95]
    ds_read_b64_tr_b16 a[244:245], v126 offset:53248
    ds_read_b64_tr_b16 a[246:247], v126 offset:53760
    v_mfma_f32_16x16x32_bf16 v[92:95], v[60:63], a[228:231], v[92:95]
    ds_read_b64_tr_b16 a[248:249], v126 offset:57344
    ds_read_b64_tr_b16 a[250:251], v126 offset:57856
    s_waitcnt lgkmcnt(6)
    v_mfma_f32_16x16x32_bf16 v[92:95], v[60:63], a[232:235], v[92:95]
    ds_read_b64_tr_b16 a[252:253], v126 offset:61440
    ds_read_b64_tr_b16 a[254:255], v126 offset:61952
    v_mfma_f32_16x16x32_bf16 v[92:95], v[60:63], a[236:239], v[92:95]
    ds_read_b128 v[44:47], v2 offset:0
    ds_read_b128 v[48:51], v2 offset:1024
    s_waitcnt lgkmcnt(6)
    v_mfma_f32_16x16x32_bf16 v[92:95], v[60:63], a[240:243], v[92:95]
    ds_read_b128 v[52:55], v2 offset:2048
    ds_read_b128 v[56:59], v2 offset:3072
    v_mfma_f32_16x16x32_bf16 v[92:95], v[60:63], a[244:247], v[92:95]
    ds_read_b128 v[104:107], v2 offset:4096
    ds_read_b128 v[108:111], v2 offset:5120
    s_waitcnt lgkmcnt(6)
    v_mfma_f32_16x16x32_bf16 v[92:95], v[60:63], a[248:251], v[92:95]
    ds_read_b128 v[112:115], v2 offset:6144
    ds_read_b128 v[116:119], v2 offset:7168
    v_mfma_f32_16x16x32_bf16 v[92:95], v[60:63], a[252:255], v[92:95]
    ds_read_b128 v[20:23], v2 offset:8192
    s_waitcnt lgkmcnt(8)
    v_mfma_f32_16x16x32_bf16 v[28:31], a[192:195], v[44:47], 0
    ds_read_b128 v[24:27], v2 offset:9216
    s_waitcnt lgkmcnt(8)
    v_mfma_f32_16x16x32_bf16 v[28:31], a[196:199], v[48:51], v[28:31]
    ds_read_b128 v[44:47], v2 offset:10240
    s_waitcnt lgkmcnt(8)
    v_mfma_f32_16x16x32_bf16 v[28:31], a[200:203], v[52:55], v[28:31]
    ds_read_b128 v[48:51], v2 offset:11264
    s_barrier
    s_waitcnt lgkmcnt(8)
    v_mfma_f32_16x16x32_bf16 v[28:31], a[204:207], v[56:59], v[28:31]
    ds_read_b128 v[52:55], v2 offset:12288
    s_waitcnt lgkmcnt(5)
    v_mfma_f32_16x16x32_bf16 v[28:31], a[208:211], v[104:107], v[28:31]
    ds_read_b128 v[56:59], v2 offset:13312
    ds_write_b32 v6, v92 offset:768
    v_mfma_f32_16x16x32_bf16 v[28:31], a[212:215], v[108:111], v[28:31]
    ds_read_b128 v[104:107], v2 offset:14336
    v_xor_b32 v101, 32, v9
    v_mfma_f32_16x16x32_bf16 v[28:31], a[216:219], v[112:115], v[28:31]
    ds_read_b128 v[108:111], v2 offset:15360
    v_xor_b32 v102, 64, v9
    v_mfma_f32_16x16x32_bf16 v[28:31], a[220:223], v[116:119], v[28:31]
    ds_read_b128 v[112:115], v2 offset:16384
    s_waitcnt lgkmcnt(6)
    v_mfma_f32_16x16x32_bf16 v[28:31], a[224:227], v[20:23], v[28:31]
    ds_read_b128 v[116:119], v2 offset:17408
    v_xor_b32 v103, 96, v9
    v_mfma_f32_16x16x32_bf16 v[28:31], a[228:231], v[24:27], v[28:31]
    ds_read_b128 v[20:23], v2 offset:18432
    v_cndmask_b32 v60, v18, 0, s[64:65]
    v_mfma_f32_16x16x32_bf16 v[28:31], a[232:235], v[44:47], v[28:31]
    ds_read_b128 v[24:27], v2 offset:19456
    v_cndmask_b32 v61, v18, 0, s[66:67]
    v_mfma_f32_16x16x32_bf16 v[28:31], a[236:239], v[48:51], v[28:31]
    ds_read_b128 v[44:47], v2 offset:20480
    s_waitcnt lgkmcnt(5)
    v_mfma_f32_16x16x32_bf16 v[28:31], a[240:243], v[52:55], v[28:31]
    ds_read_b128 v[48:51], v2 offset:21504
    v_cndmask_b32 v62, v18, 0, s[68:69]
    v_mfma_f32_16x16x32_bf16 v[28:31], a[244:247], v[56:59], v[28:31]
    ds_read_b128 v[52:55], v2 offset:22528
    v_cndmask_b32 v63, v18, 0, s[70:71]
    v_mfma_f32_16x16x32_bf16 v[28:31], a[248:251], v[104:107], v[28:31]
    ds_read_b128 v[56:59], v2 offset:23552
    v_cndmask_b32 v64, v18, 0, s[72:73]
    v_mfma_f32_16x16x32_bf16 v[28:31], a[252:255], v[108:111], v[28:31]
    ds_read_b128 v[104:107], v2 offset:24576
    s_waitcnt lgkmcnt(5)
    v_mfma_f32_16x16x32_bf16 v[32:35], a[192:195], v[112:115], 0
    ds_read_b128 v[108:111], v2 offset:25600
    buffer_load_dword v79, v19, s[32:35], s57 offen offset:0 sc1
    v_mfma_f32_16x16x32_bf16 v[32:35], a[196:199], v[116:119], v[32:35]
    ds_read_b128 v[112:115], v2 offset:26624
    v_cndmask_b32 v65, v18, 0, s[74:75]
    v_mfma_f32_16x16x32_bf16 v[32:35], a[200:203], v[20:23], v[32:35]
    ds_read_b128 v[116:119], v2 offset:27648
    s_waitcnt vmcnt(2)
    buffer_store_dwordx4 v[96:99], v100, s[32:35], s98 offen sc1
    v_mfma_f32_16x16x32_bf16 v[32:35], a[204:207], v[24:27], v[32:35]
    ds_read_b128 v[20:23], v2 offset:28672
    s_waitcnt lgkmcnt(5)
    v_mfma_f32_16x16x32_bf16 v[32:35], a[208:211], v[44:47], v[32:35]
    ds_read_b128 v[24:27], v2 offset:29696
    v_cndmask_b32 v66, v18, 0, s[76:77]
    v_mfma_f32_16x16x32_bf16 v[32:35], a[212:215], v[48:51], v[32:35]
    ds_read_b128 v[44:47], v2 offset:30720
    v_cndmask_b32 v67, v18, 0, s[78:79]
    v_mfma_f32_16x16x32_bf16 v[32:35], a[216:219], v[52:55], v[32:35]
    s_add_u32 m0, s44, 0
    s_xor_b32 s7, s47, 0
    ds_read_b128 v[48:51], v2 offset:31744
    v_mfma_f32_16x16x32_bf16 v[32:35], a[220:223], v[56:59], v[32:35]
    buffer_load_dwordx4 v9, s[24:27], s7 offen offset:0 lds
    ds_read_b128 v[52:55], v2 offset:32768
    s_waitcnt lgkmcnt(5)
    v_mfma_f32_16x16x32_bf16 v[32:35], a[224:227], v[104:107], v[32:35]
    ds_read_b128 v[56:59], v2 offset:33792
    v_cndmask_b32 v68, v18, 0, s[80:81]
    v_mfma_f32_16x16x32_bf16 v[32:35], a[228:231], v[108:111], v[32:35]
    ds_read_b128 v[104:107], v2 offset:34816
    v_cndmask_b32 v69, v18, 0, s[82:83]
    v_mfma_f32_16x16x32_bf16 v[32:35], a[232:235], v[112:115], v[32:35]
    ds_read_b128 v[108:111], v2 offset:35840
    v_cndmask_b32 v70, v18, 0, s[84:85]
    v_mfma_f32_16x16x32_bf16 v[32:35], a[236:239], v[116:119], v[32:35]
    buffer_load_dwordx4 v101, s[24:27], s7 offen offset:1024 lds
    ds_read_b128 v[112:115], v2 offset:36864
    s_waitcnt lgkmcnt(5)
    v_mfma_f32_16x16x32_bf16 v[32:35], a[240:243], v[20:23], v[32:35]
    ds_read_b128 v[116:119], v2 offset:37888
    v_cndmask_b32 v71, v18, 0, s[86:87]
    v_mfma_f32_16x16x32_bf16 v[32:35], a[244:247], v[24:27], v[32:35]
    ds_read_b128 v[20:23], v2 offset:38912
    v_cndmask_b32 v72, v18, 0, s[88:89]
    v_mfma_f32_16x16x32_bf16 v[32:35], a[248:251], v[44:47], v[32:35]
    ds_read_b128 v[24:27], v2 offset:39936
    v_cndmask_b32 v73, v18, 0, s[90:91]
    v_mfma_f32_16x16x32_bf16 v[32:35], a[252:255], v[48:51], v[32:35]
    buffer_load_dwordx4 v102, s[24:27], s7 offen offset:2048 lds
    ds_read_b128 v[44:47], v2 offset:40960
    s_waitcnt lgkmcnt(5)
    v_mfma_f32_16x16x32_bf16 v[36:39], a[192:195], v[52:55], 0
    ds_read_b128 v[48:51], v2 offset:41984
    v_cndmask_b32 v74, v18, 0, s[92:93]
    v_mfma_f32_16x16x32_bf16 v[36:39], a[196:199], v[56:59], v[36:39]
    ds_read_b128 v[52:55], v2 offset:43008
    v_cndmask_b32 v75, v18, 0, s[94:95]
    v_mfma_f32_16x16x32_bf16 v[36:39], a[200:203], v[104:107], v[36:39]
    ds_read_b128 v[56:59], v2 offset:44032
    v_mfma_f32_16x16x32_bf16 v[36:39], a[204:207], v[108:111], v[36:39]
    buffer_load_dwordx4 v103, s[24:27], s7 offen offset:3072 lds
    ds_read_b128 v[104:107], v2 offset:45056
    s_waitcnt lgkmcnt(5)
    v_mfma_f32_16x16x32_bf16 v[36:39], a[208:211], v[112:115], v[36:39]
    ds_read_b128 v[108:111], v2 offset:46080
    v_mfma_f32_16x16x32_bf16 v[36:39], a[212:215], v[116:119], v[36:39]
    ds_read_b128 v[112:115], v2 offset:47104
    v_mfma_f32_16x16x32_bf16 v[36:39], a[216:219], v[20:23], v[36:39]
    s_add_u32 m0, s44, 4096
    s_xor_b32 s7, s47, 32768
    ds_read_b128 v[116:119], v2 offset:48128
    v_mfma_f32_16x16x32_bf16 v[36:39], a[220:223], v[24:27], v[36:39]
    buffer_load_dwordx4 v9, s[24:27], s7 offen offset:0 lds
    ds_read_b128 v[20:23], v2 offset:49152
    s_waitcnt lgkmcnt(5)
    v_mfma_f32_16x16x32_bf16 v[36:39], a[224:227], v[44:47], v[36:39]
    ds_read_b128 v[24:27], v2 offset:50176
    v_mfma_f32_16x16x32_bf16 v[36:39], a[228:231], v[48:51], v[36:39]
    ds_read_b128 v[44:47], v2 offset:51200
    v_mfma_f32_16x16x32_bf16 v[36:39], a[232:235], v[52:55], v[36:39]
    ds_read_b128 v[48:51], v2 offset:52224
    v_mfma_f32_16x16x32_bf16 v[36:39], a[236:239], v[56:59], v[36:39]
    buffer_load_dwordx4 v101, s[24:27], s7 offen offset:1024 lds
    ds_read_b128 v[52:55], v2 offset:53248
    s_waitcnt lgkmcnt(5)
    v_mfma_f32_16x16x32_bf16 v[36:39], a[240:243], v[104:107], v[36:39]
    ds_read_b128 v[56:59], v2 offset:54272
    v_mfma_f32_16x16x32_bf16 v[36:39], a[244:247], v[108:111], v[36:39]
    ds_read_b128 v[104:107], v2 offset:55296
    v_mfma_f32_16x16x32_bf16 v[36:39], a[248:251], v[112:115], v[36:39]
    ds_read_b128 v[108:111], v2 offset:56320
    v_mfma_f32_16x16x32_bf16 v[36:39], a[252:255], v[116:119], v[36:39]
    buffer_load_dwordx4 v102, s[24:27], s7 offen offset:2048 lds
    ds_read_b128 v[112:115], v2 offset:57344
    s_waitcnt lgkmcnt(5)
    v_mfma_f32_16x16x32_bf16 v[40:43], a[192:195], v[20:23], 0
    ds_read_b128 v[116:119], v2 offset:58368
    v_mfma_f32_16x16x32_bf16 v[40:43], a[196:199], v[24:27], v[40:43]
    ds_read_b128 v[20:23], v2 offset:59392
    v_mfma_f32_16x16x32_bf16 v[40:43], a[200:203], v[44:47], v[40:43]
    ds_read_b128 v[24:27], v2 offset:60416
    v_mfma_f32_16x16x32_bf16 v[40:43], a[204:207], v[48:51], v[40:43]
    buffer_load_dwordx4 v103, s[24:27], s7 offen offset:3072 lds
    ds_read_b128 v[44:47], v2 offset:61440
    s_waitcnt lgkmcnt(5)
    v_mfma_f32_16x16x32_bf16 v[40:43], a[208:211], v[52:55], v[40:43]
    ds_read_b128 v[48:51], v2 offset:62464
    v_mfma_f32_16x16x32_bf16 v[40:43], a[212:215], v[56:59], v[40:43]
    ds_read_b128 v[52:55], v2 offset:63488
    ds_read_b128 v[88:91], v5 offset:768
    v_mfma_f32_16x16x32_bf16 v[40:43], a[216:219], v[104:107], v[40:43]
    ds_read_b128 v[56:59], v2 offset:64512
    ds_read2_b32 v[120:121], v4 offset0:0 offset1:64
    v_mfma_f32_16x16x32_bf16 v[40:43], a[220:223], v[108:111], v[40:43]
    ds_read2_b32 v[122:123], v4 offset0:16 offset1:80
    s_waitcnt lgkmcnt(7)
    v_mfma_f32_16x16x32_bf16 v[40:43], a[224:227], v[112:115], v[40:43]
    ds_read2_b32 v[124:125], v4 offset0:32 offset1:96
    ds_read2_b32 v[126:127], v4 offset0:48 offset1:112
    v_mfma_f32_16x16x32_bf16 v[40:43], a[228:231], v[116:119], v[40:43]
    v_mfma_f32_16x16x32_bf16 v[40:43], a[232:235], v[20:23], v[40:43]
    v_mfma_f32_16x16x32_bf16 v[40:43], a[236:239], v[24:27], v[40:43]
    s_waitcnt lgkmcnt(4)
    v_mfma_f32_16x16x32_bf16 v[40:43], a[240:243], v[44:47], v[40:43]
    v_mfma_f32_16x16x32_bf16 v[40:43], a[244:247], v[48:51], v[40:43]
    s_waitcnt vmcnt(9)
    v_cmp_ne_u32 vcc, s39, v79
    s_cbranch_vccnz L_retry_19
L_back_20:
    s_barrier
    v_mfma_f32_16x16x32_bf16 v[40:43], a[248:251], v[52:55], v[40:43]
    s_add_u32 m0, s58, 0
    v_mfma_f32_16x16x32_bf16 v[40:43], a[252:255], v[56:59], v[40:43]
    buffer_load_dwordx4 v1, s[32:35], s60 offen offset:0 sc1 lds
    s_barrier
    v_mov_b32 v92, 0x3eb8aa3b
    buffer_load_dwordx4 v1, s[32:35], s60 offen offset:1024 sc1 lds
    ds_write2_b32 v16, v17, v17 offset0:0 offset1:1
    ds_write2_b32 v16, v17, v17 offset0:2 offset1:3
    s_waitcnt lgkmcnt(5)
    v_pk_mul_f32 v[120:121], v[120:121], v[92:93] op_sel:[0,0] op_sel_hi:[1,0]
    s_waitcnt lgkmcnt(4)
    v_pk_mul_f32 v[122:123], v[122:123], v[92:93] op_sel:[0,0] op_sel_hi:[1,0]
    s_waitcnt lgkmcnt(3)
    v_pk_mul_f32 v[124:125], v[124:125], v[92:93] op_sel:[0,0] op_sel_hi:[1,0]
    s_waitcnt lgkmcnt(2)
    v_pk_mul_f32 v[126:127], v[126:127], v[92:93] op_sel:[0,0] op_sel_hi:[1,0]
    v_pk_mul_f32 v[92:93], v[88:89], v[120:121] op_sel:[0,1] op_sel_hi:[1,1]
    s_add_u32 m0, s58, 2064
    v_pk_mul_f32 v[94:95], v[90:91], v[120:121] op_sel:[0,1] op_sel_hi:[1,1]
    buffer_load_dwordx4 v1, s[32:35], s61 offen offset:0 sc1 lds
    v_pk_fma_f32 v[28:29], v[28:29], v[120:121], v[92:93] op_sel:[0,0,0] op_sel_hi:[1,0,1]
    v_pk_fma_f32 v[30:31], v[30:31], v[120:121], v[94:95] op_sel:[0,0,0] op_sel_hi:[1,0,1]
    v_cvt_pk_bf16_f32 v20, v28, v29
    v_cvt_pk_bf16_f32 v21, v30, v31
    v_pk_mul_f32 v[92:93], v[88:89], v[122:123] op_sel:[0,1] op_sel_hi:[1,1]
    v_pk_mul_f32 v[94:95], v[90:91], v[122:123] op_sel:[0,1] op_sel_hi:[1,1]
    v_pk_fma_f32 v[32:33], v[32:33], v[122:123], v[92:93] op_sel:[0,0,0] op_sel_hi:[1,0,1]
    v_pk_fma_f32 v[34:35], v[34:35], v[122:123], v[94:95] op_sel:[0,0,0] op_sel_hi:[1,0,1]
    buffer_load_dwordx4 v1, s[32:35], s61 offen offset:1024 sc1 lds
    v_cvt_pk_bf16_f32 v22, v32, v33
    v_cvt_pk_bf16_f32 v23, v34, v35
    v_pk_mul_f32 v[92:93], v[88:89], v[124:125] op_sel:[0,1] op_sel_hi:[1,1]
    v_pk_mul_f32 v[94:95], v[90:91], v[124:125] op_sel:[0,1] op_sel_hi:[1,1]
    v_pk_fma_f32 v[36:37], v[36:37], v[124:125], v[92:93] op_sel:[0,0,0] op_sel_hi:[1,0,1]
    v_pk_fma_f32 v[38:39], v[38:39], v[124:125], v[94:95] op_sel:[0,0,0] op_sel_hi:[1,0,1]
    v_permlane16_swap_b32 v20, v22
    v_permlane16_swap_b32 v21, v23
    buffer_load_dword v8, v19, s[32:35], s5 offen offset:0 sc1
    v_cvt_pk_bf16_f32 v24, v36, v37
    v_cvt_pk_bf16_f32 v25, v38, v39
    v_pk_mul_f32 v[92:93], v[88:89], v[126:127] op_sel:[0,1] op_sel_hi:[1,1]
    v_pk_mul_f32 v[94:95], v[90:91], v[126:127] op_sel:[0,1] op_sel_hi:[1,1]
    v_pk_fma_f32 v[40:41], v[40:41], v[126:127], v[92:93] op_sel:[0,0,0] op_sel_hi:[1,0,1]
    v_pk_fma_f32 v[42:43], v[42:43], v[126:127], v[94:95] op_sel:[0,0,0] op_sel_hi:[1,0,1]
    v_cvt_pk_bf16_f32 v26, v40, v41
    s_add_u32 m0, s58, 4128
    v_cvt_pk_bf16_f32 v27, v42, v43
    buffer_load_dwordx4 v1, s[32:35], s62 offen offset:0 sc1 lds
    buffer_load_dwordx4 v1, s[32:35], s62 offen offset:1024 sc1 lds
    s_add_u32 m0, s58, 6192
    s_nop 0
    buffer_load_dwordx4 v1, s[32:35], s63 offen offset:0 sc1 lds
    buffer_load_dwordx4 v1, s[32:35], s63 offen offset:1024 sc1 lds
    buffer_store_dwordx4 v[96:99], v100, s[32:35], s3 offen sc1
    s_nop 0
    s_nop 0
    v_mfma_f32_32x32x16_bf16 v[96:111], v[80:83], v[20:23], v[60:75]
    v_permlane16_swap_b32 v24, v26
    v_permlane16_swap_b32 v25, v27
    s_nop 1
    v_mfma_f32_32x32x16_bf16 v[112:127], v[84:87], v[24:27], v[60:75]
    s_nop 6
    v_max3_f32 v16, v96, v97, v98
    v_max3_f32 v76, v99, v100, v101
    v_max3_f32 v16, v16, v102, v103
    v_max3_f32 v76, v76, v104, v105
    v_max3_f32 v16, v16, v106, v107
    v_max3_f32 v76, v76, v108, v109
    v_max3_f32 v16, v16, v110, v111
    v_max_f32 v16, v16, v76
    v_mov_b32 v76, v16
    v_max3_f32 v17, v112, v113, v114
    v_max3_f32 v77, v115, v116, v117
    v_max3_f32 v17, v17, v118, v119
    v_max3_f32 v77, v77, v120, v121
    v_max3_f32 v17, v17, v122, v123
    v_max3_f32 v77, v77, v124, v125
    v_max3_f32 v17, v17, v126, v127
    v_max_f32 v17, v17, v77
    v_mov_b32 v77, v17
    v_permlane32_swap_b32 v16, v76
    s_nop 0
    v_permlane32_swap_b32 v17, v77
    v_min_f32_e64 v16, -v16, -v76
    v_min_f32_e64 v17, -v17, -v77
    v_max_f32 v17, v16, v17
    v_pk_add_f32 v[96:97], v[96:97], v[16:17] op_sel:[0,1] op_sel_hi:[1,1]
    v_pk_add_f32 v[98:99], v[98:99], v[16:17] op_sel:[0,1] op_sel_hi:[1,1]
    v_pk_add_f32 v[100:101], v[100:101], v[16:17] op_sel:[0,1] op_sel_hi:[1,1]
    v_pk_add_f32 v[102:103], v[102:103], v[16:17] op_sel:[0,1] op_sel_hi:[1,1]
    v_pk_add_f32 v[104:105], v[104:105], v[16:17] op_sel:[0,1] op_sel_hi:[1,1]
    v_pk_add_f32 v[106:107], v[106:107], v[16:17] op_sel:[0,1] op_sel_hi:[1,1]
    v_pk_add_f32 v[108:109], v[108:109], v[16:17] op_sel:[0,1] op_sel_hi:[1,1]
    v_pk_add_f32 v[110:111], v[110:111], v[16:17] op_sel:[0,1] op_sel_hi:[1,1]
    v_pk_add_f32 v[112:113], v[112:113], v[16:17] op_sel:[0,1] op_sel_hi:[1,1]
    v_pk_add_f32 v[114:115], v[114:115], v[16:17] op_sel:[0,1] op_sel_hi:[1,1]
    v_pk_add_f32 v[116:117], v[116:117], v[16:17] op_sel:[0,1] op_sel_hi:[1,1]
    v_pk_add_f32 v[118:119], v[118:119], v[16:17] op_sel:[0,1] op_sel_hi:[1,1]
    v_pk_add_f32 v[120:121], v[120:121], v[16:17] op_sel:[0,1] op_sel_hi:[1,1]
    v_pk_add_f32 v[122:123], v[122:123], v[16:17] op_sel:[0,1] op_sel_hi:[1,1]
    v_pk_add_f32 v[124:125], v[124:125], v[16:17] op_sel:[0,1] op_sel_hi:[1,1]
    v_pk_add_f32 v[126:127], v[126:127], v[16:17] op_sel:[0,1] op_sel_hi:[1,1]
    v_pk_mov_b32 v[60:61], v[16:17], v[16:17] op_sel:[1,1]
    v_pk_mov_b32 v[62:63], v[16:17], v[16:17] op_sel:[1,1]
    v_pk_mov_b32 v[64:65], v[16:17], v[16:17] op_sel:[1,1]
    v_pk_mov_b32 v[66:67], v[16:17], v[16:17] op_sel:[1,1]
    v_pk_mov_b32 v[68:69], v[16:17], v[16:17] op_sel:[1,1]
    v_pk_mov_b32 v[70:71], v[16:17], v[16:17] op_sel:[1,1]
    v_pk_mov_b32 v[72:73], v[16:17], v[16:17] op_sel:[1,1]
    v_pk_mov_b32 v[74:75], v[16:17], v[16:17] op_sel:[1,1]
    v_exp_f32 v96, v96
    v_exp_f32 v97, v97
    ds_read_b128 v[88:91], v14 offset:0
    v_exp_f32 v98, v98
    v_exp_f32 v99, v99
    v_cvt_pk_bf16_f32 v96, v96, v97
    v_exp_f32 v100, v100
    v_exp_f32 v101, v101
    ds_read_b128 v[92:95], v15 offset:0
    v_cvt_pk_bf16_f32 v97, v98, v99
    v_exp_f32 v102, v102
    v_exp_f32 v103, v103
    v_cvt_pk_bf16_f32 v98, v100, v101
    v_exp_f32 v104, v104
    v_exp_f32 v105, v105
    v_cvt_pk_bf16_f32 v99, v102, v103
    v_exp_f32 v106, v106
    v_exp_f32 v107, v107
    v_cvt_pk_bf16_f32 v104, v104, v105
    v_exp_f32 v108, v108
    v_exp_f32 v109, v109
    v_cvt_pk_bf16_f32 v105, v106, v107
    v_exp_f32 v110, v110
    v_exp_f32 v111, v111
    v_cvt_pk_bf16_f32 v106, v108, v109
    v_exp_f32 v112, v112
    v_exp_f32 v113, v113
    v_cvt_pk_bf16_f32 v107, v110, v111
    s_waitcnt lgkmcnt(0)
    v_mfma_f32_32x32x16_bf16 v[28:43], v[88:91], v[96:99], 0
    ds_read_b128 v[88:91], v14 offset:2064
    v_exp_f32 v114, v114
    v_exp_f32 v115, v115
    v_cvt_pk_bf16_f32 v112, v112, v113
    v_exp_f32 v116, v116
    v_exp_f32 v117, v117
    v_mfma_f32_32x32x16_bf16 v[28:43], v[92:95], v[104:107], v[28:43]
    ds_read_b128 v[92:95], v15 offset:2064
    v_cvt_pk_bf16_f32 v113, v114, v115
    v_exp_f32 v118, v118
    v_exp_f32 v119, v119
    v_cvt_pk_bf16_f32 v114, v116, v117
    v_mfma_f32_32x32x16_bf16 v[96:111], v[80:83], v[24:27], v[60:75]
    v_exp_f32 v120, v120
    v_exp_f32 v121, v121
    v_cvt_pk_bf16_f32 v115, v118, v119
    v_exp_f32 v122, v122
    v_exp_f32 v123, v123
    v_cvt_pk_bf16_f32 v120, v120, v121
    v_exp_f32 v124, v124
    v_exp_f32 v125, v125
    v_cvt_pk_bf16_f32 v121, v122, v123
    v_exp_f32 v126, v126
    v_exp_f32 v127, v127
    v_cvt_pk_bf16_f32 v122, v124, v125
    v_exp_f32 v96, v96
    v_exp_f32 v97, v97
    v_cvt_pk_bf16_f32 v123, v126, v127
    s_waitcnt vmcnt(8) lgkmcnt(0)
    ds_read_b128 v[76:79], v13 offset:0
    v_mfma_f32_32x32x16_bf16 v[44:59], v[88:91], v[112:115], 0
    ds_read_b128 v[88:91], v14 offset:0
    v_exp_f32 v98, v98
    v_exp_f32 v99, v99
    v_cvt_pk_bf16_f32 v96, v96, v97
    v_exp_f32 v100, v100
    v_exp_f32 v101, v101
    v_mfma_f32_32x32x16_bf16 v[44:59], v[92:95], v[120:123], v[44:59]
    ds_read_b128 v[92:95], v15 offset:0
    v_cvt_pk_bf16_f32 v97, v98, v99
    v_exp_f32 v102, v102
    v_exp_f32 v103, v103
    v_cvt_pk_bf16_f32 v98, v100, v101
    s_waitcnt lgkmcnt(2)
    v_mfma_f32_32x32x16_bf16 v[112:127], v[76:79], v[24:27], v[60:75]
    v_exp_f32 v104, v104
    v_exp_f32 v105, v105
    v_cvt_pk_bf16_f32 v99, v102, v103
    v_exp_f32 v106, v106
    v_exp_f32 v107, v107
    v_cvt_pk_bf16_f32 v104, v104, v105
    v_exp_f32 v108, v108
    v_exp_f32 v109, v109
    v_cvt_pk_bf16_f32 v105, v106, v107
    v_exp_f32 v110, v110
    v_exp_f32 v111, v111
    v_cvt_pk_bf16_f32 v106, v108, v109
    s_waitcnt vmcnt(5)
    v_cmp_ne_u32 vcc, s39, v8
    s_cbranch_vccnz L_retry_22
L_back_23:
    s_add_u32 m0, s58, 30976
    v_exp_f32 v112, v112
    buffer_load_dwordx4 v1, s[32:35], s60 offen offset:2048 sc1 lds
    v_exp_f32 v113, v113
    v_cvt_pk_bf16_f32 v107, v110, v111
    s_waitcnt lgkmcnt(0)
    v_add_u32 v14, s4, v14
    v_add_u32 v15, s4, v15
    v_mfma_f32_32x32x16_bf16 v[44:59], v[88:91], v[96:99], v[44:59]
    ds_read_b128 v[88:91], v14 offset:0
    buffer_load_dwordx4 v1, s[32:35], s60 offen offset:3072 sc1 lds
    v_exp_f32 v114, v114
    v_exp_f32 v115, v115
    v_cvt_pk_bf16_f32 v112, v112, v113
    v_exp_f32 v116, v116
    v_exp_f32 v117, v117
    v_mfma_f32_32x32x16_bf16 v[44:59], v[92:95], v[104:107], v[44:59]
    s_add_u32 m0, s58, 33040
    ds_read_b128 v[92:95], v15 offset:0
    buffer_load_dwordx4 v1, s[32:35], s61 offen offset:2048 sc1 lds
L_pad4:
    s_cbranch_execz L_warm1
    v_cvt_pk_bf16_f32 v113, v114, v115
    v_exp_f32 v118, v118
    v_exp_f32 v119, v119
    v_cvt_pk_bf16_f32 v114, v116, v117
    v_mfma_f32_32x32x16_bf16 v[96:111], v[76:79], v[20:23], v[60:75]
    ds_read_b128 v[76:79], v13 offset:2064
    v_exp_f32 v120, v120
    buffer_load_dwordx4 v1, s[32:35], s61 offen offset:3072 sc1 lds
    v_exp_f32 v121, v121
    v_cvt_pk_bf16_f32 v115, v118, v119
    v_exp_f32 v122, v122
    v_exp_f32 v123, v123
    v_cvt_pk_bf16_f32 v120, v120, v121
    v_exp_f32 v124, v124
    v_exp_f32 v125, v125
    v_cvt_pk_bf16_f32 v121, v122, v123
    v_exp_f32 v126, v126
    v_exp_f32 v127, v127
    v_cvt_pk_bf16_f32 v122, v124, v125
    s_add_u32 m0, s58, 35104
    v_exp_f32 v96, v96
    buffer_load_dwordx4 v1, s[32:35], s62 offen offset:2048 sc1 lds
    v_exp_f32 v97, v97
    v_cvt_pk_bf16_f32 v123, v126, v127
    s_waitcnt lgkmcnt(0)
    v_mfma_f32_32x32x16_bf16 v[44:59], v[88:91], v[112:115], v[44:59]
    v_exp_f32 v98, v98
    v_exp_f32 v99, v99
    v_cvt_pk_bf16_f32 v96, v96, v97
    buffer_load_dwordx4 v1, s[32:35], s62 offen offset:3072 sc1 lds
    v_exp_f32 v100, v100
    v_exp_f32 v101, v101
    v_mfma_f32_32x32x16_bf16 v[44:59], v[92:95], v[120:123], v[44:59]
    v_cvt_pk_bf16_f32 v97, v98, v99
    v_exp_f32 v102, v102
    v_exp_f32 v103, v103
    s_add_u32 m0, s58, 37168
    v_cvt_pk_bf16_f32 v98, v100, v101
    buffer_load_dwordx4 v1, s[32:35], s63 offen offset:2048 sc1 lds
    v_mfma_f32_32x32x16_bf16 v[112:127], v[76:79], v[20:23], v[60:75]
    v_exp_f32 v104, v104
    v_exp_f32 v105, v105
    v_cvt_pk_bf16_f32 v99, v102, v103
    v_exp_f32 v106, v106
    v_exp_f32 v107, v107
    v_cvt_pk_bf16_f32 v104, v104, v105
    buffer_load_dwordx4 v1, s[32:35], s63 offen offset:3072 sc1 lds
    v_exp_f32 v108, v108
    v_exp_f32 v109, v109
    v_cvt_pk_bf16_f32 v105, v106, v107
    v_exp_f32 v110, v110
    v_exp_f32 v111, v111
    v_cvt_pk_bf16_f32 v106, v108, v109
    v_exp_f32 v112, v112
    v_exp_f32 v113, v113
    v_cvt_pk_bf16_f32 v107, v110, v111
    s_waitcnt vmcnt(11)
    v_mfma_f32_32x32x16_bf16 v[28:43], v[88:91], v[96:99], v[28:43]
    ds_read_b128 v[88:91], v14 offset:2064
    v_exp_f32 v114, v114
    v_exp_f32 v115, v115
    v_cvt_pk_bf16_f32 v112, v112, v113
    v_exp_f32 v116, v116
    v_exp_f32 v117, v117
    v_mfma_f32_32x32x16_bf16 v[28:43], v[92:95], v[104:107], v[28:43]
    ds_read_b128 v[92:95], v15 offset:2064
    v_cvt_pk_bf16_f32 v113, v114, v115
    v_exp_f32 v118, v118
    v_exp_f32 v119, v119
    v_cvt_pk_bf16_f32 v114, v116, v117
    v_mfma_f32_32x32x16_bf16 v[96:111], v[76:79], v[24:27], v[60:75]
    ds_read_b128 v[76:79], v13 offset:4128
    v_exp_f32 v120, v120
    v_exp_f32 v121, v121
    v_cvt_pk_bf16_f32 v115, v118, v119
    v_exp_f32 v122, v122
    v_exp_f32 v123, v123
    v_cvt_pk_bf16_f32 v120, v120, v121
    v_exp_f32 v124, v124
    v_exp_f32 v125, v125
    v_cvt_pk_bf16_f32 v121, v122, v123
    v_exp_f32 v126, v126
    v_exp_f32 v127, v127
    v_cvt_pk_bf16_f32 v122, v124, v125
    v_xor_b32 v85, 32, v9
    v_xor_b32 v86, 64, v9
    v_xor_b32 v87, 96, v9
    s_add_u32 m0, s44, 8192
    s_xor_b32 s7, s47, 65536
    v_exp_f32 v96, v96
    buffer_load_dwordx4 v9, s[24:27], s7 offen offset:0 lds
    v_exp_f32 v97, v97
    v_cvt_pk_bf16_f32 v123, v126, v127
    s_waitcnt lgkmcnt(0)
    v_mfma_f32_32x32x16_bf16 v[28:43], v[88:91], v[112:115], v[28:43]
    v_exp_f32 v98, v98
    v_exp_f32 v99, v99
    v_cvt_pk_bf16_f32 v96, v96, v97
    buffer_load_dwordx4 v85, s[24:27], s7 offen offset:1024 lds
    v_exp_f32 v100, v100
    v_exp_f32 v101, v101
    v_mfma_f32_32x32x16_bf16 v[28:43], v[92:95], v[120:123], v[28:43]
    v_cvt_pk_bf16_f32 v97, v98, v99
    v_exp_f32 v102, v102
    v_exp_f32 v103, v103
    v_cvt_pk_bf16_f32 v98, v100, v101
    buffer_load_dwordx4 v86, s[24:27], s7 offen offset:2048 lds
    v_mfma_f32_32x32x16_bf16 v[112:127], v[76:79], v[24:27], v[60:75]
    v_exp_f32 v104, v104
    v_exp_f32 v105, v105
    v_cvt_pk_bf16_f32 v99, v102, v103
    v_exp_f32 v106, v106
    v_exp_f32 v107, v107
    v_cvt_pk_bf16_f32 v104, v104, v105
    buffer_load_dwordx4 v87, s[24:27], s7 offen offset:3072 lds
    v_exp_f32 v108, v108
    v_exp_f32 v109, v109
    v_cvt_pk_bf16_f32 v105, v106, v107
    v_exp_f32 v110, v110
    v_exp_f32 v111, v111
    v_cvt_pk_bf16_f32 v106, v108, v109
    s_add_u32 m0, s44, 12288
    s_xor_b32 s7, s47, 98304
    v_exp_f32 v112, v112
    buffer_load_dwordx4 v9, s[24:27], s7 offen offset:0 lds
    v_exp_f32 v113, v113
    v_cvt_pk_bf16_f32 v107, v110, v111
    s_waitcnt vmcnt(14)
    v_mfma_f32_32x32x16_bf16 v[44:59], v[88:91], v[96:99], v[44:59]
    ds_read_b128 v[88:91], v14 offset:4128
    v_exp_f32 v114, v114
    v_exp_f32 v115, v115
    buffer_load_dwordx4 v85, s[24:27], s7 offen offset:1024 lds
    v_cvt_pk_bf16_f32 v112, v112, v113
    v_exp_f32 v116, v116
    v_exp_f32 v117, v117
    v_mfma_f32_32x32x16_bf16 v[44:59], v[92:95], v[104:107], v[44:59]
    ds_read_b128 v[92:95], v15 offset:4128
    v_cvt_pk_bf16_f32 v113, v114, v115
    v_exp_f32 v118, v118
    buffer_load_dwordx4 v86, s[24:27], s7 offen offset:2048 lds
    v_exp_f32 v119, v119
    v_cvt_pk_bf16_f32 v114, v116, v117
    v_mfma_f32_32x32x16_bf16 v[96:111], v[76:79], v[20:23], v[60:75]
    ds_read_b128 v[76:79], v13 offset:6192
    v_exp_f32 v120, v120
    v_exp_f32 v121, v121
    v_cvt_pk_bf16_f32 v115, v118, v119
    buffer_load_dwordx4 v87, s[24:27], s7 offen offset:3072 lds
    v_exp_f32 v122, v122
    v_exp_f32 v123, v123
    v_cvt_pk_bf16_f32 v120, v120, v121
    v_exp_f32 v124, v124
    v_exp_f32 v125, v125
    v_cvt_pk_bf16_f32 v121, v122, v123
    v_exp_f32 v126, v126
    v_exp_f32 v127, v127
    v_cvt_pk_bf16_f32 v122, v124, v125
    v_exp_f32 v96, v96
    v_exp_f32 v97, v97
    v_cvt_pk_bf16_f32 v123, v126, v127
    s_waitcnt lgkmcnt(0)
    v_mfma_f32_32x32x16_bf16 v[44:59], v[88:91], v[112:115], v[44:59]
    v_exp_f32 v98, v98
    v_exp_f32 v99, v99
    v_cvt_pk_bf16_f32 v96, v96, v97
    v_exp_f32 v100, v100
    v_exp_f32 v101, v101
    v_mfma_f32_32x32x16_bf16 v[44:59], v[92:95], v[120:123], v[44:59]
    v_cvt_pk_bf16_f32 v97, v98, v99
    v_exp_f32 v102, v102
    v_exp_f32 v103, v103
    v_cvt_pk_bf16_f32 v98, v100, v101
    v_mfma_f32_32x32x16_bf16 v[112:127], v[76:79], v[20:23], v[60:75]
    v_exp_f32 v104, v104
    v_exp_f32 v105, v105
    v_cvt_pk_bf16_f32 v99, v102, v103
    v_exp_f32 v106, v106
    v_exp_f32 v107, v107
    v_cvt_pk_bf16_f32 v104, v104, v105
    v_exp_f32 v108, v108
    v_exp_f32 v109, v109
    v_cvt_pk_bf16_f32 v105, v106, v107
    v_exp_f32 v110, v110
    v_exp_f32 v111, v111
    v_cvt_pk_bf16_f32 v106, v108, v109
    v_exp_f32 v112, v112
    v_exp_f32 v113, v113
    v_cvt_pk_bf16_f32 v107, v110, v111
    s_waitcnt vmcnt(14)
    ds_read_b128 v[76:79], v13 offset:33024
    v_mfma_f32_32x32x16_bf16 v[28:43], v[88:91], v[96:99], v[28:43]
    ds_read_b128 v[88:91], v14 offset:6192
    v_exp_f32 v114, v114
    v_exp_f32 v115, v115
    v_cndmask_b32 v112, v112, 0, s[64:65]
    v_cndmask_b32 v113, v113, 0, s[66:67]
    v_cvt_pk_bf16_f32 v112, v112, v113
    v_exp_f32 v116, v116
    v_exp_f32 v117, v117
    v_mfma_f32_32x32x16_bf16 v[28:43], v[92:95], v[104:107], v[28:43]
    ds_read_b128 v[92:95], v15 offset:6192
    v_cndmask_b32 v114, v114, 0, s[68:69]
    v_cndmask_b32 v115, v115, 0, s[70:71]
    v_cvt_pk_bf16_f32 v113, v114, v115
    v_exp_f32 v118, v118
    v_exp_f32 v119, v119
    v_cndmask_b32 v116, v116, 0, s[72:73]
    v_cndmask_b32 v117, v117, 0, s[74:75]
    v_cvt_pk_bf16_f32 v114, v116, v117
    s_waitcnt lgkmcnt(2)
    v_mfma_f32_32x32x16_bf16 v[96:111], v[76:79], v[20:23], v[60:75]
    v_exp_f32 v120, v120
    v_exp_f32 v121, v121
    v_cndmask_b32 v118, v118, 0, s[76:77]
    v_cndmask_b32 v119, v119, 0, s[78:79]
    v_cvt_pk_bf16_f32 v115, v118, v119
    v_exp_f32 v122, v122
    v_exp_f32 v123, v123
    v_cndmask_b32 v120, v120, 0, s[80:81]
    v_cndmask_b32 v121, v121, 0, s[82:83]
    v_cvt_pk_bf16_f32 v120, v120, v121
    v_exp_f32 v124, v124
    v_exp_f32 v125, v125
    v_cndmask_b32 v122, v122, 0, s[84:85]
    v_cndmask_b32 v123, v123, 0, s[86:87]
    v_cvt_pk_bf16_f32 v121, v122, v123
    v_exp_f32 v126, v126
    v_exp_f32 v127, v127
    v_cndmask_b32 v124, v124, 0, s[88:89]
    v_cndmask_b32 v125, v125, 0, s[90:91]
    v_cvt_pk_bf16_f32 v122, v124, v125
    v_exp_f32 v96, v96
    v_exp_f32 v97, v97
    v_cndmask_b32 v126, v126, 0, s[92:93]
    v_cndmask_b32 v127, v127, 0, s[94:95]
    v_cvt_pk_bf16_f32 v123, v126, v127
    s_waitcnt vmcnt(12) lgkmcnt(0)
    v_mfma_f32_32x32x16_bf16 v[28:43], v[88:91], v[112:115], v[28:43]
    ds_read_b128 v[88:91], v14 offset:33024
    v_exp_f32 v98, v98
    v_exp_f32 v99, v99
    v_cvt_pk_bf16_f32 v96, v96, v97
    v_exp_f32 v100, v100
    v_exp_f32 v101, v101
    v_mfma_f32_32x32x16_bf16 v[28:43], v[92:95], v[120:123], v[28:43]
    ds_read_b128 v[92:95], v15 offset:33024
    v_cvt_pk_bf16_f32 v97, v98, v99
    v_exp_f32 v102, v102
    v_exp_f32 v103, v103
    v_cvt_pk_bf16_f32 v98, v100, v101
    v_mfma_f32_32x32x16_bf16 v[112:127], v[76:79], v[24:27], v[60:75]
    ds_read_b128 v[76:79], v13 offset:35088
    v_exp_f32 v104, v104
    v_exp_f32 v105, v105
    v_cvt_pk_bf16_f32 v99, v102, v103
    v_exp_f32 v106, v106
    v_exp_f32 v107, v107
    v_cvt_pk_bf16_f32 v104, v104, v105
    v_exp_f32 v108, v108
    v_exp_f32 v109, v109
    v_cvt_pk_bf16_f32 v105, v106, v107
    v_exp_f32 v110, v110
    v_exp_f32 v111, v111
    v_cvt_pk_bf16_f32 v106, v108, v109
    v_mov_b32 v80, -1
    v_mov_b32 v81, -1
    v_mov_b32 v82, -1
    v_mov_b32 v83, -1
    s_add_u32 s3, s56, 0x400000
    v_exp_f32 v112, v112
    v_exp_f32 v113, v113
    v_cvt_pk_bf16_f32 v107, v110, v111
    s_waitcnt lgkmcnt(0)
    v_mfma_f32_32x32x16_bf16 v[28:43], v[88:91], v[96:99], v[28:43]
    v_exp_f32 v114, v114
    v_exp_f32 v115, v115
    v_cvt_pk_bf16_f32 v112, v112, v113
    v_exp_f32 v116, v116
    v_exp_f32 v117, v117
    v_mfma_f32_32x32x16_bf16 v[28:43], v[92:95], v[104:107], v[28:43]
    v_cvt_pk_bf16_f32 v113, v114, v115
    v_exp_f32 v118, v118
    v_exp_f32 v119, v119
    v_cvt_pk_bf16_f32 v114, v116, v117
    v_mfma_f32_32x32x16_bf16 v[96:111], v[76:79], v[24:27], v[60:75]
    v_exp_f32 v120, v120
    v_exp_f32 v121, v121
    v_cvt_pk_bf16_f32 v115, v118, v119
    v_exp_f32 v122, v122
    v_exp_f32 v123, v123
    v_cvt_pk_bf16_f32 v120, v120, v121
    v_exp_f32 v124, v124
    v_exp_f32 v125, v125
    v_cvt_pk_bf16_f32 v121, v122, v123
    v_exp_f32 v126, v126
    v_exp_f32 v127, v127
    v_cvt_pk_bf16_f32 v122, v124, v125
    buffer_store_dwordx4 v[80:83], v1, s[32:35], s3 offen offset:0 sc1
    v_exp_f32 v96, v96
    v_exp_f32 v97, v97
    v_cvt_pk_bf16_f32 v123, v126, v127
    s_waitcnt vmcnt(11)
    v_mfma_f32_32x32x16_bf16 v[44:59], v[88:91], v[112:115], v[44:59]
    ds_read_b128 v[88:91], v14 offset:35088
    v_exp_f32 v98, v98
    v_exp_f32 v99, v99
    v_cvt_pk_bf16_f32 v96, v96, v97
    v_exp_f32 v100, v100
    v_exp_f32 v101, v101
    v_mfma_f32_32x32x16_bf16 v[44:59], v[92:95], v[120:123], v[44:59]
    ds_read_b128 v[92:95], v15 offset:35088
    v_cvt_pk_bf16_f32 v97, v98, v99
    v_exp_f32 v102, v102
    v_exp_f32 v103, v103
    v_cvt_pk_bf16_f32 v98, v100, v101
    v_mfma_f32_32x32x16_bf16 v[112:127], v[76:79], v[20:23], v[60:75]
    ds_read_b128 v[76:79], v13 offset:37152
    v_exp_f32 v104, v104
    v_exp_f32 v105, v105
    v_cvt_pk_bf16_f32 v99, v102, v103
    v_exp_f32 v106, v106
    v_exp_f32 v107, v107
    v_cvt_pk_bf16_f32 v104, v104, v105
    v_exp_f32 v108, v108
    v_exp_f32 v109, v109
    v_cvt_pk_bf16_f32 v105, v106, v107
    v_exp_f32 v110, v110
    v_exp_f32 v111, v111
    v_cvt_pk_bf16_f32 v106, v108, v109
    buffer_store_dwordx4 v[80:83], v1, s[32:35], s3 offen offset:1024 sc1
    v_exp_f32 v112, v112
    v_exp_f32 v113, v113
    v_cvt_pk_bf16_f32 v107, v110, v111
    s_waitcnt lgkmcnt(0)
    v_mfma_f32_32x32x16_bf16 v[44:59], v[88:91], v[96:99], v[44:59]
    v_exp_f32 v114, v114
    v_exp_f32 v115, v115
    v_cvt_pk_bf16_f32 v112, v112, v113
    v_exp_f32 v116, v116
    v_exp_f32 v117, v117
    v_mfma_f32_32x32x16_bf16 v[44:59], v[92:95], v[104:107], v[44:59]
    v_cvt_pk_bf16_f32 v113, v114, v115
    v_exp_f32 v118, v118
    v_exp_f32 v119, v119
    v_cvt_pk_bf16_f32 v114, v116, v117
    v_mfma_f32_32x32x16_bf16 v[96:111], v[76:79], v[20:23], v[60:75]
    v_exp_f32 v120, v120
    v_exp_f32 v121, v121
    v_cvt_pk_bf16_f32 v115, v118, v119
    v_exp_f32 v122, v122
    v_exp_f32 v123, v123
    v_cvt_pk_bf16_f32 v120, v120, v121
    v_exp_f32 v124, v124
    v_exp_f32 v125, v125
    v_cvt_pk_bf16_f32 v121, v122, v123
    v_exp_f32 v126, v126
    v_exp_f32 v127, v127
    v_cvt_pk_bf16_f32 v122, v124, v125
    buffer_store_dwordx4 v[80:83], v1, s[32:35], s3 offen offset:2048 sc1
    v_exp_f32 v96, v96
    v_exp_f32 v97, v97
    v_cvt_pk_bf16_f32 v123, v126, v127
    s_waitcnt vmcnt(11)
    v_mfma_f32_32x32x16_bf16 v[28:43], v[88:91], v[112:115], v[28:43]
    ds_read_b128 v[88:91], v14 offset:37152
    v_exp_f32 v98, v98
    v_exp_f32 v99, v99
    v_cvt_pk_bf16_f32 v96, v96, v97
    v_exp_f32 v100, v100
    v_exp_f32 v101, v101
    v_mfma_f32_32x32x16_bf16 v[28:43], v[92:95], v[120:123], v[28:43]
    ds_read_b128 v[92:95], v15 offset:37152
    v_cvt_pk_bf16_f32 v97, v98, v99
    v_exp_f32 v102, v102
    v_exp_f32 v103, v103
    v_cvt_pk_bf16_f32 v98, v100, v101
    v_mfma_f32_32x32x16_bf16 v[112:127], v[76:79], v[24:27], v[60:75]
    ds_read_b128 v[76:79], v13 offset:39216
    v_exp_f32 v104, v104
    v_exp_f32 v105, v105
    v_cvt_pk_bf16_f32 v99, v102, v103
    v_exp_f32 v106, v106
    v_exp_f32 v107, v107
    v_cvt_pk_bf16_f32 v104, v104, v105
    v_exp_f32 v108, v108
    v_exp_f32 v109, v109
    v_cvt_pk_bf16_f32 v105, v106, v107
    v_exp_f32 v110, v110
    v_exp_f32 v111, v111
    v_cvt_pk_bf16_f32 v106, v108, v109
    buffer_store_dwordx4 v[80:83], v1, s[32:35], s3 offen offset:3072 sc1
    v_exp_f32 v112, v112
    v_exp_f32 v113, v113
    v_cvt_pk_bf16_f32 v107, v110, v111
    s_waitcnt lgkmcnt(0)
    v_mfma_f32_32x32x16_bf16 v[28:43], v[88:91], v[96:99], v[28:43]
    v_exp_f32 v114, v114
    v_exp_f32 v115, v115
    v_cvt_pk_bf16_f32 v112, v112, v113
    v_exp_f32 v116, v116
    v_exp_f32 v117, v117
    v_mfma_f32_32x32x16_bf16 v[28:43], v[92:95], v[104:107], v[28:43]
    v_cvt_pk_bf16_f32 v113, v114, v115
    v_exp_f32 v118, v118
    v_exp_f32 v119, v119
    v_cvt_pk_bf16_f32 v114, v116, v117
    v_mfma_f32_32x32x16_bf16 v[96:111], v[76:79], v[20:23], v[60:75]
    v_exp_f32 v120, v120
    v_exp_f32 v121, v121
    v_cvt_pk_bf16_f32 v115, v118, v119
    v_exp_f32 v122, v122
    v_exp_f32 v123, v123
    v_cvt_pk_bf16_f32 v120, v120, v121
    v_exp_f32 v124, v124
    v_exp_f32 v125, v125
    v_cvt_pk_bf16_f32 v121, v122, v123
    v_exp_f32 v126, v126
    v_exp_f32 v127, v127
    v_cvt_pk_bf16_f32 v122, v124, v125
    v_exp_f32 v96, v96
    v_exp_f32 v97, v97
    v_cvt_pk_bf16_f32 v123, v126, v127
    v_mfma_f32_32x32x16_bf16 v[44:59], v[88:91], v[112:115], v[44:59]
    ds_read_b128 v[88:91], v14 offset:39216
    v_exp_f32 v98, v98
    v_exp_f32 v99, v99
    v_cvt_pk_bf16_f32 v96, v96, v97
    v_exp_f32 v100, v100
    v_exp_f32 v101, v101
    v_mfma_f32_32x32x16_bf16 v[44:59], v[92:95], v[120:123], v[44:59]
    ds_read_b128 v[92:95], v15 offset:39216
    v_cvt_pk_bf16_f32 v97, v98, v99
    v_exp_f32 v102, v102
    v_exp_f32 v103, v103
    v_cvt_pk_bf16_f32 v98, v100, v101
    v_mfma_f32_32x32x16_bf16 v[112:127], v[76:79], v[24:27], v[60:75]
    v_exp_f32 v104, v104
    v_exp_f32 v105, v105
    v_cvt_pk_bf16_f32 v99, v102, v103
    v_exp_f32 v106, v106
    v_exp_f32 v107, v107
    v_cvt_pk_bf16_f32 v104, v104, v105
    v_exp_f32 v108, v108
    v_exp_f32 v109, v109
    v_cvt_pk_bf16_f32 v105, v106, v107
    v_exp_f32 v110, v110
    v_exp_f32 v111, v111
    v_cvt_pk_bf16_f32 v106, v108, v109
    v_exp_f32 v112, v112
    v_exp_f32 v113, v113
    v_cvt_pk_bf16_f32 v107, v110, v111
    s_waitcnt lgkmcnt(0)
    v_mfma_f32_32x32x16_bf16 v[28:43], v[88:91], v[96:99], v[28:43]
    v_exp_f32 v114, v114
    v_exp_f32 v115, v115
    v_cndmask_b32 v112, v112, 0, s[64:65]
    v_cndmask_b32 v113, v113, 0, s[66:67]
    v_cvt_pk_bf16_f32 v112, v112, v113
    v_exp_f32 v116, v116
    v_exp_f32 v117, v117
    v_mfma_f32_32x32x16_bf16 v[28:43], v[92:95], v[104:107], v[28:43]
    v_cndmask_b32 v114, v114, 0, s[68:69]
    v_cndmask_b32 v115, v115, 0, s[70:71]
    v_cvt_pk_bf16_f32 v113, v114, v115
    v_exp_f32 v118, v118
    v_exp_f32 v119, v119
    v_cndmask_b32 v116, v116, 0, s[72:73]
    v_cndmask_b32 v117, v117, 0, s[74:75]
    v_cvt_pk_bf16_f32 v114, v116, v117
    v_exp_f32 v120, v120
    v_exp_f32 v121, v121
    v_cndmask_b32 v118, v118, 0, s[76:77]
    v_cndmask_b32 v119, v119, 0, s[78:79]
    v_cvt_pk_bf16_f32 v115, v118, v119
    v_exp_f32 v122, v122
    v_exp_f32 v123, v123
    v_cndmask_b32 v120, v120, 0, s[80:81]
    v_cndmask_b32 v121, v121, 0, s[82:83]
    v_cvt_pk_bf16_f32 v120, v120, v121
    v_exp_f32 v124, v124
    v_exp_f32 v125, v125
    v_mfma_f32_32x32x16_bf16 v[44:59], v[88:91], v[112:115], v[44:59]
    v_cndmask_b32 v122, v122, 0, s[84:85]
    v_cndmask_b32 v123, v123, 0, s[86:87]
    v_cvt_pk_bf16_f32 v121, v122, v123
    v_exp_f32 v126, v126
    v_exp_f32 v127, v127
    v_cndmask_b32 v124, v124, 0, s[88:89]
    v_cndmask_b32 v125, v125, 0, s[90:91]
    v_cvt_pk_bf16_f32 v122, v124, v125
    s_add_u32 s4, s41, 2097152
    v_maximum3_f32 v84, abs(v28), abs(v29), v36
    v_rcp_f32 v36, v36
    v_maximum3_f32 v84, abs(v30), abs(v31), v84
    v_maximum3_f32 v84, abs(v32), abs(v33), v84
    v_maximum3_f32 v84, abs(v34), abs(v35), v84
    v_mul_f32 v28, v28, v36
    v_mul_f32 v29, v29, v36
    v_mul_f32 v30, v30, v36
    v_mul_f32 v31, v31, v36
    v_mul_f32 v32, v32, v36
    v_mul_f32 v33, v33, v36
    v_mul_f32 v34, v34, v36
    v_mul_f32 v35, v35, v36
    s_cmp_eq_u32 s53, 0
    v_cvt_pk_bf16_f32 v38, v28, v29
    v_cvt_pk_bf16_f32 v39, v30, v31
    v_cvt_pk_bf16_f32 v40, v32, v33
    v_cvt_pk_bf16_f32 v41, v34, v35
    s_cbranch_scc1 L_slow_25
    buffer_store_dwordx4 v[38:41], v7, s[32:35], s4 offen
L_back_26:
    v_cndmask_b32 v126, v126, 0, s[92:93]
    v_cndmask_b32 v127, v127, 0, s[94:95]
    v_cvt_pk_bf16_f32 v123, v126, v127
    s_nop 1
    v_mfma_f32_32x32x16_bf16 v[44:59], v[92:95], v[120:123], v[44:59]
    s_add_u32 s5, s4, 32768
    s_mov_b32 s40, 1
    s_cmp_eq_u32 s53, 0
    v_mov_b32 v70, s39
    v_min_u32 v71, 1, v0
    v_lshlrev_b32 v71, 26, v71
    s_nop 5
    v_rcp_f32 v52, v52
    s_nop 0
    v_pk_mul_f32 v[44:45], v[44:45], v[52:53] op_sel:[0,0] op_sel_hi:[1,0]
    v_pk_mul_f32 v[46:47], v[46:47], v[52:53] op_sel:[0,0] op_sel_hi:[1,0]
    v_pk_mul_f32 v[48:49], v[48:49], v[52:53] op_sel:[0,0] op_sel_hi:[1,0]
    v_pk_mul_f32 v[50:51], v[50:51], v[52:53] op_sel:[0,0] op_sel_hi:[1,0]
    v_cvt_pk_bf16_f32 v54, v44, v45
    v_cvt_pk_bf16_f32 v55, v46, v47
    v_cvt_pk_bf16_f32 v56, v48, v49
    v_cvt_pk_bf16_f32 v57, v50, v51
    s_cbranch_scc1 L_slow_27
    buffer_store_dwordx4 v[54:57], v7, s[32:35], s5 offen
L_back_28:
    v_maximum3_f32 v76, abs(v44), abs(v45), v84
    v_maximum3_f32 v77, abs(v46), abs(v47), v53
    v_maximum3_f32 v76, abs(v48), abs(v49), v76
    v_maximum3_f32 v77, abs(v50), abs(v51), v77
    v_maximum3_f32 v76, v76, v77, v77
    v_cmp_nlt_f32 vcc, v76, abs(v18)
    s_cbranch_vccnz L_fallback
L_fbdone1:
    s_lshl_b32 s6, s38, 11
    s_add_u32 s6, s6, 150144
    v_add_u32 v14, s6, v1
    ds_read_b128 v[60:63], v14
    ds_read_b128 v[64:67], v14 offset:1024
    v_xor_b32 v124, 32, v10
    v_xor_b32 v125, 64, v10
    v_xor_b32 v126, 96, v10
    s_add_u32 s6, s49, 2097152
    v_mov_b32 v15, v71
    v_mov_b32 v16, 0x3f803f80
    v_and_b32 v8, 7, v0
    v_lshlrev_b32 v8, 2, v8
    v_lshrrev_b32 v18, 4, v0
    v_min_u32 v18, 1, v18
    v_lshl_add_u32 v18, v18, 26, v1
    s_add_u32 s0, s39, 3
    s_waitcnt lgkmcnt(1)
    v_permlane16_swap_b32 v60, v62
    v_permlane16_swap_b32 v61, v63
    s_waitcnt lgkmcnt(0)
    v_permlane16_swap_b32 v64, v66
    v_permlane16_swap_b32 v65, v67
    v_lshlrev_b32 v20, 16, v60
    v_and_b32 v21, 0xffff0000, v60
    v_lshlrev_b32 v22, 16, v61
    v_and_b32 v23, 0xffff0000, v61
    v_lshlrev_b32 v24, 16, v62
    v_and_b32 v25, 0xffff0000, v62
    v_lshlrev_b32 v26, 16, v63
    v_and_b32 v27, 0xffff0000, v63
    v_lshlrev_b32 v28, 16, v64
    v_and_b32 v29, 0xffff0000, v64
    v_lshlrev_b32 v30, 16, v65
    v_and_b32 v31, 0xffff0000, v65
    v_lshlrev_b32 v32, 16, v66
    v_and_b32 v33, 0xffff0000, v66
    v_lshlrev_b32 v34, 16, v67
    v_and_b32 v35, 0xffff0000, v67
    s_cmp_eq_u32 s53, 0
    s_waitcnt vmcnt(0)
    s_barrier
    s_cbranch_scc1 L_slow_29
    buffer_store_dword v70, v71, s[32:35], s52 offen offset:32
L_back_30:
    s_xor_b32 s5, s6, 0
    buffer_load_dwordx4 v[36:39], v1, s[32:35], s5 offen offset:0 sc1
    buffer_load_dwordx4 v[40:43], v1, s[32:35], s5 offen offset:1024 sc1
    ds_read_b64_tr_b16 v[120:121], v124 offset:12288
    ds_read_b64_tr_b16 v[122:123], v124 offset:12544
    ds_read_b64_tr_b16 v[116:117], v10 offset:12288
    ds_read_b64_tr_b16 v[118:119], v10 offset:12544
    ds_read_b64_tr_b16 v[112:113], v126 offset:8192
    ds_read_b64_tr_b16 v[114:115], v126 offset:8448
    ds_read_b64_tr_b16 v[108:109], v125 offset:8192
    ds_read_b64_tr_b16 v[110:111], v125 offset:8448
    ds_read_b64_tr_b16 v[104:105], v124 offset:8192
    ds_read_b64_tr_b16 v[106:107], v124 offset:8448
    ds_read_b64_tr_b16 v[100:101], v10 offset:8192
    ds_read_b64_tr_b16 v[102:103], v10 offset:8448
    ds_read_b64_tr_b16 v[96:97], v126 offset:4096
    ds_read_b64_tr_b16 v[98:99], v126 offset:4352
    buffer_load_dword v127, v8, s[32:35], s51 offen offset:32 sc1
    ds_read_b64_tr_b16 v[92:93], v125 offset:4096
    ds_read_b64_tr_b16 v[94:95], v125 offset:4352
    ds_read_b64_tr_b16 v[88:89], v124 offset:4096
    ds_read_b64_tr_b16 v[90:91], v124 offset:4352
    ds_read_b64_tr_b16 v[84:85], v10 offset:4096
    ds_read_b64_tr_b16 v[86:87], v10 offset:4352
    ds_read_b64_tr_b16 v[80:81], v126 offset:0
    ds_read_b64_tr_b16 v[82:83], v126 offset:256
    ds_read_b64_tr_b16 v[76:77], v125 offset:0
    ds_read_b64_tr_b16 v[78:79], v125 offset:256
    ds_read_b64_tr_b16 v[72:73], v124 offset:0
    ds_read_b64_tr_b16 v[74:75], v124 offset:256
    ds_read_b64_tr_b16 v[68:69], v10 offset:0
    ds_read_b64_tr_b16 v[70:71], v10 offset:256
    buffer_load_dword v17, v8, s[32:35], s51 offen offset:32 sc1
L_mp_31:
    s_waitcnt vmcnt(1)
    v_cmp_ne_u32 vcc, s39, v127
    s_cbranch_vccz L_md_32
    buffer_load_dword v127, v8, s[32:35], s51 offen offset:32 sc1
    s_waitcnt vmcnt(1)
    v_cmp_ne_u32 vcc, s39, v17
    s_cbranch_vccz L_md_33
    buffer_load_dword v17, v8, s[32:35], s51 offen offset:32 sc1
    s_add_u32 s43, s43, 1
    s_cmp_lt_u32 s43, 0x20000
    s_cbranch_scc1 L_mp_31
    s_endpgm
L_md_32:
L_md_33:
    s_xor_b32 s5, s6, 2048
    buffer_load_dwordx4 v[44:47], v1, s[32:35], s5 offen offset:0 sc1
    buffer_load_dwordx4 v[48:51], v1, s[32:35], s5 offen offset:1024 sc1
    s_barrier
    s_xor_b32 s5, s6, 4096
    buffer_load_dwordx4 v[52:55], v1, s[32:35], s5 offen offset:0 sc1
    buffer_load_dwordx4 v[56:59], v1, s[32:35], s5 offen offset:1024 sc1
    s_barrier
    s_xor_b32 s5, s6, 6144
    buffer_load_dwordx4 v[60:63], v1, s[32:35], s5 offen offset:0 sc1
    buffer_load_dwordx4 v[64:67], v1, s[32:35], s5 offen offset:1024 sc1
    s_waitcnt lgkmcnt(0)
    v_mfma_f32_16x16x32_bf16 v[20:23], v[68:71], v[36:39], v[20:23]
    ds_read_b64_tr_b16 v[68:69], v125 offset:12288
    ds_read_b64_tr_b16 v[70:71], v125 offset:12544
    v_mfma_f32_16x16x32_bf16 v[24:27], v[72:75], v[36:39], v[24:27]
    ds_read_b64_tr_b16 v[72:73], v126 offset:12288
    ds_read_b64_tr_b16 v[74:75], v126 offset:12544
    v_mfma_f32_16x16x32_bf16 v[28:31], v[76:79], v[36:39], v[28:31]
    ds_read_b64_tr_b16 v[76:77], v10 offset:16384
    ds_read_b64_tr_b16 v[78:79], v10 offset:16640
    v_mfma_f32_16x16x32_bf16 v[32:35], v[80:83], v[36:39], v[32:35]
    ds_read_b64_tr_b16 v[80:81], v124 offset:16384
    ds_read_b64_tr_b16 v[82:83], v124 offset:16640
    s_xor_b32 s5, s6, 8192
    buffer_load_dwordx4 v[36:39], v1, s[32:35], s5 offen offset:0 sc1
    v_mfma_f32_16x16x32_bf16 v[20:23], v[84:87], v[40:43], v[20:23]
    ds_read_b64_tr_b16 v[84:85], v125 offset:16384
    ds_read_b64_tr_b16 v[86:87], v125 offset:16640
    v_mfma_f32_16x16x32_bf16 v[24:27], v[88:91], v[40:43], v[24:27]
    ds_read_b64_tr_b16 v[88:89], v126 offset:16384
    ds_read_b64_tr_b16 v[90:91], v126 offset:16640
    v_mfma_f32_16x16x32_bf16 v[28:31], v[92:95], v[40:43], v[28:31]
    ds_read_b64_tr_b16 v[92:93], v10 offset:20480
    ds_read_b64_tr_b16 v[94:95], v10 offset:20736
    v_mfma_f32_16x16x32_bf16 v[32:35], v[96:99], v[40:43], v[32:35]
    ds_read_b64_tr_b16 v[96:97], v124 offset:20480
    ds_read_b64_tr_b16 v[98:99], v124 offset:20736
L_pad5:
    s_cbranch_execz L_warm1
    buffer_load_dwordx4 v[40:43], v1, s[32:35], s5 offen offset:1024 sc1
    s_waitcnt vmcnt(7)
    v_mfma_f32_16x16x32_bf16 v[20:23], v[100:103], v[44:47], v[20:23]
    ds_read_b64_tr_b16 v[100:101], v125 offset:20480
    ds_read_b64_tr_b16 v[102:103], v125 offset:20736
    v_mfma_f32_16x16x32_bf16 v[24:27], v[104:107], v[44:47], v[24:27]
    ds_read_b64_tr_b16 v[104:105], v126 offset:20480
    ds_read_b64_tr_b16 v[106:107], v126 offset:20736
    v_mfma_f32_16x16x32_bf16 v[28:31], v[108:111], v[44:47], v[28:31]
    ds_read_b64_tr_b16 v[108:109], v10 offset:24576
    ds_read_b64_tr_b16 v[110:111], v10 offset:24832
    v_mfma_f32_16x16x32_bf16 v[32:35], v[112:115], v[44:47], v[32:35]
    ds_read_b64_tr_b16 v[112:113], v124 offset:24576
    ds_read_b64_tr_b16 v[114:115], v124 offset:24832
    s_xor_b32 s5, s6, 10240
    buffer_load_dwordx4 v[44:47], v1, s[32:35], s5 offen offset:0 sc1
    s_waitcnt vmcnt(7) lgkmcnt(14)
    v_mfma_f32_16x16x32_bf16 v[20:23], v[116:119], v[48:51], v[20:23]
    ds_read_b64_tr_b16 v[116:117], v125 offset:24576
    ds_read_b64_tr_b16 v[118:119], v125 offset:24832
    v_mfma_f32_16x16x32_bf16 v[24:27], v[120:123], v[48:51], v[24:27]
    ds_read_b64_tr_b16 v[120:121], v126 offset:24576
    ds_read_b64_tr_b16 v[122:123], v126 offset:24832
    v_mfma_f32_16x16x32_bf16 v[28:31], v[68:71], v[48:51], v[28:31]
    ds_read_b64_tr_b16 v[68:69], v10 offset:28672
    ds_read_b64_tr_b16 v[70:71], v10 offset:28928
    v_mfma_f32_16x16x32_bf16 v[32:35], v[72:75], v[48:51], v[32:35]
    ds_read_b64_tr_b16 v[72:73], v124 offset:28672
    ds_read_b64_tr_b16 v[74:75], v124 offset:28928
    buffer_load_dwordx4 v[48:51], v1, s[32:35], s5 offen offset:1024 sc1
    s_waitcnt vmcnt(7) lgkmcnt(14)
    v_mfma_f32_16x16x32_bf16 v[20:23], v[76:79], v[52:55], v[20:23]
    ds_read_b64_tr_b16 v[76:77], v125 offset:28672
    ds_read_b64_tr_b16 v[78:79], v125 offset:28928
    v_mfma_f32_16x16x32_bf16 v[24:27], v[80:83], v[52:55], v[24:27]
    ds_read_b64_tr_b16 v[80:81], v126 offset:28672
    ds_read_b64_tr_b16 v[82:83], v126 offset:28928
    v_mfma_f32_16x16x32_bf16 v[28:31], v[84:87], v[52:55], v[28:31]
    ds_read_b64_tr_b16 v[84:85], v10 offset:32768
    ds_read_b64_tr_b16 v[86:87], v10 offset:33024
    v_mfma_f32_16x16x32_bf16 v[32:35], v[88:91], v[52:55], v[32:35]
    ds_read_b64_tr_b16 v[88:89], v124 offset:32768
    ds_read_b64_tr_b16 v[90:91], v124 offset:33024
    s_xor_b32 s5, s6, 12288
    buffer_load_dwordx4 v[52:55], v1, s[32:35], s5 offen offset:0 sc1
    s_waitcnt vmcnt(7) lgkmcnt(14)
    v_mfma_f32_16x16x32_bf16 v[20:23], v[92:95], v[56:59], v[20:23]
    ds_read_b64_tr_b16 v[92:93], v125 offset:32768
    ds_read_b64_tr_b16 v[94:95], v125 offset:33024
    v_mfma_f32_16x16x32_bf16 v[24:27], v[96:99], v[56:59], v[24:27]
    ds_read_b64_tr_b16 v[96:97], v126 offset:32768
    ds_read_b64_tr_b16 v[98:99], v126 offset:33024
    v_mfma_f32_16x16x32_bf16 v[28:31], v[100:103], v[56:59], v[28:31]
    ds_read_b64_tr_b16 v[100:101], v10 offset:36864
    ds_read_b64_tr_b16 v[102:103], v10 offset:37120
    v_mfma_f32_16x16x32_bf16 v[32:35], v[104:107], v[56:59], v[32:35]
    ds_read_b64_tr_b16 v[104:105], v124 offset:36864
    ds_read_b64_tr_b16 v[106:107], v124 offset:37120
    buffer_load_dwordx4 v[56:59], v1, s[32:35], s5 offen offset:1024 sc1
    s_waitcnt vmcnt(7) lgkmcnt(14)
    v_mfma_f32_16x16x32_bf16 v[20:23], v[108:111], v[60:63], v[20:23]
    ds_read_b64_tr_b16 v[108:109], v125 offset:36864
    ds_read_b64_tr_b16 v[110:111], v125 offset:37120
    v_mfma_f32_16x16x32_bf16 v[24:27], v[112:115], v[60:63], v[24:27]
    ds_read_b64_tr_b16 v[112:113], v126 offset:36864
    ds_read_b64_tr_b16 v[114:115], v126 offset:37120
    v_mfma_f32_16x16x32_bf16 v[28:31], v[116:119], v[60:63], v[28:31]
    ds_read_b64_tr_b16 v[116:117], v10 offset:40960
    ds_read_b64_tr_b16 v[118:119], v10 offset:41216
    v_mfma_f32_16x16x32_bf16 v[32:35], v[120:123], v[60:63], v[32:35]
    ds_read_b64_tr_b16 v[120:121], v124 offset:40960
    ds_read_b64_tr_b16 v[122:123], v124 offset:41216
    s_xor_b32 s5, s6, 14336
    buffer_load_dwordx4 v[60:63], v1, s[32:35], s5 offen offset:0 sc1
    s_waitcnt vmcnt(7) lgkmcnt(14)
    v_mfma_f32_16x16x32_bf16 v[20:23], v[68:71], v[64:67], v[20:23]
    ds_read_b64_tr_b16 v[68:69], v125 offset:40960
    ds_read_b64_tr_b16 v[70:71], v125 offset:41216
    v_mfma_f32_16x16x32_bf16 v[24:27], v[72:75], v[64:67], v[24:27]
    ds_read_b64_tr_b16 v[72:73], v126 offset:40960
    ds_read_b64_tr_b16 v[74:75], v126 offset:41216
    v_mfma_f32_16x16x32_bf16 v[28:31], v[76:79], v[64:67], v[28:31]
    ds_read_b64_tr_b16 v[76:77], v10 offset:45056
    ds_read_b64_tr_b16 v[78:79], v10 offset:45312
    v_mfma_f32_16x16x32_bf16 v[32:35], v[80:83], v[64:67], v[32:35]
    ds_read_b64_tr_b16 v[80:81], v124 offset:45056
    ds_read_b64_tr_b16 v[82:83], v124 offset:45312
    buffer_load_dwordx4 v[64:67], v1, s[32:35], s5 offen offset:1024 sc1
    s_waitcnt vmcnt(7) lgkmcnt(14)
    v_mfma_f32_16x16x32_bf16 v[20:23], v[84:87], v[36:39], v[20:23]
    ds_read_b64_tr_b16 v[84:85], v125 offset:45056
    ds_read_b64_tr_b16 v[86:87], v125 offset:45312
    v_mfma_f32_16x16x32_bf16 v[24:27], v[88:91], v[36:39], v[24:27]
    ds_read_b64_tr_b16 v[88:89], v126 offset:45056
    ds_read_b64_tr_b16 v[90:91], v126 offset:45312
    v_mfma_f32_16x16x32_bf16 v[28:31], v[92:95], v[36:39], v[28:31]
    ds_read_b64_tr_b16 v[92:93], v10 offset:49152
    ds_read_b64_tr_b16 v[94:95], v10 offset:49408
    v_mfma_f32_16x16x32_bf16 v[32:35], v[96:99], v[36:39], v[32:35]
    ds_read_b64_tr_b16 v[96:97], v124 offset:49152
    ds_read_b64_tr_b16 v[98:99], v124 offset:49408
    s_waitcnt vmcnt(6) lgkmcnt(14)
    v_mfma_f32_16x16x32_bf16 v[20:23], v[100:103], v[40:43], v[20:23]
    ds_read_b64_tr_b16 v[100:101], v10 offset:53248
    ds_read_b64_tr_b16 v[102:103], v10 offset:53504
    v_mfma_f32_16x16x32_bf16 v[24:27], v[104:107], v[40:43], v[24:27]
    ds_read_b64_tr_b16 v[104:105], v124 offset:53248
    ds_read_b64_tr_b16 v[106:107], v124 offset:53504
    v_mfma_f32_16x16x32_bf16 v[28:31], v[108:111], v[40:43], v[28:31]
    ds_read_b64_tr_b16 v[108:109], v10 offset:57344
    ds_read_b64_tr_b16 v[110:111], v10 offset:57600
    v_mfma_f32_16x16x32_bf16 v[32:35], v[112:115], v[40:43], v[32:35]
    ds_read_b64_tr_b16 v[112:113], v124 offset:57344
    ds_read_b64_tr_b16 v[114:115], v124 offset:57600
    s_waitcnt vmcnt(5) lgkmcnt(14)
    v_mfma_f32_16x16x32_bf16 v[20:23], v[116:119], v[44:47], v[20:23]
    ds_read_b64_tr_b16 v[116:117], v10 offset:61440
    ds_read_b64_tr_b16 v[118:119], v10 offset:61696
    v_mfma_f32_16x16x32_bf16 v[24:27], v[120:123], v[44:47], v[24:27]
    ds_read_b64_tr_b16 v[120:121], v124 offset:61440
    ds_read_b64_tr_b16 v[122:123], v124 offset:61696
    v_mfma_f32_16x16x32_bf16 v[28:31], v[68:71], v[44:47], v[28:31]
    ds_read_b64_tr_b16 v[68:69], v125 offset:49152
    ds_read_b64_tr_b16 v[70:71], v125 offset:49408
    v_mfma_f32_16x16x32_bf16 v[32:35], v[72:75], v[44:47], v[32:35]
    ds_read_b64_tr_b16 v[72:73], v126 offset:49152
    ds_read_b64_tr_b16 v[74:75], v126 offset:49408
    s_waitcnt vmcnt(4) lgkmcnt(14)
    v_mfma_f32_16x16x32_bf16 v[20:23], v[76:79], v[48:51], v[20:23]
    ds_read_b64_tr_b16 v[76:77], v125 offset:53248
    ds_read_b64_tr_b16 v[78:79], v125 offset:53504
    v_mfma_f32_16x16x32_bf16 v[24:27], v[80:83], v[48:51], v[24:27]
    ds_read_b64_tr_b16 v[80:81], v126 offset:53248
    ds_read_b64_tr_b16 v[82:83], v126 offset:53504
    v_mfma_f32_16x16x32_bf16 v[28:31], v[84:87], v[48:51], v[28:31]
    ds_read_b64_tr_b16 v[84:85], v125 offset:57344
    ds_read_b64_tr_b16 v[86:87], v125 offset:57600
    v_mfma_f32_16x16x32_bf16 v[32:35], v[88:91], v[48:51], v[32:35]
    ds_read_b64_tr_b16 v[88:89], v126 offset:57344
    ds_read_b64_tr_b16 v[90:91], v126 offset:57600
    s_waitcnt vmcnt(2) lgkmcnt(14)
    v_mfma_f32_16x16x32_bf16 v[20:23], v[92:95], v[52:55], v[20:23]
    ds_read_b64_tr_b16 v[92:93], v125 offset:61440
    ds_read_b64_tr_b16 v[94:95], v125 offset:61696
    v_mfma_f32_16x16x32_bf16 v[24:27], v[96:99], v[52:55], v[24:27]
    ds_read_b64_tr_b16 v[96:97], v126 offset:61440
    ds_read_b64_tr_b16 v[98:99], v126 offset:61696
    v_mfma_f32_16x16x32_bf16 v[20:23], v[100:103], v[56:59], v[20:23]
    s_add_u32 s4, s49, 4194304
    v_mfma_f32_16x16x32_bf16 v[24:27], v[104:107], v[56:59], v[24:27]
    s_waitcnt vmcnt(0) lgkmcnt(14)
    v_mfma_f32_16x16x32_bf16 v[20:23], v[108:111], v[60:63], v[20:23]
    v_mfma_f32_16x16x32_bf16 v[24:27], v[112:115], v[60:63], v[24:27]
    v_mfma_f32_16x16x32_bf16 v[20:23], v[116:119], v[64:67], v[20:23]
    v_mfma_f32_16x16x32_bf16 v[24:27], v[120:123], v[64:67], v[24:27]
    s_waitcnt lgkmcnt(8)
    v_mfma_f32_16x16x32_bf16 v[28:31], v[68:71], v[52:55], v[28:31]
    v_mfma_f32_16x16x32_bf16 v[32:35], v[72:75], v[52:55], v[32:35]
    v_mfma_f32_16x16x32_bf16 v[28:31], v[76:79], v[56:59], v[28:31]
    s_nop 2
    v_cvt_pk_bf16_f32 v36, v20, v21
    v_cvt_pk_bf16_f32 v37, v22, v23
    v_mfma_f32_16x16x32_bf16 v[32:35], v[80:83], v[56:59], v[32:35]
    v_cvt_pk_bf16_f32 v38, v24, v25
    v_cvt_pk_bf16_f32 v39, v26, v27
    s_waitcnt lgkmcnt(0)
    v_mfma_f32_16x16x32_bf16 v[28:31], v[84:87], v[60:63], v[28:31]
    s_cmp_eq_u32 s53, 0
    v_permlane16_swap_b32 v36, v38
    v_mfma_f32_16x16x32_bf16 v[32:35], v[88:91], v[60:63], v[32:35]
    v_permlane16_swap_b32 v37, v39
    s_cbranch_scc1 L_slow_34
    buffer_store_dwordx4 v[36:39], v11, s[32:35], s4 offen offset:0
L_back_35:
    v_mfma_f32_16x16x32_bf16 v[28:31], v[92:95], v[64:67], v[28:31]
    v_mfma_f32_16x16x32_bf16 v[32:35], v[96:99], v[64:67], v[32:35]
    v_dot2_f32_bf16 v44, v36, v16, 0
    v_dot2_f32_bf16 v45, v36, v36, 0
    v_dot2_f32_bf16 v44, v37, v16, v44
    v_dot2_f32_bf16 v45, v37, v37, v45
    v_dot2_f32_bf16 v44, v38, v16, v44
    v_dot2_f32_bf16 v45, v38, v38, v45
    v_dot2_f32_bf16 v44, v39, v16, v44
    v_cvt_pk_bf16_f32 v40, v28, v29
    v_cvt_pk_bf16_f32 v41, v30, v31
    v_cvt_pk_bf16_f32 v42, v32, v33
    v_cvt_pk_bf16_f32 v43, v34, v35
    s_cmp_eq_u32 s53, 0
    v_permlane16_swap_b32 v40, v42
    v_permlane16_swap_b32 v41, v43
    s_cbranch_scc1 L_slow_36
    buffer_store_dwordx4 v[40:43], v11, s[32:35], s4 offen offset:1024
L_back_37:
    v_dot2_f32_bf16 v45, v39, v39, v45
    v_dot2_f32_bf16 v44, v40, v16, v44
    v_dot2_f32_bf16 v45, v40, v40, v45
    v_dot2_f32_bf16 v44, v41, v16, v44
    v_dot2_f32_bf16 v45, v41, v41, v45
    v_dot2_f32_bf16 v44, v42, v16, v44
    v_dot2_f32_bf16 v45, v42, v42, v45
    v_dot2_f32_bf16 v44, v43, v16, v44
    v_dot2_f32_bf16 v45, v43, v43, v45
    v_mov_b32 v46, s0
    v_mov_b32 v47, s0
    v_add_u32 v2, 65792, v1
    v_permlane32_swap_b32 v44, v45
    v_add_f32 v44, v44, v45
    v_mov_b32 v45, v44
    s_nop 1
    v_permlane16_swap_b32 v44, v45
    v_add_f32 v44, v44, v45
    v_mov_b32 v45, v44
    s_nop 1
    v_permlane32_swap_b32 v44, v45
    ds_write_b128 v14, v[36:39]
    ds_write_b128 v14, v[40:43] offset:1024
    s_lshl_b32 s6, s38, 11
    s_add_u32 s4, s41, 4194304
    s_add_u32 s3, s4, s6
    s_add_u32 m0, s6, 65792
    s_add_u32 s4, s4, s46
    s_add_u32 s5, s46, 65792
    s_and_b32 s6, s1, 0xfffff800
    v_lshlrev_b32 v119, 6, s38
    v_add_u32 v119, v119, v4
    s_cmp_eq_u32 s53, 0
    s_waitcnt vmcnt(0)
    s_cbranch_scc1 L_slow_38
    buffer_store_dwordx4 v[44:47], v18, s[32:35], s1 offen
L_back_39:
    s_waitcnt vmcnt(0)
    buffer_load_dwordx4 v[20:23], v1, s[32:35], s6 offen offset:0 sc1
    buffer_load_dwordx4 v[24:27], v1, s[32:35], s6 offen offset:1024 sc1
    v_mov_b32 v14, 0x358637bd
    v_mov_b32 v15, 0x3fb8aa3b
    v_mov_b32 v13, 0xb5c1a2a0
    v_and_b32 v16, 3, v0
    v_subrev_u32 v16, 1, v16
    v_ashrrev_i32 v16, 31, v16
    v_and_b32 v19, 0x3f803f80, v16
    v_and_b32 v18, 0x3f803f80, v16
    v_and_b32 v17, 0x3f803f80, v16
    v_and_b32 v16, 0x3f803f80, v16
    ds_read2_b32 v[104:105], v6 offset0:16 offset1:32
    s_branch L_xc_41
L_xp_40:
    buffer_load_dwordx4 v[20:23], v1, s[32:35], s6 offen offset:0 sc1
    buffer_load_dwordx4 v[24:27], v1, s[32:35], s6 offen offset:1024 sc1
    s_add_u32 s43, s43, 1
    s_cmp_ge_u32 s43, 0x20000
    s_cbranch_scc1 L_end
L_xc_41:
    s_waitcnt vmcnt(0)
    v_cmp_ne_u32 vcc, s0, v22
    v_cmp_ne_u32 s[96:97], s0, v26
    s_or_b64 exec, vcc, s[96:97]
    s_cbranch_scc1 L_xp_40
    s_mov_b64 exec, -1
    s_barrier
    v_add_f32 v112, v20, v24
    v_add_f32 v113, v21, v25
L_entry2:
    buffer_load_dwordx4 v1, s[32:35], s3 offen offset:0 sc1 lds
    buffer_load_dwordx4 v1, s[32:35], s3 offen offset:1024 sc1 lds
    s_add_u32 m0, m0, 8192
    s_add_u32 s3, s3, 8192
    v_permlane32_swap_b32 v112, v113
    v_add_f32 v112, v112, v113
    v_mov_b32 v113, v112
    s_barrier
    buffer_load_dwordx4 v1, s[32:35], s3 offen offset:0 sc1 lds
    buffer_load_dwordx4 v1, s[32:35], s3 offen offset:1024 sc1 lds
    s_add_u32 m0, s5, 16384
    s_add_u32 s3, s4, 16384
    v_permlane16_swap_b32 v112, v113
    v_add_f32 v112, v112, v113
    v_mov_b32 v113, v112
    s_barrier
    s_nop 0
    v_permlane32_swap_b32 v112, v113
    buffer_load_dwordx4 v1, s[32:35], s3 offen offset:0 sc1 lds
    v_mul_f32 v112, 0xbb000000, v112
    v_mul_f32 v113, 0x3b000000, v113
    v_fma_f32 v113, -v112, v112, v113
    buffer_load_dwordx4 v1, s[32:35], s3 offen offset:1024 sc1 lds
    v_max_f32 v113, 0, v113
    v_add_f32 v113, 0x3727c5ac, v113
    v_rsq_f32 v114, v113
    buffer_load_dwordx4 v1, s[32:35], s3 offen offset:2048 sc1 lds
    v_mul_f32 v112, v112, v114
    ds_write2st64_b32 v119, v114, v112 offset0:0 offset1:1
    s_waitcnt vmcnt(5) lgkmcnt(0)
    s_barrier
    ds_read_b128 v[36:39], v2 offset:0
    ds_read_b128 v[40:43], v2 offset:1024
    ds_read_b128 v[44:47], v2 offset:2048
    ds_read_b128 v[48:51], v2 offset:3072
    ds_read_b128 v[52:55], v2 offset:4096
    ds_read_b128 v[56:59], v2 offset:5120
    ds_read_b128 v[60:63], v2 offset:6144
    s_waitcnt lgkmcnt(6)
    v_mfma_f32_16x16x32_bf16 v[20:23], v[36:39], a[0:3], 0
    buffer_load_dwordx4 v1, s[32:35], s3 offen offset:3072 sc1 lds
    v_mfma_f32_16x16x32_bf16 v[24:27], v[36:39], a[64:67], 0
    ds_read_b128 v[64:67], v2 offset:7168
    v_xor_b32 v116, 32, v9
    s_waitcnt lgkmcnt(6)
    v_mfma_f32_16x16x32_bf16 v[20:23], v[40:43], a[4:7], v[20:23]
    v_xor_b32 v117, 64, v9
    v_xor_b32 v118, 96, v9
    v_mfma_f32_16x16x32_bf16 v[24:27], v[40:43], a[68:71], v[24:27]
    s_add_u32 m0, s5, 32768
    s_add_u32 s3, s4, 32768
    s_waitcnt lgkmcnt(5)
    v_mfma_f32_16x16x32_bf16 v[20:23], v[44:47], a[8:11], v[20:23]
    buffer_load_dwordx4 v1, s[32:35], s3 offen offset:0 sc1 lds
    v_mfma_f32_16x16x32_bf16 v[24:27], v[44:47], a[72:75], v[24:27]
    s_waitcnt lgkmcnt(4)
    v_mfma_f32_16x16x32_bf16 v[20:23], v[48:51], a[12:15], v[20:23]
    v_mfma_f32_16x16x32_bf16 v[24:27], v[48:51], a[76:79], v[24:27]
    s_waitcnt vmcnt(5)
    s_barrier
    ds_read_b128 v[36:39], v2 offset:8192
    ds_read_b128 v[40:43], v2 offset:9216
    ds_read_b128 v[44:47], v2 offset:10240
    s_waitcnt lgkmcnt(3)
    v_mfma_f32_16x16x32_bf16 v[20:23], v[52:55], a[16:19], v[20:23]
    buffer_load_dwordx4 v1, s[32:35], s3 offen offset:1024 sc1 lds
    v_mfma_f32_16x16x32_bf16 v[24:27], v[52:55], a[80:83], v[24:27]
    ds_read_b128 v[48:51], v2 offset:11264
    ds_read_b128 v[72:75], v3 offset:256
    v_mfma_f32_16x16x32_bf16 v[20:23], v[56:59], a[20:23], v[20:23]
    ds_read_b128 v[68:71], v3 offset:0
    v_mfma_f32_16x16x32_bf16 v[24:27], v[56:59], a[84:87], v[24:27]
    ds_read_b128 v[52:55], v2 offset:12288
    v_mfma_f32_16x16x32_bf16 v[20:23], v[60:63], a[24:27], v[20:23]
    buffer_load_dwordx4 v1, s[32:35], s3 offen offset:2048 sc1 lds
    v_mfma_f32_16x16x32_bf16 v[24:27], v[60:63], a[88:91], v[24:27]
    ds_read_b128 v[56:59], v2 offset:13312
    v_mfma_f32_16x16x32_bf16 v[20:23], v[64:67], a[28:31], v[20:23]
    v_mfma_f32_16x16x32_bf16 v[24:27], v[64:67], a[92:95], v[24:27]
    ds_read_b128 v[60:63], v2 offset:14336
    s_waitcnt lgkmcnt(5)
    v_mfma_f32_16x16x32_bf16 v[20:23], v[36:39], a[32:35], v[20:23]
    buffer_load_dwordx4 v1, s[32:35], s3 offen offset:3072 sc1 lds
    v_mfma_f32_16x16x32_bf16 v[24:27], v[36:39], a[96:99], v[24:27]
    ds_read_b128 v[64:67], v2 offset:15360
    s_waitcnt lgkmcnt(4)
    v_mfma_f32_16x16x32_bf16 v[20:23], v[40:43], a[36:39], v[20:23]
    v_fma_f32 v108, v72, v104, v14
    v_fma_f32 v109, v73, v104, v14
    v_mfma_f32_16x16x32_bf16 v[24:27], v[40:43], a[100:103], v[24:27]
    s_add_u32 m0, s5, 49152
    s_add_u32 s3, s4, 49152
    v_mfma_f32_16x16x32_bf16 v[20:23], v[44:47], a[40:43], v[20:23]
    buffer_load_dwordx4 v1, s[32:35], s3 offen offset:0 sc1 lds
    v_mfma_f32_16x16x32_bf16 v[24:27], v[44:47], a[104:107], v[24:27]
    v_fma_f32 v110, v74, v104, v14
    v_fma_f32 v111, v75, v104, v14
    v_mfma_f32_16x16x32_bf16 v[20:23], v[48:51], a[44:47], v[20:23]
    v_mul_f32 v72, v72, v105
    v_mul_f32 v73, v73, v105
    v_mfma_f32_16x16x32_bf16 v[24:27], v[48:51], a[108:111], v[24:27]
    s_waitcnt vmcnt(5)
    s_barrier
    ds_read_b128 v[36:39], v2 offset:16384
    ds_read_b128 v[40:43], v2 offset:17408
    ds_read_b128 v[44:47], v2 offset:18432
    s_waitcnt lgkmcnt(3)
    v_mfma_f32_16x16x32_bf16 v[20:23], v[52:55], a[48:51], v[20:23]
    buffer_load_dwordx4 v1, s[32:35], s3 offen offset:1024 sc1 lds
    v_mfma_f32_16x16x32_bf16 v[24:27], v[52:55], a[112:115], v[24:27]
    ds_read_b128 v[48:51], v2 offset:19456
    v_mul_f32 v74, v74, v105
    v_mfma_f32_16x16x32_bf16 v[20:23], v[56:59], a[52:55], v[20:23]
    v_mul_f32 v75, v75, v105
    v_mfma_f32_16x16x32_bf16 v[24:27], v[56:59], a[116:119], v[24:27]
    ds_read_b128 v[52:55], v2 offset:20480
    v_mfma_f32_16x16x32_bf16 v[20:23], v[60:63], a[56:59], v[20:23]
    buffer_load_dwordx4 v1, s[32:35], s3 offen offset:2048 sc1 lds
    v_mfma_f32_16x16x32_bf16 v[24:27], v[60:63], a[120:123], v[24:27]
    ds_read_b128 v[56:59], v2 offset:21504
    v_mfma_f32_16x16x32_bf16 v[20:23], v[64:67], a[60:63], v[20:23]
    v_mfma_f32_16x16x32_bf16 v[24:27], v[64:67], a[124:127], v[24:27]
    ds_read_b128 v[60:63], v2 offset:22528
    s_waitcnt lgkmcnt(3)
    v_mfma_f32_16x16x32_bf16 v[28:31], v[36:39], a[0:3], 0
    buffer_load_dwordx4 v1, s[32:35], s3 offen offset:3072 sc1 lds
    v_mfma_f32_16x16x32_bf16 v[32:35], v[36:39], a[64:67], 0
    ds_read_b128 v[64:67], v2 offset:23552
    v_mfma_f32_16x16x32_bf16 v[28:31], v[40:43], a[4:7], v[28:31]
    v_fma_f32 v20, v20, v68, v108
    v_fma_f32 v21, v21, v69, v109
    v_fma_f32 v22, v22, v70, v110
    v_mfma_f32_16x16x32_bf16 v[32:35], v[40:43], a[68:71], v[32:35]
    s_add_u32 m0, s44, 0
    s_xor_b32 s7, s47, 0
    ds_read_b128 v[36:39], v2 offset:24576
    v_mfma_f32_16x16x32_bf16 v[28:31], v[44:47], a[8:11], v[28:31]
    buffer_load_dwordx4 v9, s[16:19], s7 offen offset:0 lds
    v_fma_f32 v23, v23, v71, v111
    v_mfma_f32_16x16x32_bf16 v[32:35], v[44:47], a[72:75], v[32:35]
    ds_read_b128 v[40:43], v2 offset:25600
    v_fma_f32 v24, v24, v68, v72
    v_fma_f32 v25, v25, v69, v73
    v_mfma_f32_16x16x32_bf16 v[28:31], v[48:51], a[12:15], v[28:31]
    v_fma_f32 v26, v26, v70, v74
    v_fma_f32 v27, v27, v71, v75
    ds_read_b128 v[72:75], v3 offset:320
    v_mfma_f32_16x16x32_bf16 v[32:35], v[48:51], a[76:79], v[32:35]
    ds_read_b128 v[44:47], v2 offset:26624
    ds_read_b128 v[68:71], v3 offset:64
    s_waitcnt lgkmcnt(5)
    v_mfma_f32_16x16x32_bf16 v[28:31], v[52:55], a[16:19], v[28:31]
    buffer_load_dwordx4 v116, s[16:19], s7 offen offset:1024 lds
    v_fma_f32 v76, v20, v15, v13
    v_mfma_f32_16x16x32_bf16 v[32:35], v[52:55], a[80:83], v[32:35]
    ds_read_b128 v[48:51], v2 offset:27648
    v_fma_f32 v77, v21, v15, v13
    v_fma_f32 v78, v22, v15, v13
    v_mfma_f32_16x16x32_bf16 v[28:31], v[56:59], a[20:23], v[28:31]
    v_fma_f32 v79, v23, v15, v13
    v_cvt_pk_bf16_f32 v88, v24, v25
    v_cvt_pk_bf16_f32 v89, v26, v27
    v_mfma_f32_16x16x32_bf16 v[32:35], v[56:59], a[84:87], v[32:35]
    ds_read_b128 v[52:55], v2 offset:28672
    v_exp_f32_e64 v76, v76 clamp
    v_mfma_f32_16x16x32_bf16 v[28:31], v[60:63], a[24:27], v[28:31]
    buffer_load_dwordx4 v117, s[16:19], s7 offen offset:2048 lds
    v_max_f32 v20, v20, v14
    v_mfma_f32_16x16x32_bf16 v[32:35], v[60:63], a[88:91], v[32:35]
    ds_read_b128 v[56:59], v2 offset:29696
    v_exp_f32_e64 v77, v77 clamp
    v_mfma_f32_16x16x32_bf16 v[28:31], v[64:67], a[28:31], v[28:31]
    v_max_f32 v21, v21, v14
    v_exp_f32_e64 v78, v78 clamp
    v_mfma_f32_16x16x32_bf16 v[32:35], v[64:67], a[92:95], v[32:35]
    ds_read_b128 v[60:63], v2 offset:30720
    v_max_f32 v22, v22, v14
    s_waitcnt lgkmcnt(3)
    v_mfma_f32_16x16x32_bf16 v[28:31], v[36:39], a[32:35], v[28:31]
    buffer_load_dwordx4 v118, s[16:19], s7 offen offset:3072 lds
    v_exp_f32_e64 v79, v79 clamp
    v_mfma_f32_16x16x32_bf16 v[32:35], v[36:39], a[96:99], v[32:35]
    ds_read_b128 v[64:67], v2 offset:31744
    v_max_f32 v23, v23, v14
    v_add_f32 v20, v20, v76
    v_mfma_f32_16x16x32_bf16 v[28:31], v[40:43], a[36:39], v[28:31]
    v_add_f32 v21, v21, v77
    v_add_f32 v22, v22, v78
    v_add_f32 v23, v23, v79
    v_mfma_f32_16x16x32_bf16 v[32:35], v[40:43], a[100:103], v[32:35]
    s_add_u32 m0, s44, 4096
    s_xor_b32 s7, s47, 32768
    s_waitcnt vmcnt(8)
    s_barrier
    ds_read_b128 v[36:39], v2 offset:32768
    v_mfma_f32_16x16x32_bf16 v[28:31], v[44:47], a[40:43], v[28:31]
    buffer_load_dwordx4 v9, s[16:19], s7 offen offset:0 lds
    v_mfma_f32_16x16x32_bf16 v[32:35], v[44:47], a[104:107], v[32:35]
    ds_read_b128 v[40:43], v2 offset:33792
    v_cvt_pk_bf16_f32 v80, v20, v21
    v_mfma_f32_16x16x32_bf16 v[28:31], v[48:51], a[44:47], v[28:31]
    v_cvt_pk_bf16_f32 v81, v22, v23
    v_mfma_f32_16x16x32_bf16 v[32:35], v[48:51], a[108:111], v[32:35]
    ds_read_b128 v[44:47], v2 offset:34816
    s_waitcnt lgkmcnt(3)
    v_mfma_f32_16x16x32_bf16 v[28:31], v[52:55], a[48:51], v[28:31]
    buffer_load_dwordx4 v116, s[16:19], s7 offen offset:1024 lds
    v_mfma_f32_16x16x32_bf16 v[32:35], v[52:55], a[112:115], v[32:35]
    ds_read_b128 v[48:51], v2 offset:35840
    v_fma_f32 v108, v72, v104, v14
    v_mfma_f32_16x16x32_bf16 v[28:31], v[56:59], a[52:55], v[28:31]
    v_fma_f32 v109, v73, v104, v14
    v_fma_f32 v110, v74, v104, v14
    v_mfma_f32_16x16x32_bf16 v[32:35], v[56:59], a[116:119], v[32:35]
    ds_read_b128 v[52:55], v2 offset:36864
    v_fma_f32 v111, v75, v104, v14
    v_mfma_f32_16x16x32_bf16 v[28:31], v[60:63], a[56:59], v[28:31]
    buffer_load_dwordx4 v117, s[16:19], s7 offen offset:2048 lds
    v_mfma_f32_16x16x32_bf16 v[32:35], v[60:63], a[120:123], v[32:35]
    ds_read_b128 v[56:59], v2 offset:37888
    v_mul_f32 v72, v72, v105
    v_mfma_f32_16x16x32_bf16 v[28:31], v[64:67], a[60:63], v[28:31]
    v_mul_f32 v73, v73, v105
    v_mul_f32 v74, v74, v105
    v_mfma_f32_16x16x32_bf16 v[32:35], v[64:67], a[124:127], v[32:35]
    ds_read_b128 v[60:63], v2 offset:38912
    v_mul_f32 v75, v75, v105
    s_waitcnt lgkmcnt(3)
    v_mfma_f32_16x16x32_bf16 v[20:23], v[36:39], a[0:3], 0
    buffer_load_dwordx4 v118, s[16:19], s7 offen offset:3072 lds
    v_mfma_f32_16x16x32_bf16 v[24:27], v[36:39], a[64:67], 0
    ds_read_b128 v[64:67], v2 offset:39936
    v_mfma_f32_16x16x32_bf16 v[20:23], v[40:43], a[4:7], v[20:23]
    v_fma_f32 v28, v28, v68, v108
    v_fma_f32 v29, v29, v69, v109
    v_fma_f32 v30, v30, v70, v110
    v_mfma_f32_16x16x32_bf16 v[24:27], v[40:43], a[68:71], v[24:27]
    s_add_u32 m0, s44, 8192
    s_xor_b32 s7, s47, 65536
    ds_read_b128 v[36:39], v2 offset:40960
    v_mfma_f32_16x16x32_bf16 v[20:23], v[44:47], a[8:11], v[20:23]
    buffer_load_dwordx4 v9, s[16:19], s7 offen offset:0 lds
    v_fma_f32 v31, v31, v71, v111
    v_mfma_f32_16x16x32_bf16 v[24:27], v[44:47], a[72:75], v[24:27]
    ds_read_b128 v[40:43], v2 offset:41984
    v_fma_f32 v32, v32, v68, v72
    v_fma_f32 v33, v33, v69, v73
    v_mfma_f32_16x16x32_bf16 v[20:23], v[48:51], a[12:15], v[20:23]
    v_fma_f32 v34, v34, v70, v74
    v_fma_f32 v35, v35, v71, v75
    ds_read_b128 v[72:75], v3 offset:384
    v_mfma_f32_16x16x32_bf16 v[24:27], v[48:51], a[76:79], v[24:27]
    ds_read_b128 v[44:47], v2 offset:43008
    ds_read_b128 v[68:71], v3 offset:128
    s_waitcnt lgkmcnt(5)
    v_mfma_f32_16x16x32_bf16 v[20:23], v[52:55], a[16:19], v[20:23]
    buffer_load_dwordx4 v116, s[16:19], s7 offen offset:1024 lds
    v_fma_f32 v76, v28, v15, v13
    v_mfma_f32_16x16x32_bf16 v[24:27], v[52:55], a[80:83], v[24:27]
    ds_read_b128 v[48:51], v2 offset:44032
    v_fma_f32 v77, v29, v15, v13
    v_fma_f32 v78, v30, v15, v13
    v_mfma_f32_16x16x32_bf16 v[20:23], v[56:59], a[20:23], v[20:23]
    v_fma_f32 v79, v31, v15, v13
    v_cvt_pk_bf16_f32 v90, v32, v33
    v_cvt_pk_bf16_f32 v91, v34, v35
    v_mfma_f32_16x16x32_bf16 v[24:27], v[56:59], a[84:87], v[24:27]
    ds_read_b128 v[52:55], v2 offset:45056
    v_exp_f32_e64 v76, v76 clamp
    v_mfma_f32_16x16x32_bf16 v[20:23], v[60:63], a[24:27], v[20:23]
    buffer_load_dwordx4 v117, s[16:19], s7 offen offset:2048 lds
    v_max_f32 v28, v28, v14
    v_mfma_f32_16x16x32_bf16 v[24:27], v[60:63], a[88:91], v[24:27]
    ds_read_b128 v[56:59], v2 offset:46080
    v_exp_f32_e64 v77, v77 clamp
    v_mfma_f32_16x16x32_bf16 v[20:23], v[64:67], a[28:31], v[20:23]
    v_max_f32 v29, v29, v14
    v_exp_f32_e64 v78, v78 clamp
    v_mfma_f32_16x16x32_bf16 v[24:27], v[64:67], a[92:95], v[24:27]
    ds_read_b128 v[60:63], v2 offset:47104
    s_waitcnt lgkmcnt(3)
    v_mfma_f32_16x16x32_bf16 v[20:23], v[36:39], a[32:35], v[20:23]
    buffer_load_dwordx4 v118, s[16:19], s7 offen offset:3072 lds
    v_mfma_f32_16x16x32_bf16 v[24:27], v[36:39], a[96:99], v[24:27]
    ds_read_b128 v[64:67], v2 offset:48128
    v_max_f32 v30, v30, v14
    v_mfma_f32_16x16x32_bf16 v[20:23], v[40:43], a[36:39], v[20:23]
    v_exp_f32_e64 v79, v79 clamp
    v_mfma_f32_16x16x32_bf16 v[24:27], v[40:43], a[100:103], v[24:27]
    s_waitcnt vmcnt(12)
    s_barrier
    ds_read_b128 v[36:39], v2 offset:49152
    v_mfma_f32_16x16x32_bf16 v[20:23], v[44:47], a[40:43], v[20:23]
    v_max_f32 v31, v31, v14
    v_add_f32 v28, v28, v76
    v_mfma_f32_16x16x32_bf16 v[24:27], v[44:47], a[104:107], v[24:27]
    ds_read_b128 v[40:43], v2 offset:50176
    v_add_f32 v29, v29, v77
    v_mfma_f32_16x16x32_bf16 v[20:23], v[48:51], a[44:47], v[20:23]
    v_add_f32 v30, v30, v78
    v_add_f32 v31, v31, v79
    v_mfma_f32_16x16x32_bf16 v[24:27], v[48:51], a[108:111], v[24:27]
    ds_read_b128 v[44:47], v2 offset:51200
    s_waitcnt lgkmcnt(3)
    v_mfma_f32_16x16x32_bf16 v[20:23], v[52:55], a[48:51], v[20:23]
    v_cvt_pk_bf16_f32 v82, v28, v29
    v_cvt_pk_bf16_f32 v83, v30, v31
    v_mfma_f32_16x16x32_bf16 v[24:27], v[52:55], a[112:115], v[24:27]
    ds_read_b128 v[48:51], v2 offset:52224
    v_mfma_f32_16x16x32_bf16 v[20:23], v[56:59], a[52:55], v[20:23]
    v_fma_f32 v108, v72, v104, v14
    v_fma_f32 v109, v73, v104, v14
    v_mfma_f32_16x16x32_bf16 v[24:27], v[56:59], a[116:119], v[24:27]
    ds_read_b128 v[52:55], v2 offset:53248
    v_fma_f32 v110, v74, v104, v14
    v_mfma_f32_16x16x32_bf16 v[20:23], v[60:63], a[56:59], v[20:23]
    v_fma_f32 v111, v75, v104, v14
L_pad6:
    s_cbranch_execz L_warm1
    v_mul_f32 v72, v72, v105
    v_mfma_f32_16x16x32_bf16 v[24:27], v[60:63], a[120:123], v[24:27]
    ds_read_b128 v[56:59], v2 offset:54272
    v_mul_f32 v73, v73, v105
    v_mfma_f32_16x16x32_bf16 v[20:23], v[64:67], a[60:63], v[20:23]
    v_mul_f32 v74, v74, v105
    v_mul_f32 v75, v75, v105
    v_mfma_f32_16x16x32_bf16 v[24:27], v[64:67], a[124:127], v[24:27]
    ds_read_b128 v[60:63], v2 offset:55296
    s_waitcnt lgkmcnt(3)
    v_mfma_f32_16x16x32_bf16 v[28:31], v[36:39], a[0:3], 0
    v_mfma_f32_16x16x32_bf16 v[96:99], v[80:83], v[88:91], 0
    v_mfma_f32_16x16x32_bf16 v[100:103], v[80:83], v[16:19], 0
    v_mfma_f32_16x16x32_bf16 v[32:35], v[36:39], a[64:67], 0
    ds_read_b128 v[64:67], v2 offset:56320
    v_mfma_f32_16x16x32_bf16 v[28:31], v[40:43], a[4:7], v[28:31]
    v_fma_f32 v20, v20, v68, v108
    v_fma_f32 v21, v21, v69, v109
    v_mfma_f32_16x16x32_bf16 v[32:35], v[40:43], a[68:71], v[32:35]
    ds_read_b128 v[36:39], v2 offset:57344
    v_fma_f32 v22, v22, v70, v110
    v_mfma_f32_16x16x32_bf16 v[28:31], v[44:47], a[8:11], v[28:31]
    v_fma_f32 v23, v23, v71, v111
    v_fma_f32 v24, v24, v68, v72
    v_mfma_f32_16x16x32_bf16 v[32:35], v[44:47], a[72:75], v[32:35]
    ds_read_b128 v[40:43], v2 offset:58368
    v_fma_f32 v25, v25, v69, v73
    v_mfma_f32_16x16x32_bf16 v[28:31], v[48:51], a[12:15], v[28:31]
    v_fma_f32 v26, v26, v70, v74
    v_fma_f32 v27, v27, v71, v75
    v_mfma_f32_16x16x32_bf16 v[32:35], v[48:51], a[76:79], v[32:35]
    ds_read_b128 v[44:47], v2 offset:59392
    s_waitcnt lgkmcnt(3)
    v_mfma_f32_16x16x32_bf16 v[28:31], v[52:55], a[16:19], v[28:31]
    ds_read_b128 v[72:75], v3 offset:448
    ds_read_b128 v[68:71], v3 offset:192
    v_mfma_f32_16x16x32_bf16 v[32:35], v[52:55], a[80:83], v[32:35]
    ds_read_b128 v[48:51], v2 offset:60416
    v_fma_f32 v76, v20, v15, v13
    v_mfma_f32_16x16x32_bf16 v[28:31], v[56:59], a[20:23], v[28:31]
    v_fma_f32 v77, v21, v15, v13
    v_fma_f32 v78, v22, v15, v13
    v_mfma_f32_16x16x32_bf16 v[32:35], v[56:59], a[84:87], v[32:35]
    ds_read_b128 v[52:55], v2 offset:61440
    v_fma_f32 v79, v23, v15, v13
    v_mfma_f32_16x16x32_bf16 v[28:31], v[60:63], a[24:27], v[28:31]
    v_cvt_pk_bf16_f32 v92, v24, v25
    v_cvt_pk_bf16_f32 v93, v26, v27
    v_mfma_f32_16x16x32_bf16 v[32:35], v[60:63], a[88:91], v[32:35]
    ds_read_b128 v[56:59], v2 offset:62464
    v_mfma_f32_16x16x32_bf16 v[28:31], v[64:67], a[28:31], v[28:31]
    v_exp_f32_e64 v76, v76 clamp
    v_mfma_f32_16x16x32_bf16 v[32:35], v[64:67], a[92:95], v[32:35]
    ds_read_b128 v[60:63], v2 offset:63488
    s_waitcnt lgkmcnt(3)
    v_mfma_f32_16x16x32_bf16 v[28:31], v[36:39], a[32:35], v[28:31]
    v_max_f32 v20, v20, v14
    v_mfma_f32_16x16x32_bf16 v[32:35], v[36:39], a[96:99], v[32:35]
    ds_read_b128 v[64:67], v2 offset:64512
    v_mfma_f32_16x16x32_bf16 v[28:31], v[40:43], a[36:39], v[28:31]
    v_exp_f32_e64 v77, v77 clamp
    v_mfma_f32_16x16x32_bf16 v[32:35], v[40:43], a[100:103], v[32:35]
    v_max_f32 v21, v21, v14
    v_mfma_f32_16x16x32_bf16 v[28:31], v[44:47], a[40:43], v[28:31]
    v_exp_f32_e64 v78, v78 clamp
    v_mfma_f32_16x16x32_bf16 v[32:35], v[44:47], a[104:107], v[32:35]
    v_max_f32 v22, v22, v14
    v_mfma_f32_16x16x32_bf16 v[28:31], v[48:51], a[44:47], v[28:31]
    v_exp_f32_e64 v79, v79 clamp
    v_mfma_f32_16x16x32_bf16 v[32:35], v[48:51], a[108:111], v[32:35]
    v_max_f32 v23, v23, v14
    s_waitcnt lgkmcnt(0)
    v_mfma_f32_16x16x32_bf16 v[28:31], v[52:55], a[48:51], v[28:31]
    v_add_f32 v20, v20, v76
    v_add_f32 v21, v21, v77
    v_mfma_f32_16x16x32_bf16 v[32:35], v[52:55], a[112:115], v[32:35]
    v_add_f32 v22, v22, v78
    v_add_f32 v23, v23, v79
    v_mfma_f32_16x16x32_bf16 v[28:31], v[56:59], a[52:55], v[28:31]
    v_cvt_pk_bf16_f32 v84, v20, v21
    v_cvt_pk_bf16_f32 v85, v22, v23
    v_mfma_f32_16x16x32_bf16 v[32:35], v[56:59], a[116:119], v[32:35]
    v_fma_f32 v108, v72, v104, v14
    v_mfma_f32_16x16x32_bf16 v[28:31], v[60:63], a[56:59], v[28:31]
    v_fma_f32 v109, v73, v104, v14
    v_fma_f32 v110, v74, v104, v14
    v_mfma_f32_16x16x32_bf16 v[32:35], v[60:63], a[120:123], v[32:35]
    v_fma_f32 v111, v75, v104, v14
    v_mul_f32 v72, v72, v105
    v_mfma_f32_16x16x32_bf16 v[28:31], v[64:67], a[60:63], v[28:31]
    v_mul_f32 v73, v73, v105
    v_mul_f32 v74, v74, v105
    v_mfma_f32_16x16x32_bf16 v[32:35], v[64:67], a[124:127], v[32:35]
    v_mul_f32 v75, v75, v105
    s_nop 3
    v_pk_fma_f32 v[28:29], v[28:29], v[68:69], v[108:109] op_sel:[0,0,0] op_sel_hi:[1,1,1]
    v_pk_fma_f32 v[30:31], v[30:31], v[70:71], v[110:111] op_sel:[0,0,0] op_sel_hi:[1,1,1]
    s_nop 0
    v_pk_fma_f32 v[32:33], v[32:33], v[68:69], v[72:73] op_sel:[0,0,0] op_sel_hi:[1,1,1]
    v_pk_fma_f32 v[34:35], v[34:35], v[70:71], v[74:75] op_sel:[0,0,0] op_sel_hi:[1,1,1]
    v_pk_fma_f32 v[108:109], v[28:29], v[14:15], v[12:13] op_sel:[0,1,1] op_sel_hi:[1,1,1]
    v_pk_fma_f32 v[110:111], v[30:31], v[14:15], v[12:13] op_sel:[0,1,1] op_sel_hi:[1,1,1]
    v_exp_f32_e64 v108, v108 clamp
    v_exp_f32_e64 v109, v109 clamp
    v_exp_f32_e64 v110, v110 clamp
    v_exp_f32_e64 v111, v111 clamp
    v_max_f32 v28, v28, v14
    v_max_f32 v29, v29, v14
    v_max_f32 v30, v30, v14
    v_max_f32 v31, v31, v14
    v_cvt_pk_bf16_f32 v94, v32, v33
    v_cvt_pk_bf16_f32 v95, v34, v35
    v_pk_add_f32 v[28:29], v[28:29], v[108:109] op_sel:[0,0] op_sel_hi:[1,1]
    v_pk_add_f32 v[30:31], v[30:31], v[110:111] op_sel:[0,0] op_sel_hi:[1,1]
    v_cvt_pk_bf16_f32 v86, v28, v29
    v_cvt_pk_bf16_f32 v87, v30, v31
    s_nop 1
    v_mfma_f32_16x16x32_bf16 v[96:99], v[84:87], v[92:95], v[96:99]
    v_mfma_f32_16x16x32_bf16 v[100:103], v[84:87], v[16:19], v[100:103]
    s_add_u32 s39, s39, 1
    s_add_u32 s5, s41, 2097152
    s_and_b32 s3, s36, 3
    s_lshl2_add_u32 s3, s37, s3
    s_and_b32 s4, s5, 0xfffc0000
    s_lshl_b32 s7, s3, 9
    s_add_u32 s4, s4, s7
    s_nop 0
    v_mov_b32_dpp v100, v101 quad_perm:[0,1,2,3] row_mask:0xf bank_mask:0x2
    v_cvt_pk_bf16_f32 v99, v98, v99
    v_cvt_pk_bf16_f32 v98, v96, v97
    v_mov_b32_dpp v100, v102 quad_perm:[0,1,2,3] row_mask:0xf bank_mask:0x4
    v_mov_b32 v101, s39
    s_cmp_eq_u32 s53, 0
    v_mov_b32_dpp v100, v103 quad_perm:[0,1,2,3] row_mask:0xf bank_mask:0x8
    s_cbranch_scc1 L_slow_42
    buffer_store_dwordx4 v[98:101], v7, s[32:35], s5 offen
L_back_43:
    ds_read_b128 v[44:47], v2 offset:0
    ds_read_b128 v[48:51], v2 offset:1024
    ds_read_b128 v[52:55], v2 offset:2048
    ds_read_b128 v[56:59], v2 offset:3072
    ds_read_b128 v[60:63], v2 offset:4096
    ds_read_b128 v[64:67], v2 offset:5120
    ds_read_b128 v[68:71], v2 offset:6144
    ds_read_b128 v[72:75], v2 offset:7168
    ds_read_b128 v[76:79], v2 offset:8192
    ds_read_b128 v[80:83], v2 offset:9216
    ds_read_b128 v[84:87], v2 offset:10240
    s_and_b32 s7, s44, 0x4000
    s_add_u32 s4, s4, s7
    s_lshr_b32 s7, s38, 1
    s_lshl_b32 s7, s7, 8
    s_add_u32 s4, s4, s7
    v_lshrrev_b32 v112, 4, v0
    v_and_b32 v116, 0xff, v1
    v_lshl_add_u32 v116, v112, 16, v116
    v_xor_b32 v113, 32, v9
    v_xor_b32 v114, 64, v9
    v_xor_b32 v115, 96, v9
    s_waitcnt lgkmcnt(10)
    v_mfma_f32_16x16x32_bf16 v[28:31], a[128:131], v[44:47], 0
    ds_read_b128 v[88:91], v2 offset:11264
    v_lshlrev_b32 v117, 2, v112
    s_waitcnt lgkmcnt(10)
    v_mfma_f32_16x16x32_bf16 v[28:31], a[132:135], v[48:51], v[28:31]
    ds_read_b128 v[44:47], v2 offset:12288
    v_min_u32 v112, 1, v112
    s_waitcnt lgkmcnt(10)
    v_mfma_f32_16x16x32_bf16 v[28:31], a[136:139], v[52:55], v[28:31]
    ds_read_b128 v[48:51], v2 offset:13312
    v_lshl_add_u32 v112, v112, 26, v1
    s_waitcnt lgkmcnt(10)
    v_mfma_f32_16x16x32_bf16 v[28:31], a[140:143], v[56:59], v[28:31]
    ds_read_b128 v[52:55], v2 offset:14336
    s_waitcnt lgkmcnt(7)
    v_mfma_f32_16x16x32_bf16 v[28:31], a[144:147], v[60:63], v[28:31]
    ds_read_b128 v[56:59], v2 offset:15360
    s_lshl_b32 s3, s3, 7
    v_mfma_f32_16x16x32_bf16 v[28:31], a[148:151], v[64:67], v[28:31]
    ds_read_b128 v[60:63], v2 offset:16384
    s_and_b32 s5, s36, 28
    v_mfma_f32_16x16x32_bf16 v[28:31], a[152:155], v[68:71], v[28:31]
    ds_read_b128 v[64:67], v2 offset:17408
    s_add_u32 s3, s3, s5
    v_mfma_f32_16x16x32_bf16 v[28:31], a[156:159], v[72:75], v[28:31]
    ds_read_b128 v[68:71], v2 offset:18432
    s_waitcnt lgkmcnt(7)
    v_mfma_f32_16x16x32_bf16 v[28:31], a[160:163], v[76:79], v[28:31]
    ds_read_b128 v[72:75], v2 offset:19456
    s_waitcnt vmcnt(0)
    buffer_load_dwordx4 v[104:107], v116, s[32:35], s4 offen offset:0 sc1
    v_mfma_f32_16x16x32_bf16 v[28:31], a[164:167], v[80:83], v[28:31]
    ds_read_b128 v[76:79], v2 offset:20480
    s_add_u32 s3, s3, s38
    v_mfma_f32_16x16x32_bf16 v[28:31], a[168:171], v[84:87], v[28:31]
    ds_read_b128 v[80:83], v2 offset:21504
    s_lshl_b32 s3, s3, 8
    v_mfma_f32_16x16x32_bf16 v[28:31], a[172:175], v[88:91], v[28:31]
    ds_read_b128 v[84:87], v2 offset:22528
    s_waitcnt lgkmcnt(7)
    v_mfma_f32_16x16x32_bf16 v[28:31], a[176:179], v[44:47], v[28:31]
    ds_read_b128 v[88:91], v2 offset:23552
    s_add_u32 s3, s3, 1048576
    v_mfma_f32_16x16x32_bf16 v[28:31], a[180:183], v[48:51], v[28:31]
    ds_read_b128 v[44:47], v2 offset:24576
    s_lshl_b32 s5, s5, 8
    v_mfma_f32_16x16x32_bf16 v[28:31], a[184:187], v[52:55], v[28:31]
    ds_read_b128 v[48:51], v2 offset:25600
    s_add_u32 s98, s54, s5
    v_mfma_f32_16x16x32_bf16 v[28:31], a[188:191], v[56:59], v[28:31]
    ds_read_b128 v[52:55], v2 offset:26624
    s_waitcnt lgkmcnt(7)
    v_mfma_f32_16x16x32_bf16 v[32:35], a[128:131], v[60:63], 0
    ds_read_b128 v[56:59], v2 offset:27648
    v_and_b32 v120, 15, v0
    v_mfma_f32_16x16x32_bf16 v[32:35], a[132:135], v[64:67], v[32:35]
    ds_read_b128 v[60:63], v2 offset:28672
    v_sub_u32 v117, v120, v117
    v_mfma_f32_16x16x32_bf16 v[32:35], a[136:139], v[68:71], v[32:35]
    ds_read_b128 v[64:67], v2 offset:29696
    v_lshrrev_b32 v120, 2, v117
    v_mfma_f32_16x16x32_bf16 v[32:35], a[140:143], v[72:75], v[32:35]
    ds_read_b128 v[68:71], v2 offset:30720
    s_waitcnt lgkmcnt(7)
    s_waitcnt vmcnt(0)
    v_cmp_ne_u32 vcc, s39, v107
    s_cbranch_vccnz L_retry_44
L_back_45:
    v_lshlrev_b32 v108, 16, v104
    v_and_b32 v109, 0xffff0000, v104
    v_lshlrev_b32 v110, 16, v105
    v_and_b32 v111, 0xffff0000, v105
    v_mov_b32 v104, v106
    v_permlane32_swap_b32 v108, v109
    v_permlane32_swap_b32 v110, v111
    v_permlane32_swap_b32 v106, v104
    v_add_f32 v108, v108, v109
    v_add_f32 v110, v110, v111
    v_add_f32 v106, v106, v104
    v_mov_b32 v104, v106
    v_permlane16_swap_b32 v108, v110
    v_add_f32 v108, v108, v110
    v_mov_b32 v109, v108
    v_permlane16_swap_b32 v106, v104
    v_add_f32 v106, v106, v104
    v_permlane32_swap_b32 v108, v109
    v_cvt_pk_bf16_f32 v104, v108, v109
    v_mov_b32 v105, v104
    s_nop 1
    v_permlane16_swap_b32 v104, v105
    buffer_store_dwordx4 v[104:107], v112, s[32:35], s3 offen sc1
    v_mfma_f32_16x16x32_bf16 v[32:35], a[144:147], v[76:79], v[32:35]
    ds_read_b128 v[72:75], v2 offset:31744
    v_min_u32 v120, 1, v120
    v_mfma_f32_16x16x32_bf16 v[32:35], a[148:151], v[80:83], v[32:35]
    ds_read_b128 v[76:79], v2 offset:32768
    v_subrev_u32 v120, 1, v120
    v_mfma_f32_16x16x32_bf16 v[32:35], a[152:155], v[84:87], v[32:35]
    ds_read_b128 v[80:83], v2 offset:33792
    v_and_b32 v120, 0x3f80, v120
    v_mfma_f32_16x16x32_bf16 v[32:35], a[156:159], v[88:91], v[32:35]
    ds_read_b128 v[84:87], v2 offset:34816
    s_waitcnt lgkmcnt(7)
    v_mfma_f32_16x16x32_bf16 v[32:35], a[160:163], v[44:47], v[32:35]
    ds_read_b128 v[88:91], v2 offset:35840
    v_mov_b32 v121, 0
    v_mfma_f32_16x16x32_bf16 v[32:35], a[164:167], v[48:51], v[32:35]
    ds_read_b128 v[44:47], v2 offset:36864
    v_lshlrev_b32 v117, 4, v117
    v_mfma_f32_16x16x32_bf16 v[32:35], a[168:171], v[52:55], v[32:35]
    ds_read_b128 v[48:51], v2 offset:37888
    v_lshlrev_b64 v[118:119], v117, v[120:121]
    v_mfma_f32_16x16x32_bf16 v[32:35], a[172:175], v[56:59], v[32:35]
    ds_read_b128 v[52:55], v2 offset:38912
    s_waitcnt lgkmcnt(7)
    v_mfma_f32_16x16x32_bf16 v[32:35], a[176:179], v[60:63], v[32:35]
    ds_read_b128 v[56:59], v2 offset:39936
    v_mfma_f32_16x16x32_bf16 v[32:35], a[180:183], v[64:67], v[32:35]
    ds_read_b128 v[60:63], v2 offset:40960
    v_mfma_f32_16x16x32_bf16 v[32:35], a[184:187], v[68:71], v[32:35]
    ds_read_b128 v[64:67], v2 offset:41984
    v_mfma_f32_16x16x32_bf16 v[32:35], a[188:191], v[72:75], v[32:35]
    ds_read_b128 v[68:71], v2 offset:43008
    s_waitcnt lgkmcnt(7)
    v_mfma_f32_16x16x32_bf16 v[36:39], a[128:131], v[76:79], 0
    ds_read_b128 v[72:75], v2 offset:44032
    v_mfma_f32_16x16x32_bf16 v[36:39], a[132:135], v[80:83], v[36:39]
    ds_read_b128 v[76:79], v2 offset:45056
    v_mfma_f32_16x16x32_bf16 v[36:39], a[136:139], v[84:87], v[36:39]
    ds_read_b128 v[80:83], v2 offset:46080
    v_mfma_f32_16x16x32_bf16 v[36:39], a[140:143], v[88:91], v[36:39]
    ds_read_b128 v[84:87], v2 offset:47104
    s_waitcnt lgkmcnt(7)
    v_mfma_f32_16x16x32_bf16 v[36:39], a[144:147], v[44:47], v[36:39]
    ds_read_b128 v[88:91], v2 offset:48128
    v_mfma_f32_16x16x32_bf16 v[36:39], a[148:151], v[48:51], v[36:39]
    ds_read_b128 v[44:47], v2 offset:49152
    v_mfma_f32_16x16x32_bf16 v[36:39], a[152:155], v[52:55], v[36:39]
    ds_read_b128 v[48:51], v2 offset:50176
    v_mfma_f32_16x16x32_bf16 v[36:39], a[156:159], v[56:59], v[36:39]
    ds_read_b128 v[52:55], v2 offset:51200
    s_waitcnt lgkmcnt(7)
    v_mfma_f32_16x16x32_bf16 v[36:39], a[160:163], v[60:63], v[36:39]
    ds_read_b128 v[56:59], v2 offset:52224
    v_mfma_f32_16x16x32_bf16 v[36:39], a[164:167], v[64:67], v[36:39]
    ds_read_b128 v[60:63], v2 offset:53248
    v_mfma_f32_16x16x32_bf16 v[36:39], a[168:171], v[68:71], v[36:39]
    s_add_u32 m0, s44, 12288
    s_xor_b32 s7, s47, 98304
    ds_read_b128 v[64:67], v2 offset:54272
    v_mfma_f32_16x16x32_bf16 v[36:39], a[172:175], v[72:75], v[36:39]
    buffer_load_dwordx4 v9, s[16:19], s7 offen offset:0 lds
    ds_read_b128 v[68:71], v2 offset:55296
    s_waitcnt lgkmcnt(7)
    v_mfma_f32_16x16x32_bf16 v[36:39], a[176:179], v[76:79], v[36:39]
    ds_read_b128 v[72:75], v2 offset:56320
    v_mfma_f32_16x16x32_bf16 v[36:39], a[180:183], v[80:83], v[36:39]
    ds_read_b128 v[76:79], v2 offset:57344
    v_mfma_f32_16x16x32_bf16 v[36:39], a[184:187], v[84:87], v[36:39]
    ds_read_b128 v[80:83], v2 offset:58368
    v_mfma_f32_16x16x32_bf16 v[36:39], a[188:191], v[88:91], v[36:39]
    buffer_load_dwordx4 v113, s[16:19], s7 offen offset:1024 lds
    ds_read_b128 v[84:87], v2 offset:59392
    s_waitcnt lgkmcnt(7)
    v_mfma_f32_16x16x32_bf16 v[40:43], a[128:131], v[44:47], 0
    ds_read_b128 v[88:91], v2 offset:60416
    v_mfma_f32_16x16x32_bf16 v[40:43], a[132:135], v[48:51], v[40:43]
    ds_read_b128 v[44:47], v2 offset:61440
    v_mfma_f32_16x16x32_bf16 v[40:43], a[136:139], v[52:55], v[40:43]
    ds_read_b128 v[48:51], v2 offset:62464
    v_mfma_f32_16x16x32_bf16 v[40:43], a[140:143], v[56:59], v[40:43]
    buffer_load_dwordx4 v114, s[16:19], s7 offen offset:2048 lds
    ds_read_b128 v[52:55], v2 offset:63488
    s_waitcnt lgkmcnt(7)
    v_mfma_f32_16x16x32_bf16 v[40:43], a[144:147], v[60:63], v[40:43]
    ds_read_b128 v[56:59], v2 offset:64512
    v_mfma_f32_16x16x32_bf16 v[40:43], a[148:151], v[64:67], v[40:43]
    v_mfma_f32_16x16x32_bf16 v[40:43], a[152:155], v[68:71], v[40:43]
    v_mfma_f32_16x16x32_bf16 v[40:43], a[156:159], v[72:75], v[40:43]
    buffer_load_dwordx4 v115, s[16:19], s7 offen offset:3072 lds
    s_waitcnt lgkmcnt(4)
    v_mfma_f32_16x16x32_bf16 v[40:43], a[160:163], v[76:79], v[40:43]
    v_mfma_f32_16x16x32_bf16 v[40:43], a[164:167], v[80:83], v[40:43]
    v_mfma_f32_16x16x32_bf16 v[40:43], a[168:171], v[84:87], v[40:43]
    v_mfma_f32_16x16x32_bf16 v[40:43], a[172:175], v[88:91], v[40:43]
    s_waitcnt lgkmcnt(0)
    v_mfma_f32_16x16x32_bf16 v[40:43], a[176:179], v[44:47], v[40:43]
    v_mfma_f32_16x16x32_bf16 v[40:43], a[180:183], v[48:51], v[40:43]
    v_mfma_f32_16x16x32_bf16 v[40:43], a[184:187], v[52:55], v[40:43]
    v_mfma_f32_16x16x32_bf16 v[40:43], a[188:191], v[56:59], v[40:43]
    ds_read_b128 v[76:79], v5
    ds_read2_b32 v[80:81], v4 offset0:0 offset1:64
    ds_read2_b32 v[82:83], v4 offset0:16 offset1:80
    ds_read2_b32 v[84:85], v4 offset0:32 offset1:96
    ds_read2_b32 v[86:87], v4 offset0:48 offset1:112
    s_waitcnt lgkmcnt(3)
    v_pk_fma_f32 v[88:89], v[76:77], v[80:81], v[14:15] op_sel:[0,1,0] op_sel_hi:[1,1,0]
    v_pk_fma_f32 v[90:91], v[78:79], v[80:81], v[14:15] op_sel:[0,1,0] op_sel_hi:[1,1,0]
    v_pk_fma_f32 v[28:29], v[28:29], v[80:81], v[88:89] op_sel:[0,0,0] op_sel_hi:[1,0,1]
    v_pk_fma_f32 v[30:31], v[30:31], v[80:81], v[90:91] op_sel:[0,0,0] op_sel_hi:[1,0,1]
    v_pk_fma_f32 v[88:89], v[28:29], v[14:15], v[12:13] op_sel:[0,1,1] op_sel_hi:[1,1,1]
    v_pk_fma_f32 v[90:91], v[30:31], v[14:15], v[12:13] op_sel:[0,1,1] op_sel_hi:[1,1,1]
    v_exp_f32_e64 v88, v88 clamp
    v_exp_f32_e64 v89, v89 clamp
    v_exp_f32_e64 v90, v90 clamp
    v_exp_f32_e64 v91, v91 clamp
    v_max_f32 v28, v28, v14
    v_max_f32 v29, v29, v14
    v_max_f32 v30, v30, v14
    v_max_f32 v31, v31, v14
    v_pk_add_f32 v[28:29], v[28:29], v[88:89] op_sel:[0,0] op_sel_hi:[1,1]
    v_pk_add_f32 v[30:31], v[30:31], v[90:91] op_sel:[0,0] op_sel_hi:[1,1]
    v_cvt_pk_bf16_f32 v20, v28, v29
    v_cvt_pk_bf16_f32 v21, v30, v31
    s_waitcnt lgkmcnt(2)
    v_pk_fma_f32 v[88:89], v[76:77], v[82:83], v[14:15] op_sel:[0,1,0] op_sel_hi:[1,1,0]
    v_pk_fma_f32 v[90:91], v[78:79], v[82:83], v[14:15] op_sel:[0,1,0] op_sel_hi:[1,1,0]
    v_pk_fma_f32 v[32:33], v[32:33], v[82:83], v[88:89] op_sel:[0,0,0] op_sel_hi:[1,0,1]
    v_pk_fma_f32 v[34:35], v[34:35], v[82:83], v[90:91] op_sel:[0,0,0] op_sel_hi:[1,0,1]
    v_pk_fma_f32 v[88:89], v[32:33], v[14:15], v[12:13] op_sel:[0,1,1] op_sel_hi:[1,1,1]
    v_pk_fma_f32 v[90:91], v[34:35], v[14:15], v[12:13] op_sel:[0,1,1] op_sel_hi:[1,1,1]
    v_exp_f32_e64 v88, v88 clamp
    v_exp_f32_e64 v89, v89 clamp
    v_exp_f32_e64 v90, v90 clamp
    v_exp_f32_e64 v91, v91 clamp
    v_max_f32 v32, v32, v14
    v_max_f32 v33, v33, v14
    v_max_f32 v34, v34, v14
    v_max_f32 v35, v35, v14
    v_pk_add_f32 v[32:33], v[32:33], v[88:89] op_sel:[0,0] op_sel_hi:[1,1]
    v_pk_add_f32 v[34:35], v[34:35], v[90:91] op_sel:[0,0] op_sel_hi:[1,1]
    v_cvt_pk_bf16_f32 v22, v32, v33
    v_cvt_pk_bf16_f32 v23, v34, v35
    s_waitcnt lgkmcnt(1)
    v_pk_fma_f32 v[88:89], v[76:77], v[84:85], v[14:15] op_sel:[0,1,0] op_sel_hi:[1,1,0]
    v_pk_fma_f32 v[90:91], v[78:79], v[84:85], v[14:15] op_sel:[0,1,0] op_sel_hi:[1,1,0]
    v_pk_fma_f32 v[36:37], v[36:37], v[84:85], v[88:89] op_sel:[0,0,0] op_sel_hi:[1,0,1]
    v_pk_fma_f32 v[38:39], v[38:39], v[84:85], v[90:91] op_sel:[0,0,0] op_sel_hi:[1,0,1]
    v_pk_fma_f32 v[88:89], v[36:37], v[14:15], v[12:13] op_sel:[0,1,1] op_sel_hi:[1,1,1]
    v_pk_fma_f32 v[90:91], v[38:39], v[14:15], v[12:13] op_sel:[0,1,1] op_sel_hi:[1,1,1]
    v_exp_f32_e64 v88, v88 clamp
    v_exp_f32_e64 v89, v89 clamp
    v_exp_f32_e64 v90, v90 clamp
    v_exp_f32_e64 v91, v91 clamp
    v_max_f32 v36, v36, v14
    v_max_f32 v37, v37, v14
    v_max_f32 v38, v38, v14
    v_max_f32 v39, v39, v14
    v_pk_add_f32 v[36:37], v[36:37], v[88:89] op_sel:[0,0] op_sel_hi:[1,1]
    v_pk_add_f32 v[38:39], v[38:39], v[90:91] op_sel:[0,0] op_sel_hi:[1,1]
    v_cvt_pk_bf16_f32 v24, v36, v37
    v_cvt_pk_bf16_f32 v25, v38, v39
    s_waitcnt lgkmcnt(0)
    v_pk_fma_f32 v[88:89], v[76:77], v[86:87], v[14:15] op_sel:[0,1,0] op_sel_hi:[1,1,0]
    v_pk_fma_f32 v[90:91], v[78:79], v[86:87], v[14:15] op_sel:[0,1,0] op_sel_hi:[1,1,0]
    v_pk_fma_f32 v[40:41], v[40:41], v[86:87], v[88:89] op_sel:[0,0,0] op_sel_hi:[1,0,1]
    v_pk_fma_f32 v[42:43], v[42:43], v[86:87], v[90:91] op_sel:[0,0,0] op_sel_hi:[1,0,1]
    v_pk_fma_f32 v[88:89], v[40:41], v[14:15], v[12:13] op_sel:[0,1,1] op_sel_hi:[1,1,1]
    v_pk_fma_f32 v[90:91], v[42:43], v[14:15], v[12:13] op_sel:[0,1,1] op_sel_hi:[1,1,1]
    v_exp_f32_e64 v88, v88 clamp
    v_exp_f32_e64 v89, v89 clamp
    v_exp_f32_e64 v90, v90 clamp
    v_exp_f32_e64 v91, v91 clamp
    v_max_f32 v40, v40, v14
    v_max_f32 v41, v41, v14
    v_max_f32 v42, v42, v14
    v_max_f32 v43, v43, v14
    v_pk_add_f32 v[40:41], v[40:41], v[88:89] op_sel:[0,0] op_sel_hi:[1,1]
    v_pk_add_f32 v[42:43], v[42:43], v[90:91] op_sel:[0,0] op_sel_hi:[1,1]
    v_cvt_pk_bf16_f32 v26, v40, v41
    v_cvt_pk_bf16_f32 v27, v42, v43
    s_xor_b32 s99, s98, 7168
    s_add_u32 s4, s41, 2097152
    buffer_load_dwordx4 v[44:47], v1, s[32:35], s99 offen offset:0 sc1
    v_permlane16_swap_b32 v20, v22
    v_permlane16_swap_b32 v21, v23
    s_add_u32 s5, s4, 32768
    v_permlane16_swap_b32 v24, v26
    s_xor_b32 s99, s98, 6144
    v_permlane16_swap_b32 v25, v27
    buffer_load_dwordx4 v[48:51], v1, s[32:35], s99 offen offset:0 sc1
    s_xor_b32 s99, s98, 5120
    buffer_load_dwordx4 v[52:55], v1, s[32:35], s99 offen offset:0 sc1
    s_xor_b32 s99, s98, 4096
    buffer_load_dwordx4 v[56:59], v1, s[32:35], s99 offen offset:0 sc1
    s_xor_b32 s99, s98, 3072
    buffer_load_dwordx4 v[60:63], v1, s[32:35], s99 offen offset:0 sc1
    s_xor_b32 s99, s98, 2048
    buffer_load_dwordx4 v[64:67], v1, s[32:35], s99 offen offset:0 sc1
    s_xor_b32 s99, s98, 1024
    buffer_load_dwordx4 v[68:71], v1, s[32:35], s99 offen offset:0 sc1
    s_waitcnt vmcnt(11)
    s_xor_b32 s99, s98, 0
    buffer_load_dwordx4 v[72:75], v1, s[32:35], s99 offen offset:0 sc1
L_sum_47:
    s_waitcnt vmcnt(7)
    v_mfma_f32_16x16x16_bf16 v[100:103], v[118:119], v[44:45], 0
    v_cmp_ne_u32 s[96:97], s39, v47
    s_waitcnt vmcnt(6)
    v_mfma_f32_16x16x16_bf16 v[100:103], v[118:119], v[48:49], v[100:103]
    v_cmp_ne_u32 vcc, s39, v51
    v_add_f32 v98, v46, v50
    s_or_b64 s[96:97], s[96:97], vcc
    s_waitcnt vmcnt(5)
    v_mfma_f32_16x16x16_bf16 v[100:103], v[118:119], v[52:53], v[100:103]
    v_cmp_ne_u32 vcc, s39, v55
    v_add_f32 v98, v98, v54
    s_or_b64 s[96:97], s[96:97], vcc
    s_waitcnt vmcnt(4)
    v_mfma_f32_16x16x16_bf16 v[100:103], v[118:119], v[56:57], v[100:103]
    v_cmp_ne_u32 vcc, s39, v59
    v_add_f32 v98, v98, v58
    s_or_b64 s[96:97], s[96:97], vcc
    s_waitcnt vmcnt(3)
    v_mfma_f32_16x16x16_bf16 v[100:103], v[118:119], v[60:61], v[100:103]
    v_cmp_ne_u32 vcc, s39, v63
    v_add_f32 v98, v98, v62
    s_or_b64 s[96:97], s[96:97], vcc
    s_waitcnt vmcnt(2)
    v_mfma_f32_16x16x16_bf16 v[100:103], v[118:119], v[64:65], v[100:103]
    v_cmp_ne_u32 vcc, s39, v67
    v_add_f32 v98, v98, v66
    s_or_b64 s[96:97], s[96:97], vcc
    s_waitcnt vmcnt(1)
    v_mfma_f32_16x16x16_bf16 v[100:103], v[118:119], v[68:69], v[100:103]
    v_cmp_ne_u32 vcc, s39, v71
    v_add_f32 v98, v98, v70
    s_or_b64 s[96:97], s[96:97], vcc
    s_waitcnt vmcnt(0)
    v_mfma_f32_16x16x16_bf16 v[100:103], v[118:119], v[72:73], v[100:103]
    v_cmp_ne_u32 vcc, s39, v75
    v_add_f32 v98, v98, v74
    s_or_b64 s[96:97], s[96:97], vcc
    s_cbranch_scc1 L_retry_48
    v_mov_b32_dpp v108, v98 row_newbcast:0 row_mask:0xf bank_mask:0xf
    v_mov_b32_dpp v109, v98 row_newbcast:4 row_mask:0xf bank_mask:0xf
    v_mov_b32_dpp v110, v98 row_newbcast:8 row_mask:0xf bank_mask:0xf
    v_mov_b32_dpp v111, v98 row_newbcast:12 row_mask:0xf bank_mask:0xf
    v_cvt_pk_bf16_f32 v96, v100, v101
    v_cvt_pk_bf16_f32 v97, v102, v103
    v_cvt_pk_bf16_f32 v98, v108, v109
    v_cvt_pk_bf16_f32 v99, v110, v111
    s_nop 0
    v_permlane16_swap_b32 v96, v98
    v_permlane16_swap_b32 v97, v99
    s_nop 1
    v_mfma_f32_32x32x16_bf16 v[28:43], v[96:99], v[20:23], 0
    v_mfma_f32_32x32x16_bf16 v[44:59], v[96:99], v[24:27], 0
    s_cmp_eq_u32 s53, 0
    v_mov_b32 v70, s39
    v_min_u32 v71, 1, v0
    v_lshlrev_b32 v71, 26, v71
    s_nop 6
    v_add_f32 v36, 0x358637bd, v36
    v_add_f32 v52, 0x358637bd, v52
    v_rcp_f32 v36, v36
    v_rcp_f32 v52, v52
    v_pk_mul_f32 v[28:29], v[28:29], v[36:37] op_sel:[0,0] op_sel_hi:[1,0]
    v_pk_mul_f32 v[30:31], v[30:31], v[36:37] op_sel:[0,0] op_sel_hi:[1,0]
    v_pk_mul_f32 v[32:33], v[32:33], v[36:37] op_sel:[0,0] op_sel_hi:[1,0]
    v_pk_mul_f32 v[34:35], v[34:35], v[36:37] op_sel:[0,0] op_sel_hi:[1,0]
    v_cvt_pk_bf16_f32 v38, v28, v29
    v_cvt_pk_bf16_f32 v39, v30, v31
    v_cvt_pk_bf16_f32 v40, v32, v33
    v_cvt_pk_bf16_f32 v41, v34, v35
    s_cbranch_scc1 L_slow_59
    buffer_store_dwordx4 v[38:41], v7, s[32:35], s4 offen
L_back_60:
    v_pk_mul_f32 v[44:45], v[44:45], v[52:53] op_sel:[0,0] op_sel_hi:[1,0]
    v_pk_mul_f32 v[46:47], v[46:47], v[52:53] op_sel:[0,0] op_sel_hi:[1,0]
    v_pk_mul_f32 v[48:49], v[48:49], v[52:53] op_sel:[0,0] op_sel_hi:[1,0]
    v_pk_mul_f32 v[50:51], v[50:51], v[52:53] op_sel:[0,0] op_sel_hi:[1,0]
    v_cvt_pk_bf16_f32 v54, v44, v45
    v_cvt_pk_bf16_f32 v55, v46, v47
    v_cvt_pk_bf16_f32 v56, v48, v49
    v_cvt_pk_bf16_f32 v57, v50, v51
    s_cbranch_scc1 L_slow_61
    buffer_store_dwordx4 v[54:57], v7, s[32:35], s5 offen
L_back_62:
    s_lshl_b32 s6, s38, 11
    s_add_u32 s6, s6, 150144
    v_add_u32 v14, s6, v1
    ds_read_b128 v[60:63], v14
    ds_read_b128 v[64:67], v14 offset:1024
    v_xor_b32 v124, 32, v10
    v_xor_b32 v125, 64, v10
    v_xor_b32 v126, 96, v10
    s_add_u32 s6, s49, 2097152
    v_mov_b32 v15, v71
    v_mov_b32 v16, 0x3f803f80
    v_lshrrev_b32 v18, 4, v0
    v_min_u32 v18, 1, v18
    v_lshl_add_u32 v18, v18, 26, v1
    s_add_u32 s0, s39, 4
    s_waitcnt lgkmcnt(1)
    v_permlane16_swap_b32 v60, v62
    v_permlane16_swap_b32 v61, v63
    s_waitcnt lgkmcnt(0)
    v_permlane16_swap_b32 v64, v66
    v_permlane16_swap_b32 v65, v67
    v_lshlrev_b32 v20, 16, v60
    v_and_b32 v21, 0xffff0000, v60
    v_lshlrev_b32 v22, 16, v61
    v_and_b32 v23, 0xffff0000, v61
    v_lshlrev_b32 v24, 16, v62
    v_and_b32 v25, 0xffff0000, v62
    v_lshlrev_b32 v26, 16, v63
    v_and_b32 v27, 0xffff0000, v63
    v_lshlrev_b32 v28, 16, v64
    v_and_b32 v29, 0xffff0000, v64
    v_lshlrev_b32 v30, 16, v65
    v_and_b32 v31, 0xffff0000, v65
    v_lshlrev_b32 v32, 16, v66
    v_and_b32 v33, 0xffff0000, v66
    v_lshlrev_b32 v34, 16, v67
    v_and_b32 v35, 0xffff0000, v67
    s_cmp_eq_u32 s53, 0
    s_waitcnt vmcnt(0)
    s_barrier
    s_cbranch_scc1 L_slow_63
    buffer_store_dword v70, v71, s[32:35], s52 offen offset:64
L_back_64:
    s_xor_b32 s5, s6, 0
    buffer_load_dwordx4 v[36:39], v1, s[32:35], s5 offen offset:0 sc1
    buffer_load_dwordx4 v[40:43], v1, s[32:35], s5 offen offset:1024 sc1
    ds_read_b64_tr_b16 v[120:121], v124 offset:12288
    ds_read_b64_tr_b16 v[122:123], v124 offset:12544
    ds_read_b64_tr_b16 v[116:117], v10 offset:12288
    ds_read_b64_tr_b16 v[118:119], v10 offset:12544
    ds_read_b64_tr_b16 v[112:113], v126 offset:8192
    ds_read_b64_tr_b16 v[114:115], v126 offset:8448
    ds_read_b64_tr_b16 v[108:109], v125 offset:8192
    ds_read_b64_tr_b16 v[110:111], v125 offset:8448
    ds_read_b64_tr_b16 v[104:105], v124 offset:8192
    ds_read_b64_tr_b16 v[106:107], v124 offset:8448
    ds_read_b64_tr_b16 v[100:101], v10 offset:8192
    ds_read_b64_tr_b16 v[102:103], v10 offset:8448
    ds_read_b64_tr_b16 v[96:97], v126 offset:4096
    ds_read_b64_tr_b16 v[98:99], v126 offset:4352
    buffer_load_dword v127, v8, s[32:35], s51 offen offset:64 sc1
    ds_read_b64_tr_b16 v[92:93], v125 offset:4096
    ds_read_b64_tr_b16 v[94:95], v125 offset:4352
    ds_read_b64_tr_b16 v[88:89], v124 offset:4096
    ds_read_b64_tr_b16 v[90:91], v124 offset:4352
    ds_read_b64_tr_b16 v[84:85], v10 offset:4096
    ds_read_b64_tr_b16 v[86:87], v10 offset:4352
    ds_read_b64_tr_b16 v[80:81], v126 offset:0
    ds_read_b64_tr_b16 v[82:83], v126 offset:256
    ds_read_b64_tr_b16 v[76:77], v125 offset:0
    ds_read_b64_tr_b16 v[78:79], v125 offset:256
    ds_read_b64_tr_b16 v[72:73], v124 offset:0
    ds_read_b64_tr_b16 v[74:75], v124 offset:256
    ds_read_b64_tr_b16 v[68:69], v10 offset:0
    ds_read_b64_tr_b16 v[70:71], v10 offset:256
    buffer_load_dword v17, v8, s[32:35], s51 offen offset:64 sc1
L_mp_65:
    s_waitcnt vmcnt(1)
    v_cmp_ne_u32 vcc, s39, v127
L_pad7:
    s_cbranch_execz L_warm1
    s_cbranch_vccz L_md_66
    buffer_load_dword v127, v8, s[32:35], s51 offen offset:64 sc1
    s_waitcnt vmcnt(1)
    v_cmp_ne_u32 vcc, s39, v17
    s_cbranch_vccz L_md_67
    buffer_load_dword v17, v8, s[32:35], s51 offen offset:64 sc1
    s_add_u32 s43, s43, 1
    s_cmp_lt_u32 s43, 0x20000
    s_cbranch_scc1 L_mp_65
    s_endpgm
L_md_66:
L_md_67:
    s_xor_b32 s5, s6, 2048
    buffer_load_dwordx4 v[44:47], v1, s[32:35], s5 offen offset:0 sc1
    buffer_load_dwordx4 v[48:51], v1, s[32:35], s5 offen offset:1024 sc1
    s_barrier
    s_xor_b32 s5, s6, 4096
    buffer_load_dwordx4 v[52:55], v1, s[32:35], s5 offen offset:0 sc1
    buffer_load_dwordx4 v[56:59], v1, s[32:35], s5 offen offset:1024 sc1
    s_barrier
    s_xor_b32 s5, s6, 6144
    buffer_load_dwordx4 v[60:63], v1, s[32:35], s5 offen offset:0 sc1
    buffer_load_dwordx4 v[64:67], v1, s[32:35], s5 offen offset:1024 sc1
    s_waitcnt lgkmcnt(0)
    v_mfma_f32_16x16x32_bf16 v[20:23], v[68:71], v[36:39], v[20:23]
    ds_read_b64_tr_b16 v[68:69], v125 offset:12288
    ds_read_b64_tr_b16 v[70:71], v125 offset:12544
    v_mfma_f32_16x16x32_bf16 v[24:27], v[72:75], v[36:39], v[24:27]
    ds_read_b64_tr_b16 v[72:73], v126 offset:12288
    ds_read_b64_tr_b16 v[74:75], v126 offset:12544
    v_mfma_f32_16x16x32_bf16 v[28:31], v[76:79], v[36:39], v[28:31]
    ds_read_b64_tr_b16 v[76:77], v10 offset:16384
    ds_read_b64_tr_b16 v[78:79], v10 offset:16640
    v_mfma_f32_16x16x32_bf16 v[32:35], v[80:83], v[36:39], v[32:35]
    ds_read_b64_tr_b16 v[80:81], v124 offset:16384
    ds_read_b64_tr_b16 v[82:83], v124 offset:16640
    s_xor_b32 s5, s6, 8192
    buffer_load_dwordx4 v[36:39], v1, s[32:35], s5 offen offset:0 sc1
    v_mfma_f32_16x16x32_bf16 v[20:23], v[84:87], v[40:43], v[20:23]
    ds_read_b64_tr_b16 v[84:85], v125 offset:16384
    ds_read_b64_tr_b16 v[86:87], v125 offset:16640
    v_mfma_f32_16x16x32_bf16 v[24:27], v[88:91], v[40:43], v[24:27]
    ds_read_b64_tr_b16 v[88:89], v126 offset:16384
    ds_read_b64_tr_b16 v[90:91], v126 offset:16640
    v_mfma_f32_16x16x32_bf16 v[28:31], v[92:95], v[40:43], v[28:31]
    ds_read_b64_tr_b16 v[92:93], v10 offset:20480
    ds_read_b64_tr_b16 v[94:95], v10 offset:20736
    v_mfma_f32_16x16x32_bf16 v[32:35], v[96:99], v[40:43], v[32:35]
    ds_read_b64_tr_b16 v[96:97], v124 offset:20480
    ds_read_b64_tr_b16 v[98:99], v124 offset:20736
    buffer_load_dwordx4 v[40:43], v1, s[32:35], s5 offen offset:1024 sc1
    s_waitcnt vmcnt(7)
    v_mfma_f32_16x16x32_bf16 v[20:23], v[100:103], v[44:47], v[20:23]
    ds_read_b64_tr_b16 v[100:101], v125 offset:20480
    ds_read_b64_tr_b16 v[102:103], v125 offset:20736
    v_mfma_f32_16x16x32_bf16 v[24:27], v[104:107], v[44:47], v[24:27]
    ds_read_b64_tr_b16 v[104:105], v126 offset:20480
    ds_read_b64_tr_b16 v[106:107], v126 offset:20736
    v_mfma_f32_16x16x32_bf16 v[28:31], v[108:111], v[44:47], v[28:31]
    ds_read_b64_tr_b16 v[108:109], v10 offset:24576
    ds_read_b64_tr_b16 v[110:111], v10 offset:24832
    v_mfma_f32_16x16x32_bf16 v[32:35], v[112:115], v[44:47], v[32:35]
    ds_read_b64_tr_b16 v[112:113], v124 offset:24576
    ds_read_b64_tr_b16 v[114:115], v124 offset:24832
    s_xor_b32 s5, s6, 10240
    buffer_load_dwordx4 v[44:47], v1, s[32:35], s5 offen offset:0 sc1
    s_waitcnt vmcnt(7) lgkmcnt(14)
    v_mfma_f32_16x16x32_bf16 v[20:23], v[116:119], v[48:51], v[20:23]
    ds_read_b64_tr_b16 v[116:117], v125 offset:24576
    ds_read_b64_tr_b16 v[118:119], v125 offset:24832
    v_mfma_f32_16x16x32_bf16 v[24:27], v[120:123], v[48:51], v[24:27]
    ds_read_b64_tr_b16 v[120:121], v126 offset:24576
    ds_read_b64_tr_b16 v[122:123], v126 offset:24832
    v_mfma_f32_16x16x32_bf16 v[28:31], v[68:71], v[48:51], v[28:31]
    ds_read_b64_tr_b16 v[68:69], v10 offset:28672
    ds_read_b64_tr_b16 v[70:71], v10 offset:28928
    v_mfma_f32_16x16x32_bf16 v[32:35], v[72:75], v[48:51], v[32:35]
    ds_read_b64_tr_b16 v[72:73], v124 offset:28672
    ds_read_b64_tr_b16 v[74:75], v124 offset:28928
    buffer_load_dwordx4 v[48:51], v1, s[32:35], s5 offen offset:1024 sc1
    s_waitcnt vmcnt(7) lgkmcnt(14)
    v_mfma_f32_16x16x32_bf16 v[20:23], v[76:79], v[52:55], v[20:23]
    ds_read_b64_tr_b16 v[76:77], v125 offset:28672
    ds_read_b64_tr_b16 v[78:79], v125 offset:28928
    v_mfma_f32_16x16x32_bf16 v[24:27], v[80:83], v[52:55], v[24:27]
    ds_read_b64_tr_b16 v[80:81], v126 offset:28672
    ds_read_b64_tr_b16 v[82:83], v126 offset:28928
    v_mfma_f32_16x16x32_bf16 v[28:31], v[84:87], v[52:55], v[28:31]
    ds_read_b64_tr_b16 v[84:85], v10 offset:32768
    ds_read_b64_tr_b16 v[86:87], v10 offset:33024
    v_mfma_f32_16x16x32_bf16 v[32:35], v[88:91], v[52:55], v[32:35]
    ds_read_b64_tr_b16 v[88:89], v124 offset:32768
    ds_read_b64_tr_b16 v[90:91], v124 offset:33024
    s_xor_b32 s5, s6, 12288
    buffer_load_dwordx4 v[52:55], v1, s[32:35], s5 offen offset:0 sc1
    s_waitcnt vmcnt(7) lgkmcnt(14)
    v_mfma_f32_16x16x32_bf16 v[20:23], v[92:95], v[56:59], v[20:23]
    ds_read_b64_tr_b16 v[92:93], v125 offset:32768
    ds_read_b64_tr_b16 v[94:95], v125 offset:33024
    v_mfma_f32_16x16x32_bf16 v[24:27], v[96:99], v[56:59], v[24:27]
    ds_read_b64_tr_b16 v[96:97], v126 offset:32768
    ds_read_b64_tr_b16 v[98:99], v126 offset:33024
    v_mfma_f32_16x16x32_bf16 v[28:31], v[100:103], v[56:59], v[28:31]
    ds_read_b64_tr_b16 v[100:101], v10 offset:36864
    ds_read_b64_tr_b16 v[102:103], v10 offset:37120
    v_mfma_f32_16x16x32_bf16 v[32:35], v[104:107], v[56:59], v[32:35]
    ds_read_b64_tr_b16 v[104:105], v124 offset:36864
    ds_read_b64_tr_b16 v[106:107], v124 offset:37120
    buffer_load_dwordx4 v[56:59], v1, s[32:35], s5 offen offset:1024 sc1
    s_waitcnt vmcnt(7) lgkmcnt(14)
    v_mfma_f32_16x16x32_bf16 v[20:23], v[108:111], v[60:63], v[20:23]
    ds_read_b64_tr_b16 v[108:109], v125 offset:36864
    ds_read_b64_tr_b16 v[110:111], v125 offset:37120
    v_mfma_f32_16x16x32_bf16 v[24:27], v[112:115], v[60:63], v[24:27]
    ds_read_b64_tr_b16 v[112:113], v126 offset:36864
    ds_read_b64_tr_b16 v[114:115], v126 offset:37120
    v_mfma_f32_16x16x32_bf16 v[28:31], v[116:119], v[60:63], v[28:31]
    ds_read_b64_tr_b16 v[116:117], v10 offset:40960
    ds_read_b64_tr_b16 v[118:119], v10 offset:41216
    v_mfma_f32_16x16x32_bf16 v[32:35], v[120:123], v[60:63], v[32:35]
    ds_read_b64_tr_b16 v[120:121], v124 offset:40960
    ds_read_b64_tr_b16 v[122:123], v124 offset:41216
    s_xor_b32 s5, s6, 14336
    buffer_load_dwordx4 v[60:63], v1, s[32:35], s5 offen offset:0 sc1
    s_waitcnt vmcnt(7) lgkmcnt(14)
    v_mfma_f32_16x16x32_bf16 v[20:23], v[68:71], v[64:67], v[20:23]
    ds_read_b64_tr_b16 v[68:69], v125 offset:40960
    ds_read_b64_tr_b16 v[70:71], v125 offset:41216
    v_mfma_f32_16x16x32_bf16 v[24:27], v[72:75], v[64:67], v[24:27]
    ds_read_b64_tr_b16 v[72:73], v126 offset:40960
    ds_read_b64_tr_b16 v[74:75], v126 offset:41216
    v_mfma_f32_16x16x32_bf16 v[28:31], v[76:79], v[64:67], v[28:31]
    ds_read_b64_tr_b16 v[76:77], v10 offset:45056
    ds_read_b64_tr_b16 v[78:79], v10 offset:45312
    v_mfma_f32_16x16x32_bf16 v[32:35], v[80:83], v[64:67], v[32:35]
    ds_read_b64_tr_b16 v[80:81], v124 offset:45056
    ds_read_b64_tr_b16 v[82:83], v124 offset:45312
    buffer_load_dwordx4 v[64:67], v1, s[32:35], s5 offen offset:1024 sc1
    s_waitcnt vmcnt(7) lgkmcnt(14)
    v_mfma_f32_16x16x32_bf16 v[20:23], v[84:87], v[36:39], v[20:23]
    ds_read_b64_tr_b16 v[84:85], v125 offset:45056
    ds_read_b64_tr_b16 v[86:87], v125 offset:45312
    v_mfma_f32_16x16x32_bf16 v[24:27], v[88:91], v[36:39], v[24:27]
    ds_read_b64_tr_b16 v[88:89], v126 offset:45056
    ds_read_b64_tr_b16 v[90:91], v126 offset:45312
    v_mfma_f32_16x16x32_bf16 v[28:31], v[92:95], v[36:39], v[28:31]
    ds_read_b64_tr_b16 v[92:93], v10 offset:49152
    ds_read_b64_tr_b16 v[94:95], v10 offset:49408
    v_mfma_f32_16x16x32_bf16 v[32:35], v[96:99], v[36:39], v[32:35]
    ds_read_b64_tr_b16 v[96:97], v124 offset:49152
    ds_read_b64_tr_b16 v[98:99], v124 offset:49408
    s_waitcnt vmcnt(6) lgkmcnt(14)
    v_mfma_f32_16x16x32_bf16 v[20:23], v[100:103], v[40:43], v[20:23]
    ds_read_b64_tr_b16 v[100:101], v10 offset:53248
    ds_read_b64_tr_b16 v[102:103], v10 offset:53504
    v_mfma_f32_16x16x32_bf16 v[24:27], v[104:107], v[40:43], v[24:27]
    ds_read_b64_tr_b16 v[104:105], v124 offset:53248
    ds_read_b64_tr_b16 v[106:107], v124 offset:53504
    v_mfma_f32_16x16x32_bf16 v[28:31], v[108:111], v[40:43], v[28:31]
    ds_read_b64_tr_b16 v[108:109], v10 offset:57344
    ds_read_b64_tr_b16 v[110:111], v10 offset:57600
    v_mfma_f32_16x16x32_bf16 v[32:35], v[112:115], v[40:43], v[32:35]
    ds_read_b64_tr_b16 v[112:113], v124 offset:57344
    ds_read_b64_tr_b16 v[114:115], v124 offset:57600
    s_waitcnt vmcnt(5) lgkmcnt(14)
    v_mfma_f32_16x16x32_bf16 v[20:23], v[116:119], v[44:47], v[20:23]
    ds_read_b64_tr_b16 v[116:117], v10 offset:61440
    ds_read_b64_tr_b16 v[118:119], v10 offset:61696
    v_mfma_f32_16x16x32_bf16 v[24:27], v[120:123], v[44:47], v[24:27]
    ds_read_b64_tr_b16 v[120:121], v124 offset:61440
    ds_read_b64_tr_b16 v[122:123], v124 offset:61696
    v_mfma_f32_16x16x32_bf16 v[28:31], v[68:71], v[44:47], v[28:31]
    ds_read_b64_tr_b16 v[68:69], v125 offset:49152
    ds_read_b64_tr_b16 v[70:71], v125 offset:49408
    v_mfma_f32_16x16x32_bf16 v[32:35], v[72:75], v[44:47], v[32:35]
    ds_read_b64_tr_b16 v[72:73], v126 offset:49152
    ds_read_b64_tr_b16 v[74:75], v126 offset:49408
    s_waitcnt vmcnt(4) lgkmcnt(14)
    v_mfma_f32_16x16x32_bf16 v[20:23], v[76:79], v[48:51], v[20:23]
    ds_read_b64_tr_b16 v[76:77], v125 offset:53248
    ds_read_b64_tr_b16 v[78:79], v125 offset:53504
    v_mfma_f32_16x16x32_bf16 v[24:27], v[80:83], v[48:51], v[24:27]
    ds_read_b64_tr_b16 v[80:81], v126 offset:53248
    ds_read_b64_tr_b16 v[82:83], v126 offset:53504
    v_mfma_f32_16x16x32_bf16 v[28:31], v[84:87], v[48:51], v[28:31]
    ds_read_b64_tr_b16 v[84:85], v125 offset:57344
    ds_read_b64_tr_b16 v[86:87], v125 offset:57600
    v_mfma_f32_16x16x32_bf16 v[32:35], v[88:91], v[48:51], v[32:35]
    ds_read_b64_tr_b16 v[88:89], v126 offset:57344
    ds_read_b64_tr_b16 v[90:91], v126 offset:57600
    s_waitcnt vmcnt(2) lgkmcnt(14)
    v_mfma_f32_16x16x32_bf16 v[20:23], v[92:95], v[52:55], v[20:23]
    ds_read_b64_tr_b16 v[92:93], v125 offset:61440
    ds_read_b64_tr_b16 v[94:95], v125 offset:61696
    v_mfma_f32_16x16x32_bf16 v[24:27], v[96:99], v[52:55], v[24:27]
    ds_read_b64_tr_b16 v[96:97], v126 offset:61440
    ds_read_b64_tr_b16 v[98:99], v126 offset:61696
    v_mfma_f32_16x16x32_bf16 v[20:23], v[100:103], v[56:59], v[20:23]
    s_add_u32 s4, s49, 4194304
    v_mfma_f32_16x16x32_bf16 v[24:27], v[104:107], v[56:59], v[24:27]
    s_waitcnt vmcnt(0) lgkmcnt(14)
    v_mfma_f32_16x16x32_bf16 v[20:23], v[108:111], v[60:63], v[20:23]
    v_mfma_f32_16x16x32_bf16 v[24:27], v[112:115], v[60:63], v[24:27]
    v_mfma_f32_16x16x32_bf16 v[20:23], v[116:119], v[64:67], v[20:23]
    v_mfma_f32_16x16x32_bf16 v[24:27], v[120:123], v[64:67], v[24:27]
    s_waitcnt lgkmcnt(8)
    v_mfma_f32_16x16x32_bf16 v[28:31], v[68:71], v[52:55], v[28:31]
    v_mfma_f32_16x16x32_bf16 v[32:35], v[72:75], v[52:55], v[32:35]
    v_mfma_f32_16x16x32_bf16 v[28:31], v[76:79], v[56:59], v[28:31]
    s_nop 2
    v_cvt_pk_bf16_f32 v36, v20, v21
    v_cvt_pk_bf16_f32 v37, v22, v23
    v_mfma_f32_16x16x32_bf16 v[32:35], v[80:83], v[56:59], v[32:35]
    v_cvt_pk_bf16_f32 v38, v24, v25
    v_cvt_pk_bf16_f32 v39, v26, v27
    s_waitcnt lgkmcnt(0)
    v_mfma_f32_16x16x32_bf16 v[28:31], v[84:87], v[60:63], v[28:31]
    s_cmp_eq_u32 s53, 0
    v_permlane16_swap_b32 v36, v38
    v_mfma_f32_16x16x32_bf16 v[32:35], v[88:91], v[60:63], v[32:35]
    v_permlane16_swap_b32 v37, v39
    s_cbranch_scc1 L_slow_68
    buffer_store_dwordx4 v[36:39], v11, s[32:35], s4 offen offset:0
L_back_69:
    v_mfma_f32_16x16x32_bf16 v[28:31], v[92:95], v[64:67], v[28:31]
    v_mfma_f32_16x16x32_bf16 v[32:35], v[96:99], v[64:67], v[32:35]
    v_dot2_f32_bf16 v44, v36, v16, 0
    v_dot2_f32_bf16 v45, v36, v36, 0
    v_dot2_f32_bf16 v44, v37, v16, v44
    v_dot2_f32_bf16 v45, v37, v37, v45
    v_dot2_f32_bf16 v44, v38, v16, v44
    v_dot2_f32_bf16 v45, v38, v38, v45
    v_dot2_f32_bf16 v44, v39, v16, v44
    v_cvt_pk_bf16_f32 v40, v28, v29
    v_cvt_pk_bf16_f32 v41, v30, v31
    v_cvt_pk_bf16_f32 v42, v32, v33
    v_cvt_pk_bf16_f32 v43, v34, v35
    s_cmp_eq_u32 s53, 0
    v_permlane16_swap_b32 v40, v42
    v_permlane16_swap_b32 v41, v43
    s_cbranch_scc1 L_slow_70
    buffer_store_dwordx4 v[40:43], v11, s[32:35], s4 offen offset:1024
L_back_71:
    v_dot2_f32_bf16 v45, v39, v39, v45
    v_dot2_f32_bf16 v44, v40, v16, v44
    v_dot2_f32_bf16 v45, v40, v40, v45
    v_dot2_f32_bf16 v44, v41, v16, v44
    v_dot2_f32_bf16 v45, v41, v41, v45
    v_dot2_f32_bf16 v44, v42, v16, v44
    v_dot2_f32_bf16 v45, v42, v42, v45
    v_dot2_f32_bf16 v44, v43, v16, v44
    v_dot2_f32_bf16 v45, v43, v43, v45
    v_mov_b32 v46, s0
    v_mov_b32 v47, s0
    v_add_u32 v2, 65792, v1
    v_permlane32_swap_b32 v44, v45
    v_add_f32 v44, v44, v45
    v_mov_b32 v45, v44
    s_nop 1
    v_permlane16_swap_b32 v44, v45
    v_add_f32 v44, v44, v45
    v_mov_b32 v45, v44
    s_nop 1
    v_permlane32_swap_b32 v44, v45
    ds_write_b128 v14, v[36:39]
    ds_write_b128 v14, v[40:43] offset:1024
    s_lshl_b32 s6, s38, 11
    s_add_u32 s4, s41, 4194304
    s_add_u32 s3, s4, s6
    s_add_u32 m0, s6, 65792
    s_add_u32 s4, s4, s46
    s_add_u32 s5, s46, 65792
    s_and_b32 s6, s1, 0xfffff800
    v_lshlrev_b32 v119, 6, s38
    v_add_u32 v119, v119, v4
    s_cmp_eq_u32 s53, 0
    s_waitcnt vmcnt(0)
    s_cbranch_scc1 L_slow_72
    buffer_store_dwordx4 v[44:47], v18, s[32:35], s1 offen
L_back_73:
    v_and_b32 v60, 1, v0
    v_lshrrev_b32 v61, 1, v0
    v_sub_u32 v61, 3, v61
    v_lshl_add_u32 v61, v60, 4, v61
    v_cmp_gt_u32 vcc, 8, v0
    v_mov_b32 v62, s58
    v_mov_b32 v63, s59
    v_cndmask_b32 v60, v60, v61, vcc
    v_cndmask_b32 v62, v63, v62, vcc
    v_mul_u32_u24 v60, 2064, v60
    v_lshl_add_u32 v61, s36, 1, v0
    v_cmp_le_u32 vcc, 8, v61
    v_add_u32 v60, v60, v62
    v_mov_b32 v62, 0x3f803f80
    v_cndmask_b32 v17, 0, v62, vcc
    v_cmp_gt_u32 vcc, 10, v0
    v_add_u32 v60, 2048, v60
    v_mov_b32 v63, 161792
    v_cndmask_b32 v16, v63, v60, vcc
    v_lshrrev_b32 v60, 5, v0
    v_and_b32 v61, 15, v0
    v_lshlrev_b32 v61, 4, v61
    v_lshl_add_u32 v60, v60, 8, v61
    v_and_b32 v62, 10, v0
    v_min_u32 v62, 1, v62
    s_waitcnt vmcnt(0)
    buffer_load_dwordx4 v[20:23], v1, s[32:35], s6 offen offset:0 sc1
    buffer_load_dwordx4 v[24:27], v1, s[32:35], s6 offen offset:1024 sc1
    v_and_b32 v63, 16, v0
    v_cmp_eq_u32 vcc, 0, v63
    v_add_u32 v60, 1024, v60
    v_add_u32 v61, 512, v60
    v_mul_u32_u24 v62, 98304, v62
    v_add_u32 v62, 2048, v62
    v_cndmask_b32 v60, v62, v60, vcc
    v_cndmask_b32 v61, v62, v61, vcc
    v_add_u32 v13, s58, v1
    v_add_u32 v14, s59, v60
    v_add_u32 v15, s59, v61
    v_and_b32 v60, 3, v0
    v_sub_u32 v60, s36, v60
    v_subrev_u32 v60, 1, v60
    v_cmp_gt_i32 vcc, 0, v60
    v_mov_b32 v61, s36
    v_mov_b32 v18, 0xf149f2ca
    v_cndmask_b32 v60, v60, v61, vcc
    v_lshlrev_b32 v19, 12, v60
    s_add_u32 s60, s60, 0x400000
    s_add_u32 s61, s61, 0x400000
    s_add_u32 s62, s62, 0x400000
    s_add_u32 s63, s63, 0x400000
    s_add_u32 s56, s56, 0x400000
    s_branch L_xc_75
L_xp_74:
    buffer_load_dwordx4 v[20:23], v1, s[32:35], s6 offen offset:0 sc1
    buffer_load_dwordx4 v[24:27], v1, s[32:35], s6 offen offset:1024 sc1
    s_add_u32 s43, s43, 1
    s_cmp_ge_u32 s43, 0x20000
    s_cbranch_scc1 L_end
L_xc_75:
    s_waitcnt vmcnt(0)
    v_cmp_ne_u32 vcc, s0, v22
    v_cmp_ne_u32 s[96:97], s0, v26
    s_or_b64 exec, vcc, s[96:97]
    s_cbranch_scc1 L_xp_74
    s_mov_b64 exec, -1
    s_barrier
    v_add_f32 v112, v20, v24
    v_add_f32 v113, v21, v25
L_entry3:
    buffer_load_dwordx4 v1, s[32:35], s3 offen offset:0 sc1 lds
    buffer_load_dwordx4 v1, s[32:35], s3 offen offset:1024 sc1 lds
    s_add_u32 m0, m0, 8192
    s_add_u32 s3, s3, 8192
    v_permlane32_swap_b32 v112, v113
    v_add_f32 v112, v112, v113
    v_mov_b32 v113, v112
    s_barrier
    buffer_load_dwordx4 v1, s[32:35], s3 offen offset:0 sc1 lds
    buffer_load_dwordx4 v1, s[32:35], s3 offen offset:1024 sc1 lds
    s_add_u32 m0, s5, 16384
    s_add_u32 s3, s4, 16384
    v_permlane16_swap_b32 v112, v113
    v_add_f32 v112, v112, v113
    v_mov_b32 v113, v112
    s_barrier
    s_nop 0
    v_permlane32_swap_b32 v112, v113
    buffer_load_dwordx4 v1, s[32:35], s3 offen offset:0 sc1 lds
    v_mul_f32 v112, 0xbb000000, v112
    v_mul_f32 v113, 0x3b000000, v113
    v_fma_f32 v113, -v112, v112, v113
    buffer_load_dwordx4 v1, s[32:35], s3 offen offset:1024 sc1 lds
    v_max_f32 v113, 0, v113
    v_add_f32 v113, 0x3727c5ac, v113
    v_rsq_f32 v114, v113
    buffer_load_dwordx4 v1, s[32:35], s3 offen offset:2048 sc1 lds
    v_mul_f32 v112, v112, v114
    ds_write2st64_b32 v119, v114, v112 offset0:0 offset1:1
    s_waitcnt vmcnt(5) lgkmcnt(0)
    s_barrier
    ds_read_b128 a[128:131], v2 offset:0
    ds_read_b128 a[132:135], v2 offset:1024
    ds_read_b128 a[136:139], v2 offset:2048
    ds_read_b128 a[140:143], v2 offset:3072
    ds_read_b128 a[144:147], v2 offset:4096
    ds_read_b128 a[148:151], v2 offset:5120
    ds_read_b128 a[152:155], v2 offset:6144
    s_waitcnt lgkmcnt(6)
    v_mfma_f32_16x16x32_bf16 v[28:31], v[128:131], a[128:131], 0
    buffer_load_dwordx4 v1, s[32:35], s3 offen offset:3072 sc1 lds
    ds_read_b128 v[104:107], v5 offset:832
    v_mfma_f32_16x16x32_bf16 v[32:35], a[128:131], v[192:195], 0
    ds_read_b32 v108, v6 offset:896
    ds_read_b128 v[124:127], v5 offset:768
    v_xor_b32 v101, 32, v9
    v_mfma_f32_16x16x32_bf16 v[44:47], a[192:195], a[128:131], 0
    ds_read_b128 a[156:159], v2 offset:7168
    v_xor_b32 v102, 64, v9
    v_xor_b32 v103, 96, v9
    s_waitcnt lgkmcnt(9)
    v_mfma_f32_16x16x32_bf16 v[28:31], v[132:135], a[132:135], v[28:31]
    s_add_u32 m0, s5, 32768
    s_add_u32 s3, s4, 32768
    v_add_u32 v122, s59, v1
    v_mfma_f32_16x16x32_bf16 v[32:35], a[132:135], v[196:199], v[32:35]
    buffer_load_dwordx4 v1, s[32:35], s3 offen offset:0 sc1 lds
    v_mfma_f32_16x16x32_bf16 v[44:47], a[196:199], a[132:135], v[44:47]
    s_lshl_b32 s99, s36, 12
    s_add_u32 s99, s99, s57
    s_waitcnt lgkmcnt(8)
    v_mfma_f32_16x16x32_bf16 v[28:31], v[136:139], a[136:139], v[28:31]
    s_add_u32 s98, s99, 0x20000
    v_lshrrev_b32 v100, 3, v0
    v_mfma_f32_16x16x32_bf16 v[32:35], a[136:139], v[200:203], v[32:35]
    v_min_u32 v100, 1, v100
    v_lshl_add_u32 v100, v100, 26, v1
    v_mfma_f32_16x16x32_bf16 v[44:47], a[200:203], a[136:139], v[44:47]
    v_mov_b32 v96, s39
    v_mov_b32 v97, s39
    s_waitcnt lgkmcnt(7)
    v_mfma_f32_16x16x32_bf16 v[28:31], v[140:143], a[140:143], v[28:31]
    buffer_load_dwordx4 v1, s[32:35], s3 offen offset:1024 sc1 lds
    v_mfma_f32_16x16x32_bf16 v[32:35], a[140:143], v[204:207], v[32:35]
    v_mov_b32 v98, s39
    v_mov_b32 v99, s39
    v_mfma_f32_16x16x32_bf16 v[44:47], a[204:207], a[140:143], v[44:47]
    s_waitcnt vmcnt(6)
    s_barrier
    ds_read_b128 a[160:163], v2 offset:8192
    ds_read_b128 a[164:167], v2 offset:9216
    ds_read_b128 a[168:171], v2 offset:10240
    s_waitcnt lgkmcnt(3)
    v_mfma_f32_16x16x32_bf16 v[28:31], v[144:147], a[144:147], v[28:31]
    v_mul_f32 v124, 0x3eb8aa3b, v124
    v_mul_f32 v125, 0x3eb8aa3b, v125
    v_mfma_f32_16x16x32_bf16 v[32:35], a[144:147], v[208:211], v[32:35]
    buffer_load_dwordx4 v1, s[32:35], s3 offen offset:2048 sc1 lds
    v_mfma_f32_16x16x32_bf16 v[44:47], a[208:211], a[144:147], v[44:47]
    ds_read_b128 a[172:175], v2 offset:11264
    v_mul_f32 v126, 0x3eb8aa3b, v126
    v_mfma_f32_16x16x32_bf16 v[28:31], v[148:151], a[148:151], v[28:31]
    v_mul_f32 v127, 0x3eb8aa3b, v127
    ds_read_b128 v[52:55], v3 offset:0
    v_mfma_f32_16x16x32_bf16 v[32:35], a[148:151], v[212:215], v[32:35]
    ds_read_b128 v[56:59], v3 offset:256
    ds_read2_b32 v[22:23], v4 offset0:0 offset1:64
    v_mfma_f32_16x16x32_bf16 v[44:47], a[212:215], a[148:151], v[44:47]
    ds_read_b128 a[176:179], v2 offset:12288
    v_cndmask_b32 v60, v18, 0, s[64:65]
    v_mfma_f32_16x16x32_bf16 v[28:31], v[152:155], a[152:155], v[28:31]
    buffer_load_dwordx4 v1, s[32:35], s3 offen offset:3072 sc1 lds
    v_mfma_f32_16x16x32_bf16 v[32:35], a[152:155], v[216:219], v[32:35]
    v_cndmask_b32 v61, v18, 0, s[66:67]
    v_cndmask_b32 v62, v18, 0, s[68:69]
    v_mfma_f32_16x16x32_bf16 v[44:47], a[216:219], a[152:155], v[44:47]
    ds_read_b128 a[180:183], v2 offset:13312
    v_cndmask_b32 v63, v18, 0, s[70:71]
    v_mfma_f32_16x16x32_bf16 v[28:31], v[156:159], a[156:159], v[28:31]
    s_add_u32 m0, s5, 49152
    s_add_u32 s3, s4, 49152
    v_mfma_f32_16x16x32_bf16 v[32:35], a[156:159], v[220:223], v[32:35]
    buffer_load_dwordx4 v1, s[32:35], s3 offen offset:0 sc1 lds
    v_mfma_f32_16x16x32_bf16 v[44:47], a[220:223], a[156:159], v[44:47]
    ds_read_b128 a[184:187], v2 offset:14336
    s_waitcnt lgkmcnt(6)
    v_mfma_f32_16x16x32_bf16 v[28:31], v[160:163], a[160:163], v[28:31]
    v_cndmask_b32 v64, v18, 0, s[72:73]
    v_cndmask_b32 v65, v18, 0, s[74:75]
    v_mfma_f32_16x16x32_bf16 v[32:35], a[160:163], v[224:227], v[32:35]
    v_cndmask_b32 v66, v18, 0, s[76:77]
    v_cndmask_b32 v67, v18, 0, s[78:79]
    v_mfma_f32_16x16x32_bf16 v[44:47], a[224:227], a[160:163], v[44:47]
    ds_read_b128 a[188:191], v2 offset:15360
    v_cndmask_b32 v68, v18, 0, s[80:81]
    v_mfma_f32_16x16x32_bf16 v[28:31], v[164:167], a[164:167], v[28:31]
    buffer_load_dwordx4 v1, s[32:35], s3 offen offset:1024 sc1 lds
    v_mfma_f32_16x16x32_bf16 v[32:35], a[164:167], v[228:231], v[32:35]
    v_cndmask_b32 v69, v18, 0, s[82:83]
    v_cndmask_b32 v70, v18, 0, s[84:85]
    v_mfma_f32_16x16x32_bf16 v[44:47], a[228:231], a[164:167], v[44:47]
    v_cndmask_b32 v71, v18, 0, s[86:87]
    v_cndmask_b32 v72, v18, 0, s[88:89]
    v_mfma_f32_16x16x32_bf16 v[28:31], v[168:171], a[168:171], v[28:31]
    v_cndmask_b32 v73, v18, 0, s[90:91]
    v_cndmask_b32 v74, v18, 0, s[92:93]
    v_mfma_f32_16x16x32_bf16 v[32:35], a[168:171], v[232:235], v[32:35]
    buffer_load_dwordx4 v1, s[32:35], s3 offen offset:2048 sc1 lds
    v_mfma_f32_16x16x32_bf16 v[44:47], a[232:235], a[168:171], v[44:47]
    v_cndmask_b32 v75, v18, 0, s[94:95]
    s_waitcnt lgkmcnt(4)
    v_mfma_f32_16x16x32_bf16 v[28:31], v[172:175], a[172:175], v[28:31]
    v_mul_f32 v76, v23, v104
    v_mul_f32 v77, v23, v105
    v_mfma_f32_16x16x32_bf16 v[32:35], a[172:175], v[236:239], v[32:35]
    v_mul_f32 v78, v23, v106
    v_mul_f32 v79, v23, v107
    v_mfma_f32_16x16x32_bf16 v[44:47], a[236:239], a[172:175], v[44:47]
    s_waitcnt vmcnt(7)
    s_barrier
    ds_read_b128 a[0:3], v2 offset:16384
    ds_read_b128 a[4:7], v2 offset:17408
    ds_read_b128 a[8:11], v2 offset:18432
    s_waitcnt lgkmcnt(3)
    v_mfma_f32_16x16x32_bf16 v[28:31], v[176:179], a[176:179], v[28:31]
    buffer_load_dwordx4 v1, s[32:35], s3 offen offset:3072 sc1 lds
    v_mfma_f32_16x16x32_bf16 v[32:35], a[176:179], v[240:243], v[32:35]
    v_mul_f32 v56, v56, v108
    v_mul_f32 v57, v57, v108
    v_mfma_f32_16x16x32_bf16 v[44:47], a[240:243], a[176:179], v[44:47]
    ds_read_b128 a[12:15], v2 offset:19456
    v_mul_f32 v58, v58, v108
    v_mfma_f32_16x16x32_bf16 v[28:31], v[180:183], a[180:183], v[28:31]
    s_add_u32 m0, s44, 0
    s_xor_b32 s7, s47, 0
    v_mfma_f32_16x16x32_bf16 v[32:35], a[180:183], v[244:247], v[32:35]
    buffer_load_dwordx4 v9, s[24:27], s7 offen offset:0 lds
    v_mfma_f32_16x16x32_bf16 v[44:47], a[244:247], a[180:183], v[44:47]
    ds_read_b128 a[16:19], v2 offset:20480
    v_mul_f32 v59, v59, v108
    v_mfma_f32_16x16x32_bf16 v[28:31], v[184:187], a[184:187], v[28:31]
    v_mfma_f32_16x16x32_bf16 v[32:35], a[184:187], v[248:251], v[32:35]
    v_mfma_f32_16x16x32_bf16 v[44:47], a[248:251], a[184:187], v[44:47]
    ds_read_b128 a[20:23], v2 offset:21504
    v_mfma_f32_16x16x32_bf16 v[28:31], v[188:191], a[188:191], v[28:31]
    buffer_load_dwordx4 v101, s[24:27], s7 offen offset:1024 lds
    v_mfma_f32_16x16x32_bf16 v[32:35], a[188:191], v[252:255], v[32:35]
    v_mfma_f32_16x16x32_bf16 v[44:47], a[252:255], a[188:191], v[44:47]
    ds_read_b128 a[24:27], v2 offset:22528
    s_waitcnt lgkmcnt(3)
    v_mfma_f32_16x16x32_bf16 v[36:39], v[128:131], a[0:3], 0
    buffer_load_dwordx4 v102, s[24:27], s7 offen offset:2048 lds
    v_mfma_f32_16x16x32_bf16 v[40:43], a[0:3], v[192:195], 0
    ds_read_b128 a[28:31], v2 offset:23552
    v_mfma_f32_16x16x32_bf16 v[36:39], v[132:135], a[4:7], v[36:39]
    v_fma_f32 v28, v28, v22, v76
    v_fma_f32 v29, v29, v22, v77
    v_fma_f32 v30, v30, v22, v78
    v_mfma_f32_16x16x32_bf16 v[40:43], a[4:7], v[196:199], v[40:43]
    ds_read_b128 a[32:35], v2 offset:24576
    v_fma_f32 v31, v31, v22, v79
    v_fma_f32 v32, v32, v52, v56
    v_mfma_f32_16x16x32_bf16 v[36:39], v[136:139], a[8:11], v[36:39]
    buffer_load_dwordx4 v103, s[24:27], s7 offen offset:3072 lds
    v_mfma_f32_16x16x32_bf16 v[40:43], a[8:11], v[200:203], v[40:43]
    ds_read_b128 a[36:39], v2 offset:25600
    v_fma_f32 v33, v33, v53, v57
    v_mfma_f32_16x16x32_bf16 v[36:39], v[140:143], a[12:15], v[36:39]
    v_fma_f32 v34, v34, v54, v58
    v_fma_f32 v35, v35, v55, v59
    v_mfma_f32_16x16x32_bf16 v[40:43], a[12:15], v[204:207], v[40:43]
    s_add_u32 m0, s44, 4096
    s_xor_b32 s7, s47, 32768
    ds_read_b128 a[40:43], v2 offset:26624
    s_waitcnt lgkmcnt(3)
    v_mfma_f32_16x16x32_bf16 v[36:39], v[144:147], a[16:19], v[36:39]
    buffer_load_dwordx4 v9, s[24:27], s7 offen offset:0 lds
    v_mfma_f32_16x16x32_bf16 v[40:43], a[16:19], v[208:211], v[40:43]
    ds_read_b128 a[44:47], v2 offset:27648
    v_cvt_pk_bf16_f32 v80, v28, v29
    v_mfma_f32_16x16x32_bf16 v[36:39], v[148:151], a[20:23], v[36:39]
    v_cvt_pk_bf16_f32 v81, v30, v31
    v_cvt_pk_bf16_f32 v88, v32, v33
    v_mfma_f32_16x16x32_bf16 v[40:43], a[20:23], v[212:215], v[40:43]
    ds_read_b128 a[48:51], v2 offset:28672
    v_cvt_pk_bf16_f32 v89, v34, v35
    v_mfma_f32_16x16x32_bf16 v[36:39], v[152:155], a[24:27], v[36:39]
    buffer_load_dwordx4 v101, s[24:27], s7 offen offset:1024 lds
    v_mfma_f32_16x16x32_bf16 v[40:43], a[24:27], v[216:219], v[40:43]
    ds_read_b128 a[52:55], v2 offset:29696
    ds_read_b128 v[52:55], v3 offset:64
    v_mfma_f32_16x16x32_bf16 v[36:39], v[156:159], a[28:31], v[36:39]
    ds_read_b128 v[56:59], v3 offset:320
    ds_read2_b32 v[116:117], v4 offset0:16 offset1:80
    v_mfma_f32_16x16x32_bf16 v[40:43], a[28:31], v[220:223], v[40:43]
    ds_read_b128 a[56:59], v2 offset:30720
    s_waitcnt lgkmcnt(6)
    v_mfma_f32_16x16x32_bf16 v[36:39], v[160:163], a[32:35], v[36:39]
    buffer_load_dwordx4 v102, s[24:27], s7 offen offset:2048 lds
    v_mfma_f32_16x16x32_bf16 v[40:43], a[32:35], v[224:227], v[40:43]
    ds_read_b128 a[60:63], v2 offset:31744
    s_waitcnt lgkmcnt(2)
    v_mfma_f32_16x16x32_bf16 v[36:39], v[164:167], a[36:39], v[36:39]
    v_mul_f32 v76, v117, v104
    v_mul_f32 v77, v117, v105
    v_mfma_f32_16x16x32_bf16 v[40:43], a[36:39], v[228:231], v[40:43]
    s_waitcnt vmcnt(11)
    s_barrier
    ds_read_b128 a[64:67], v2 offset:32768
    v_mfma_f32_16x16x32_bf16 v[36:39], v[168:171], a[40:43], v[36:39]
    buffer_load_dwordx4 v103, s[24:27], s7 offen offset:3072 lds
    v_mfma_f32_16x16x32_bf16 v[40:43], a[40:43], v[232:235], v[40:43]
    ds_read_b128 a[68:71], v2 offset:33792
    v_mul_f32 v78, v117, v106
    v_mfma_f32_16x16x32_bf16 v[36:39], v[172:175], a[44:47], v[36:39]
    v_mul_f32 v79, v117, v107
L_pad8:
    s_cbranch_execz L_warm2
    v_mul_f32 v56, v56, v108
    v_mfma_f32_16x16x32_bf16 v[40:43], a[44:47], v[236:239], v[40:43]
    s_add_u32 m0, s44, 8192
    s_xor_b32 s7, s47, 65536
    ds_read_b128 a[72:75], v2 offset:34816
    s_waitcnt lgkmcnt(3)
    v_mfma_f32_16x16x32_bf16 v[36:39], v[176:179], a[48:51], v[36:39]
    buffer_load_dwordx4 v9, s[24:27], s7 offen offset:0 lds
    v_mfma_f32_16x16x32_bf16 v[40:43], a[48:51], v[240:243], v[40:43]
    ds_read_b128 a[76:79], v2 offset:35840
    v_mul_f32 v57, v57, v108
    v_mfma_f32_16x16x32_bf16 v[36:39], v[180:183], a[52:55], v[36:39]
    v_mul_f32 v58, v58, v108
    v_mul_f32 v59, v59, v108
    v_mfma_f32_16x16x32_bf16 v[40:43], a[52:55], v[244:247], v[40:43]
    ds_read_b128 a[80:83], v2 offset:36864
    v_mfma_f32_16x16x32_bf16 v[36:39], v[184:187], a[56:59], v[36:39]
    buffer_load_dwordx4 v101, s[24:27], s7 offen offset:1024 lds
    v_mfma_f32_16x16x32_bf16 v[40:43], a[56:59], v[248:251], v[40:43]
    ds_read_b128 a[84:87], v2 offset:37888
    v_mfma_f32_16x16x32_bf16 v[36:39], v[188:191], a[60:63], v[36:39]
    v_mfma_f32_16x16x32_bf16 v[40:43], a[60:63], v[252:255], v[40:43]
    ds_read_b128 a[88:91], v2 offset:38912
    s_waitcnt lgkmcnt(3)
    v_mfma_f32_16x16x32_bf16 v[28:31], v[128:131], a[64:67], 0
    buffer_load_dwordx4 v102, s[24:27], s7 offen offset:2048 lds
    v_mfma_f32_16x16x32_bf16 v[32:35], a[64:67], v[192:195], 0
    ds_read_b128 a[92:95], v2 offset:39936
    v_mfma_f32_16x16x32_bf16 v[28:31], v[132:135], a[68:71], v[28:31]
    v_fma_f32 v36, v36, v116, v76
    v_fma_f32 v37, v37, v116, v77
    v_mfma_f32_16x16x32_bf16 v[32:35], a[68:71], v[196:199], v[32:35]
    ds_read_b128 a[96:99], v2 offset:40960
    v_fma_f32 v38, v38, v116, v78
    v_mfma_f32_16x16x32_bf16 v[28:31], v[136:139], a[72:75], v[28:31]
    v_fma_f32 v39, v39, v116, v79
    v_cvt_pk_bf16_f32 v82, v36, v37
    v_mfma_f32_16x16x32_bf16 v[32:35], a[72:75], v[200:203], v[32:35]
    ds_read_b128 a[100:103], v2 offset:41984
    v_cvt_pk_bf16_f32 v83, v38, v39
    v_mfma_f32_16x16x32_bf16 v[28:31], v[140:143], a[76:79], v[28:31]
    v_fma_f32 v40, v40, v52, v56
    v_fma_f32 v41, v41, v53, v57
    v_mfma_f32_16x16x32_bf16 v[32:35], a[76:79], v[204:207], v[32:35]
    ds_read_b128 a[104:107], v2 offset:43008
    s_waitcnt lgkmcnt(3)
    v_mfma_f32_16x16x32_bf16 v[28:31], v[144:147], a[80:83], v[28:31]
    v_permlane16_swap_b32 v80, v82
    v_permlane16_swap_b32 v81, v83
    v_mfma_f32_16x16x32_bf16 v[32:35], a[80:83], v[208:211], v[32:35]
    ds_read_b128 a[108:111], v2 offset:44032
    v_mfma_f32_16x16x32_bf16 v[28:31], v[148:151], a[84:87], v[28:31]
    buffer_store_dwordx4 v[80:83], v1, s[32:35], s56 offen offset:0 sc1
    v_mfma_f32_16x16x32_bf16 v[32:35], a[84:87], v[212:215], v[32:35]
    ds_read_b128 a[112:115], v2 offset:45056
    v_fma_f32 v42, v42, v54, v58
    v_mfma_f32_16x16x32_bf16 v[28:31], v[152:155], a[88:91], v[28:31]
    v_fma_f32 v43, v43, v55, v59
    v_cvt_pk_bf16_f32 v90, v40, v41
    v_mfma_f32_16x16x32_bf16 v[32:35], a[88:91], v[216:219], v[32:35]
    ds_read_b128 a[116:119], v2 offset:46080
    v_cvt_pk_bf16_f32 v91, v42, v43
    v_mfma_f32_16x16x32_bf16 v[28:31], v[156:159], a[92:95], v[28:31]
    ds_read_b128 v[52:55], v3 offset:128
    ds_read_b128 v[56:59], v3 offset:384
    v_mfma_f32_16x16x32_bf16 v[32:35], a[92:95], v[220:223], v[32:35]
    ds_read_b128 a[120:123], v2 offset:47104
    s_waitcnt lgkmcnt(5)
    v_mfma_f32_16x16x32_bf16 v[28:31], v[160:163], a[96:99], v[28:31]
    ds_read2_b32 v[120:121], v4 offset0:32 offset1:96
    v_permlane32_swap_b32 v88, v90
    v_mfma_f32_16x16x32_bf16 v[32:35], a[96:99], v[224:227], v[32:35]
    ds_read_b128 a[124:127], v2 offset:48128
    v_permlane32_swap_b32 v89, v91
    v_mfma_f32_16x16x32_bf16 v[28:31], v[164:167], a[100:103], v[28:31]
    buffer_store_dwordx4 v[88:91], v1, s[32:35], s56 offen offset:1024 sc1
    v_mfma_f32_16x16x32_bf16 v[32:35], a[100:103], v[228:231], v[32:35]
    s_waitcnt vmcnt(13)
    s_barrier
    ds_read_b128 a[128:131], v2 offset:49152
    v_mfma_f32_16x16x32_bf16 v[28:31], v[168:171], a[104:107], v[28:31]
    s_waitcnt lgkmcnt(2)
    v_mul_f32 v76, v121, v104
    v_mfma_f32_16x16x32_bf16 v[32:35], a[104:107], v[232:235], v[32:35]
    ds_read_b128 a[132:135], v2 offset:50176
    v_mul_f32 v77, v121, v105
    v_mfma_f32_16x16x32_bf16 v[28:31], v[172:175], a[108:111], v[28:31]
    v_mul_f32 v78, v121, v106
    v_mul_f32 v79, v121, v107
    v_mfma_f32_16x16x32_bf16 v[32:35], a[108:111], v[236:239], v[32:35]
    ds_read_b128 a[136:139], v2 offset:51200
    s_waitcnt lgkmcnt(3)
    v_mfma_f32_16x16x32_bf16 v[28:31], v[176:179], a[112:115], v[28:31]
    buffer_store_dwordx4 v[96:99], v100, s[32:35], s99 offen sc1
    v_mfma_f32_16x16x32_bf16 v[32:35], a[112:115], v[240:243], v[32:35]
    ds_read_b128 a[140:143], v2 offset:52224
    v_mul_f32 v56, v56, v108
    v_mfma_f32_16x16x32_bf16 v[28:31], v[180:183], a[116:119], v[28:31]
    v_mul_f32 v57, v57, v108
    v_mul_f32 v58, v58, v108
    v_mfma_f32_16x16x32_bf16 v[32:35], a[116:119], v[244:247], v[32:35]
    ds_read_b128 a[144:147], v2 offset:53248
    v_mul_f32 v59, v59, v108
    v_mfma_f32_16x16x32_bf16 v[28:31], v[184:187], a[120:123], v[28:31]
    v_mfma_f32_16x16x32_bf16 v[32:35], a[120:123], v[248:251], v[32:35]
    ds_read_b128 a[148:151], v2 offset:54272
    v_mfma_f32_16x16x32_bf16 v[28:31], v[188:191], a[124:127], v[28:31]
    v_mfma_f32_16x16x32_bf16 v[32:35], a[124:127], v[252:255], v[32:35]
    ds_read_b128 a[152:155], v2 offset:55296
    s_waitcnt lgkmcnt(3)
    v_mfma_f32_16x16x32_bf16 v[36:39], v[128:131], a[128:131], 0
    v_mfma_f32_16x16x32_bf16 v[40:43], a[128:131], v[192:195], 0
    ds_read_b128 a[156:159], v2 offset:56320
    v_mfma_f32_16x16x32_bf16 v[36:39], v[132:135], a[132:135], v[36:39]
    buffer_load_dwordx4 v103, s[24:27], s7 offen offset:3072 lds
    v_fma_f32 v28, v28, v120, v76
    v_mfma_f32_16x16x32_bf16 v[40:43], a[132:135], v[196:199], v[40:43]
    ds_read_b128 a[160:163], v2 offset:57344
    v_fma_f32 v29, v29, v120, v77
    v_fma_f32 v30, v30, v120, v78
    v_mfma_f32_16x16x32_bf16 v[36:39], v[136:139], a[136:139], v[36:39]
    v_fma_f32 v31, v31, v120, v79
    v_fma_f32 v32, v32, v52, v56
    v_mfma_f32_16x16x32_bf16 v[40:43], a[136:139], v[200:203], v[40:43]
    ds_read_b128 a[164:167], v2 offset:58368
    v_fma_f32 v33, v33, v53, v57
    v_mfma_f32_16x16x32_bf16 v[36:39], v[140:143], a[140:143], v[36:39]
    v_fma_f32 v34, v34, v54, v58
    v_fma_f32 v35, v35, v55, v59
    v_mfma_f32_16x16x32_bf16 v[40:43], a[140:143], v[204:207], v[40:43]
    s_add_u32 m0, s44, 12288
    s_xor_b32 s7, s47, 98304
    ds_read_b128 a[168:171], v2 offset:59392
    s_waitcnt lgkmcnt(3)
    v_mfma_f32_16x16x32_bf16 v[36:39], v[144:147], a[144:147], v[36:39]
    buffer_load_dwordx4 v9, s[24:27], s7 offen offset:0 lds
    v_mfma_f32_16x16x32_bf16 v[40:43], a[144:147], v[208:211], v[40:43]
    ds_read_b128 a[172:175], v2 offset:60416
    v_cvt_pk_bf16_f32 v84, v28, v29
    v_mfma_f32_16x16x32_bf16 v[36:39], v[148:151], a[148:151], v[36:39]
    v_cvt_pk_bf16_f32 v85, v30, v31
    v_cvt_pk_bf16_f32 v92, v32, v33
    v_mfma_f32_16x16x32_bf16 v[40:43], a[148:151], v[212:215], v[40:43]
    ds_read_b128 a[176:179], v2 offset:61440
    v_cvt_pk_bf16_f32 v93, v34, v35
    v_mfma_f32_16x16x32_bf16 v[36:39], v[152:155], a[152:155], v[36:39]
    ds_read_b128 v[52:55], v3 offset:192
    ds_read_b128 v[56:59], v3 offset:448
    v_mfma_f32_16x16x32_bf16 v[40:43], a[152:155], v[216:219], v[40:43]
    ds_read_b128 a[180:183], v2 offset:62464
    ds_read2_b32 v[110:111], v4 offset0:48 offset1:112
    v_mfma_f32_16x16x32_bf16 v[36:39], v[156:159], a[156:159], v[36:39]
    buffer_load_dwordx4 v101, s[24:27], s7 offen offset:1024 lds
    v_mfma_f32_16x16x32_bf16 v[40:43], a[156:159], v[220:223], v[40:43]
    ds_read_b128 a[184:187], v2 offset:63488
    s_waitcnt lgkmcnt(6)
    v_mfma_f32_16x16x32_bf16 v[36:39], v[160:163], a[160:163], v[36:39]
    ds_write_b128 v122, v[88:91] offset:1024
    v_mul_f32 v112, v23, v124
    v_mfma_f32_16x16x32_bf16 v[40:43], a[160:163], v[224:227], v[40:43]
    ds_read_b128 a[188:191], v2 offset:64512
    v_mul_f32 v113, v23, v125
    v_mfma_f32_16x16x32_bf16 v[36:39], v[164:167], a[164:167], v[36:39]
    v_mul_f32 v114, v23, v126
    v_mul_f32 v115, v23, v127
    v_mfma_f32_16x16x32_bf16 v[40:43], a[164:167], v[228:231], v[40:43]
    v_mul_f32 v22, 0x3eb8aa3b, v22
    v_fma_f32 v44, v44, v22, v112
    v_mfma_f32_16x16x32_bf16 v[36:39], v[168:171], a[168:171], v[36:39]
    buffer_load_dwordx4 v102, s[24:27], s7 offen offset:2048 lds
    v_mfma_f32_16x16x32_bf16 v[40:43], a[168:171], v[232:235], v[40:43]
    v_fma_f32 v45, v45, v22, v113
    v_fma_f32 v46, v46, v22, v114
    v_mfma_f32_16x16x32_bf16 v[36:39], v[172:175], a[172:175], v[36:39]
    v_fma_f32 v47, v47, v22, v115
    v_cvt_pk_bf16_f32 v20, v44, v45
    v_mfma_f32_16x16x32_bf16 v[40:43], a[172:175], v[236:239], v[40:43]
    v_cvt_pk_bf16_f32 v21, v46, v47
    s_waitcnt lgkmcnt(0)
    v_mfma_f32_16x16x32_bf16 v[36:39], v[176:179], a[176:179], v[36:39]
    v_mul_f32 v76, v111, v104
    v_mfma_f32_16x16x32_bf16 v[40:43], a[176:179], v[240:243], v[40:43]
    v_mul_f32 v77, v111, v105
    v_mul_f32 v78, v111, v106
    v_mfma_f32_16x16x32_bf16 v[36:39], v[180:183], a[180:183], v[36:39]
    buffer_load_dwordx4 v103, s[24:27], s7 offen offset:3072 lds
    v_mfma_f32_16x16x32_bf16 v[40:43], a[180:183], v[244:247], v[40:43]
    v_mul_f32 v79, v111, v107
    v_mul_f32 v56, v56, v108
    v_mfma_f32_16x16x32_bf16 v[36:39], v[184:187], a[184:187], v[36:39]
    v_mul_f32 v57, v57, v108
    v_mul_f32 v58, v58, v108
    v_mfma_f32_16x16x32_bf16 v[40:43], a[184:187], v[248:251], v[40:43]
    v_mul_f32 v59, v59, v108
    s_add_u32 s5, s57, 0x20000
    v_mfma_f32_16x16x32_bf16 v[36:39], v[188:191], a[188:191], v[36:39]
    s_sub_u32 s4, s58, s59
    s_add_u32 s3, s99, 0x40000
    v_mfma_f32_16x16x32_bf16 v[40:43], a[188:191], v[252:255], v[40:43]
    v_mfma_f32_16x16x32_bf16 v[48:51], a[192:195], a[0:3], 0
    s_barrier
    ds_write2_b32 v16, v17, v17 offset0:0 offset1:1
    v_mfma_f32_16x16x32_bf16 v[48:51], a[196:199], a[4:7], v[48:51]
    ds_write2_b32 v16, v17, v17 offset0:2 offset1:3
    v_mfma_f32_16x16x32_bf16 v[48:51], a[200:203], a[8:11], v[48:51]
    v_fma_f32 v36, v36, v110, v76
    v_fma_f32 v37, v37, v110, v77
    v_mfma_f32_16x16x32_bf16 v[48:51], a[204:207], a[12:15], v[48:51]
    buffer_load_dword v118, v19, s[32:35], s57 offen offset:0 sc1
    v_mfma_f32_16x16x32_bf16 v[48:51], a[208:211], a[16:19], v[48:51]
    v_fma_f32 v38, v38, v110, v78
    v_fma_f32 v39, v39, v110, v79
    v_mfma_f32_16x16x32_bf16 v[48:51], a[212:215], a[20:23], v[48:51]
    v_cvt_pk_bf16_f32 v86, v36, v37
    v_cvt_pk_bf16_f32 v87, v38, v39
    v_mfma_f32_16x16x32_bf16 v[48:51], a[216:219], a[24:27], v[48:51]
    v_fma_f32 v40, v40, v52, v56
    v_fma_f32 v41, v41, v53, v57
    v_mfma_f32_16x16x32_bf16 v[48:51], a[220:223], a[28:31], v[48:51]
    v_permlane16_swap_b32 v84, v86
    v_permlane16_swap_b32 v85, v87
    v_mfma_f32_16x16x32_bf16 v[48:51], a[224:227], a[32:35], v[48:51]
    buffer_store_dwordx4 v[84:87], v1, s[32:35], s56 offen offset:2048 sc1
    v_mfma_f32_16x16x32_bf16 v[48:51], a[228:231], a[36:39], v[48:51]
    v_fma_f32 v42, v42, v54, v58
    v_fma_f32 v43, v43, v55, v59
    v_mfma_f32_16x16x32_bf16 v[48:51], a[232:235], a[40:43], v[48:51]
    v_cvt_pk_bf16_f32 v94, v40, v41
    v_cvt_pk_bf16_f32 v95, v42, v43
    v_mfma_f32_16x16x32_bf16 v[48:51], a[236:239], a[44:47], v[48:51]
    v_permlane32_swap_b32 v92, v94
    v_permlane32_swap_b32 v93, v95
    v_mfma_f32_16x16x32_bf16 v[48:51], a[240:243], a[48:51], v[48:51]
    v_mul_f32 v112, v117, v124
    v_mul_f32 v113, v117, v125
    v_mfma_f32_16x16x32_bf16 v[48:51], a[244:247], a[52:55], v[48:51]
    v_mul_f32 v114, v117, v126
    v_mul_f32 v115, v117, v127
    v_mfma_f32_16x16x32_bf16 v[48:51], a[248:251], a[56:59], v[48:51]
    v_mul_f32 v116, 0x3eb8aa3b, v116
    v_mfma_f32_16x16x32_bf16 v[48:51], a[252:255], a[60:63], v[48:51]
    buffer_store_dwordx4 v[92:95], v1, s[32:35], s56 offen offset:3072 sc1
    v_mfma_f32_16x16x32_bf16 v[44:47], a[192:195], a[64:67], 0
    v_mfma_f32_16x16x32_bf16 v[44:47], a[196:199], a[68:71], v[44:47]
    v_mfma_f32_16x16x32_bf16 v[44:47], a[200:203], a[72:75], v[44:47]
    s_nop 3
    v_fma_f32 v48, v48, v116, v112
    v_fma_f32 v49, v49, v116, v113
    v_mfma_f32_16x16x32_bf16 v[44:47], a[204:207], a[76:79], v[44:47]
    v_fma_f32 v50, v50, v116, v114
    v_fma_f32 v51, v51, v116, v115
    v_mfma_f32_16x16x32_bf16 v[44:47], a[208:211], a[80:83], v[44:47]
    v_cvt_pk_bf16_f32 v22, v48, v49
    v_cvt_pk_bf16_f32 v23, v50, v51
    v_mfma_f32_16x16x32_bf16 v[44:47], a[212:215], a[84:87], v[44:47]
    buffer_store_dwordx4 v[96:99], v100, s[32:35], s98 offen sc1
    v_mfma_f32_16x16x32_bf16 v[44:47], a[216:219], a[88:91], v[44:47]
    v_permlane16_swap_b32 v20, v22
    v_permlane16_swap_b32 v21, v23
    v_mfma_f32_16x16x32_bf16 v[44:47], a[220:223], a[92:95], v[44:47]
    v_mul_f32 v112, v121, v124
    v_mul_f32 v113, v121, v125
    v_mfma_f32_16x16x32_bf16 v[44:47], a[224:227], a[96:99], v[44:47]
    v_mul_f32 v114, v121, v126
    v_mul_f32 v115, v121, v127
    v_mfma_f32_16x16x32_bf16 v[44:47], a[228:231], a[100:103], v[44:47]
    v_mul_f32 v120, 0x3eb8aa3b, v120
    v_mfma_f32_32x32x16_bf16 v[192:207], v[80:83], v[20:23], v[60:75]
    ds_write_b128 v122, v[92:95] offset:3088
    v_mul_f32 v176, v111, v124
    v_mul_f32 v177, v111, v125
    v_mfma_f32_16x16x32_bf16 v[44:47], a[232:235], a[104:107], v[44:47]
    v_mul_f32 v178, v111, v126
    v_mul_f32 v179, v111, v127
    v_mfma_f32_16x16x32_bf16 v[44:47], a[236:239], a[108:111], v[44:47]
    v_mul_f32 v110, 0x3eb8aa3b, v110
    v_mfma_f32_16x16x32_bf16 v[44:47], a[240:243], a[112:115], v[44:47]
    v_mfma_f32_16x16x32_bf16 v[44:47], a[244:247], a[116:119], v[44:47]
    v_mfma_f32_16x16x32_bf16 v[44:47], a[248:251], a[120:123], v[44:47]
    v_mfma_f32_16x16x32_bf16 v[44:47], a[252:255], a[124:127], v[44:47]
    v_mfma_f32_16x16x32_bf16 v[48:51], a[192:195], a[128:131], 0
    v_mfma_f32_16x16x32_bf16 v[48:51], a[196:199], a[132:135], v[48:51]
    v_mfma_f32_16x16x32_bf16 v[48:51], a[200:203], a[136:139], v[48:51]
    s_nop 4
    v_fma_f32 v44, v44, v120, v112
    v_fma_f32 v45, v45, v120, v113
    v_mfma_f32_16x16x32_bf16 v[48:51], a[204:207], a[140:143], v[48:51]
    v_fma_f32 v46, v46, v120, v114
    v_fma_f32 v47, v47, v120, v115
    v_mfma_f32_16x16x32_bf16 v[48:51], a[208:211], a[144:147], v[48:51]
    v_cvt_pk_bf16_f32 v24, v44, v45
    v_cvt_pk_bf16_f32 v25, v46, v47
    v_mfma_f32_16x16x32_bf16 v[48:51], a[212:215], a[148:151], v[48:51]
    v_max3_f32 v16, v192, v193, v194
    v_max3_f32 v76, v195, v196, v197
    v_mfma_f32_16x16x32_bf16 v[48:51], a[216:219], a[152:155], v[48:51]
    v_max3_f32 v16, v16, v198, v199
    v_max3_f32 v76, v76, v200, v201
    v_mfma_f32_16x16x32_bf16 v[48:51], a[220:223], a[156:159], v[48:51]
    v_max3_f32 v16, v16, v202, v203
    v_max3_f32 v76, v76, v204, v205
    v_mfma_f32_16x16x32_bf16 v[48:51], a[224:227], a[160:163], v[48:51]
    v_max3_f32 v16, v16, v206, v207
    v_max_f32 v16, v16, v76
    v_mfma_f32_16x16x32_bf16 v[48:51], a[228:231], a[164:167], v[48:51]
    v_mov_b32 v76, v16
    s_waitcnt vmcnt(3)
    v_cmp_ne_u32 vcc, s39, v118
    s_cbranch_vccnz L_retry_76
L_back_77:
    v_mfma_f32_16x16x32_bf16 v[48:51], a[232:235], a[168:171], v[48:51]
    v_mfma_f32_16x16x32_bf16 v[48:51], a[236:239], a[172:175], v[48:51]
    buffer_load_dwordx4 v[168:171], v1, s[32:35], s60 offen offset:0 sc1
    v_mfma_f32_16x16x32_bf16 v[48:51], a[240:243], a[176:179], v[48:51]
    v_mfma_f32_16x16x32_bf16 v[48:51], a[244:247], a[180:183], v[48:51]
    v_mfma_f32_16x16x32_bf16 v[48:51], a[248:251], a[184:187], v[48:51]
    s_add_u32 m0, s58, 0
    v_mfma_f32_16x16x32_bf16 v[48:51], a[252:255], a[188:191], v[48:51]
    buffer_load_dwordx4 v1, s[32:35], s60 offen offset:1024 sc1 lds
    v_permlane32_swap_b32 v16, v76
    buffer_load_dwordx4 v[160:163], v1, s[32:35], s61 offen offset:0 sc1
    v_min_f32_e64 v16, -v16, -v76
    v_pk_add_f32 v[192:193], v[192:193], v[16:17] op_sel:[0,0] op_sel_hi:[1,0]
    v_pk_add_f32 v[194:195], v[194:195], v[16:17] op_sel:[0,0] op_sel_hi:[1,0]
    v_pk_add_f32 v[196:197], v[196:197], v[16:17] op_sel:[0,0] op_sel_hi:[1,0]
    v_pk_add_f32 v[198:199], v[198:199], v[16:17] op_sel:[0,0] op_sel_hi:[1,0]
    s_add_u32 m0, s58, 2064
    v_pk_fma_f32 v[48:49], v[48:49], v[110:111], v[176:177] op_sel:[0,0,0] op_sel_hi:[1,0,1]
    buffer_load_dwordx4 v1, s[32:35], s61 offen offset:1024 sc1 lds
    v_pk_fma_f32 v[50:51], v[50:51], v[110:111], v[178:179] op_sel:[0,0,0] op_sel_hi:[1,0,1]
    v_cvt_pk_bf16_f32 v26, v48, v49
    v_cvt_pk_bf16_f32 v27, v50, v51
    v_pk_add_f32 v[200:201], v[200:201], v[16:17] op_sel:[0,0] op_sel_hi:[1,0]
    v_pk_add_f32 v[202:203], v[202:203], v[16:17] op_sel:[0,0] op_sel_hi:[1,0]
    v_permlane16_swap_b32 v24, v26
    buffer_load_dwordx4 v[152:155], v1, s[32:35], s62 offen offset:0 sc1
    v_permlane16_swap_b32 v25, v27
    v_pk_add_f32 v[204:205], v[204:205], v[16:17] op_sel:[0,0] op_sel_hi:[1,0]
    v_pk_add_f32 v[206:207], v[206:207], v[16:17] op_sel:[0,0] op_sel_hi:[1,0]
    v_mfma_f32_32x32x16_bf16 v[208:223], v[84:87], v[24:27], v[60:75]
    v_mov_b32 v128, v16
    s_add_u32 m0, s58, 4128
    v_mov_b32 v129, v16
    buffer_load_dwordx4 v1, s[32:35], s62 offen offset:1024 sc1 lds
    v_mov_b32 v130, v16
    v_mov_b32 v131, v16
    v_mov_b32 v132, v16
    v_mov_b32 v133, v16
    v_mov_b32 v134, v16
    v_mov_b32 v135, v16
    buffer_load_dwordx4 v[144:147], v1, s[32:35], s63 offen offset:0 sc1
    v_mov_b32 v136, v16
    v_mov_b32 v137, v16
    v_pk_mov_b32 v[138:139], v[16:17], v[16:17] op_sel:[0,0]
    v_max3_f32 v17, v208, v209, v210
    v_max3_f32 v77, v211, v212, v213
    s_add_u32 m0, s58, 6192
    v_max3_f32 v17, v17, v214, v215
    buffer_load_dwordx4 v1, s[32:35], s63 offen offset:1024 sc1 lds
    v_max3_f32 v77, v77, v216, v217
    v_max3_f32 v17, v17, v218, v219
    v_max3_f32 v77, v77, v220, v221
    v_max3_f32 v17, v17, v222, v223
    v_max_f32 v17, v17, v77
    v_mov_b32 v77, v17
    v_pk_mov_b32 v[140:141], v[16:17], v[16:17] op_sel:[0,0]
    v_pk_mov_b32 v[142:143], v[16:17], v[16:17] op_sel:[0,0]
    v_permlane32_swap_b32 v17, v77
    v_min_f32_e64 v17, -v17, -v77
    v_pk_add_f32 v[208:209], v[208:209], v[16:17] op_sel:[0,1] op_sel_hi:[1,1]
    v_pk_add_f32 v[210:211], v[210:211], v[16:17] op_sel:[0,1] op_sel_hi:[1,1]
    v_pk_add_f32 v[212:213], v[212:213], v[16:17] op_sel:[0,1] op_sel_hi:[1,1]
    v_pk_add_f32 v[214:215], v[214:215], v[16:17] op_sel:[0,1] op_sel_hi:[1,1]
    v_pk_add_f32 v[216:217], v[216:217], v[16:17] op_sel:[0,1] op_sel_hi:[1,1]
    v_pk_add_f32 v[218:219], v[218:219], v[16:17] op_sel:[0,1] op_sel_hi:[1,1]
    v_pk_add_f32 v[220:221], v[220:221], v[16:17] op_sel:[0,1] op_sel_hi:[1,1]
    v_pk_add_f32 v[222:223], v[222:223], v[16:17] op_sel:[0,1] op_sel_hi:[1,1]
    v_pk_mov_b32 v[60:61], v[16:17], v[16:17] op_sel:[1,1]
    v_pk_mov_b32 v[62:63], v[16:17], v[16:17] op_sel:[1,1]
    v_pk_mov_b32 v[64:65], v[16:17], v[16:17] op_sel:[1,1]
    v_pk_mov_b32 v[66:67], v[16:17], v[16:17] op_sel:[1,1]
    v_pk_mov_b32 v[68:69], v[16:17], v[16:17] op_sel:[1,1]
    v_pk_mov_b32 v[70:71], v[16:17], v[16:17] op_sel:[1,1]
    v_pk_mov_b32 v[72:73], v[16:17], v[16:17] op_sel:[1,1]
    v_pk_mov_b32 v[74:75], v[16:17], v[16:17] op_sel:[1,1]
    v_exp_f32 v192, v192
    v_exp_f32 v193, v193
    ds_read_b128 v[88:91], v14 offset:0
    v_exp_f32 v194, v194
    v_exp_f32 v195, v195
    v_cvt_pk_bf16_f32 v192, v192, v193
    v_exp_f32 v196, v196
    v_exp_f32 v197, v197
    ds_read_b128 v[92:95], v15 offset:0
    v_cvt_pk_bf16_f32 v193, v194, v195
    v_exp_f32 v198, v198
    v_exp_f32 v199, v199
    v_cvt_pk_bf16_f32 v194, v196, v197
    v_exp_f32 v200, v200
    v_exp_f32 v201, v201
    v_cvt_pk_bf16_f32 v195, v198, v199
    v_exp_f32 v202, v202
    v_exp_f32 v203, v203
    v_cvt_pk_bf16_f32 v200, v200, v201
    v_exp_f32 v204, v204
    v_exp_f32 v205, v205
    v_cvt_pk_bf16_f32 v201, v202, v203
    v_exp_f32 v206, v206
    v_exp_f32 v207, v207
    v_cvt_pk_bf16_f32 v202, v204, v205
    v_exp_f32 v208, v208
    v_exp_f32 v209, v209
    v_cvt_pk_bf16_f32 v203, v206, v207
    s_waitcnt lgkmcnt(0)
    v_mfma_f32_32x32x16_bf16 v[28:43], v[88:91], v[192:195], 0
    ds_read_b128 v[88:91], v14 offset:2064
    v_exp_f32 v210, v210
    v_exp_f32 v211, v211
    v_cvt_pk_bf16_f32 v208, v208, v209
    v_exp_f32 v212, v212
    v_exp_f32 v213, v213
    v_mfma_f32_32x32x16_bf16 v[28:43], v[92:95], v[200:203], v[28:43]
    ds_read_b128 v[92:95], v15 offset:2064
    v_cvt_pk_bf16_f32 v209, v210, v211
    v_exp_f32 v214, v214
    v_exp_f32 v215, v215
    v_cvt_pk_bf16_f32 v210, v212, v213
    v_mfma_f32_32x32x16_bf16 v[192:207], v[80:83], v[24:27], v[60:75]
    v_exp_f32 v216, v216
    v_exp_f32 v217, v217
    v_cvt_pk_bf16_f32 v211, v214, v215
    v_exp_f32 v218, v218
    v_exp_f32 v219, v219
    v_cvt_pk_bf16_f32 v216, v216, v217
    v_exp_f32 v220, v220
    v_exp_f32 v221, v221
    v_cvt_pk_bf16_f32 v217, v218, v219
    v_exp_f32 v222, v222
    v_exp_f32 v223, v223
    v_cvt_pk_bf16_f32 v218, v220, v221
    buffer_load_dword v3, v19, s[32:35], s5 offen offset:0 sc1
    v_exp_f32 v192, v192
    v_exp_f32 v193, v193
    v_cvt_pk_bf16_f32 v219, v222, v223
    s_waitcnt lgkmcnt(0)
    v_mfma_f32_32x32x16_bf16 v[44:59], v[88:91], v[208:211], 0
    ds_read_b128 v[88:91], v14 offset:0
    v_exp_f32 v194, v194
    v_exp_f32 v195, v195
    v_cvt_pk_bf16_f32 v192, v192, v193
    v_exp_f32 v196, v196
    v_exp_f32 v197, v197
    v_mfma_f32_32x32x16_bf16 v[44:59], v[92:95], v[216:219], v[44:59]
    ds_read_b128 v[92:95], v15 offset:0
    v_cvt_pk_bf16_f32 v193, v194, v195
    v_exp_f32 v198, v198
    v_exp_f32 v199, v199
    v_cvt_pk_bf16_f32 v194, v196, v197
    s_waitcnt vmcnt(8)
    v_mfma_f32_32x32x16_bf16 v[208:223], v[168:171], v[24:27], v[60:75]
    v_exp_f32 v200, v200
    v_exp_f32 v201, v201
    v_cvt_pk_bf16_f32 v195, v198, v199
    v_exp_f32 v202, v202
    v_exp_f32 v203, v203
    v_cvt_pk_bf16_f32 v200, v200, v201
    v_exp_f32 v204, v204
    v_exp_f32 v205, v205
    v_cvt_pk_bf16_f32 v201, v202, v203
    v_exp_f32 v206, v206
    v_exp_f32 v207, v207
    v_cvt_pk_bf16_f32 v202, v204, v205
    v_exp_f32 v208, v208
    v_exp_f32 v209, v209
    v_cvt_pk_bf16_f32 v203, v206, v207
    s_waitcnt vmcnt(7) lgkmcnt(0)
    v_add_u32 v14, s4, v14
    v_add_u32 v15, s4, v15
    v_mfma_f32_32x32x16_bf16 v[44:59], v[88:91], v[192:195], v[44:59]
    ds_read_b128 v[88:91], v14 offset:0
    v_exp_f32 v210, v210
    v_exp_f32 v211, v211
    v_cvt_pk_bf16_f32 v208, v208, v209
    v_exp_f32 v212, v212
    v_exp_f32 v213, v213
    v_mfma_f32_32x32x16_bf16 v[44:59], v[92:95], v[200:203], v[44:59]
    ds_read_b128 v[92:95], v15 offset:0
    v_cvt_pk_bf16_f32 v209, v210, v211
    v_exp_f32 v214, v214
    v_exp_f32 v215, v215
    v_cvt_pk_bf16_f32 v210, v212, v213
    v_mfma_f32_32x32x16_bf16 v[192:207], v[168:171], v[20:23], v[128:143]
    v_exp_f32 v216, v216
    v_exp_f32 v217, v217
    v_cvt_pk_bf16_f32 v211, v214, v215
    v_exp_f32 v218, v218
    v_exp_f32 v219, v219
    v_cvt_pk_bf16_f32 v216, v216, v217
    v_exp_f32 v220, v220
    v_exp_f32 v221, v221
    v_cvt_pk_bf16_f32 v217, v218, v219
    v_exp_f32 v222, v222
    v_exp_f32 v223, v223
    v_cvt_pk_bf16_f32 v218, v220, v221
    v_exp_f32 v192, v192
    v_exp_f32 v193, v193
    v_cvt_pk_bf16_f32 v219, v222, v223
    s_waitcnt lgkmcnt(0)
    v_mfma_f32_32x32x16_bf16 v[44:59], v[88:91], v[208:211], v[44:59]
    v_exp_f32 v194, v194
    v_exp_f32 v195, v195
    v_cvt_pk_bf16_f32 v192, v192, v193
    v_exp_f32 v196, v196
    v_exp_f32 v197, v197
    v_mfma_f32_32x32x16_bf16 v[44:59], v[92:95], v[216:219], v[44:59]
    v_cvt_pk_bf16_f32 v193, v194, v195
    v_exp_f32 v198, v198
    v_exp_f32 v199, v199
    v_cvt_pk_bf16_f32 v194, v196, v197
    s_waitcnt vmcnt(6)
    v_mfma_f32_32x32x16_bf16 v[208:223], v[160:163], v[20:23], v[128:143]
    v_exp_f32 v200, v200
    v_exp_f32 v201, v201
    v_cvt_pk_bf16_f32 v195, v198, v199
    v_exp_f32 v202, v202
    v_exp_f32 v203, v203
    v_cvt_pk_bf16_f32 v200, v200, v201
    v_exp_f32 v204, v204
    v_exp_f32 v205, v205
    v_cvt_pk_bf16_f32 v201, v202, v203
    v_exp_f32 v206, v206
    v_exp_f32 v207, v207
    v_cvt_pk_bf16_f32 v202, v204, v205
    v_exp_f32 v208, v208
    v_exp_f32 v209, v209
    v_cvt_pk_bf16_f32 v203, v206, v207
    s_waitcnt vmcnt(5)
    v_mfma_f32_32x32x16_bf16 v[28:43], v[88:91], v[192:195], v[28:43]
    ds_read_b128 v[88:91], v14 offset:2064
    v_exp_f32 v210, v210
    v_exp_f32 v211, v211
    v_cvt_pk_bf16_f32 v208, v208, v209
    v_exp_f32 v212, v212
    v_exp_f32 v213, v213
    v_mfma_f32_32x32x16_bf16 v[28:43], v[92:95], v[200:203], v[28:43]
    ds_read_b128 v[92:95], v15 offset:2064
    v_cvt_pk_bf16_f32 v209, v210, v211
    v_exp_f32 v214, v214
    v_exp_f32 v215, v215
    v_cvt_pk_bf16_f32 v210, v212, v213
    v_mfma_f32_32x32x16_bf16 v[192:207], v[160:163], v[24:27], v[60:75]
    v_exp_f32 v216, v216
    v_exp_f32 v217, v217
    v_cvt_pk_bf16_f32 v211, v214, v215
    v_exp_f32 v218, v218
    v_exp_f32 v219, v219
    v_cvt_pk_bf16_f32 v216, v216, v217
    v_exp_f32 v220, v220
    v_exp_f32 v221, v221
    v_cvt_pk_bf16_f32 v217, v218, v219
    v_exp_f32 v222, v222
    v_exp_f32 v223, v223
    v_cvt_pk_bf16_f32 v218, v220, v221
    s_waitcnt vmcnt(0)
    v_cmp_ne_u32 vcc, s39, v3
    s_cbranch_vccnz L_retry_79
L_back_80:
    v_exp_f32 v192, v192
    buffer_load_dwordx4 v[172:175], v1, s[32:35], s60 offen offset:2048 sc1
    v_exp_f32 v193, v193
    v_cvt_pk_bf16_f32 v219, v222, v223
    s_waitcnt lgkmcnt(0)
    v_mfma_f32_32x32x16_bf16 v[28:43], v[88:91], v[208:211], v[28:43]
    v_exp_f32 v194, v194
    v_exp_f32 v195, v195
    s_add_u32 m0, s58, 30976
    v_cvt_pk_bf16_f32 v192, v192, v193
    buffer_load_dwordx4 v1, s[32:35], s60 offen offset:3072 sc1 lds
    v_exp_f32 v196, v196
    v_exp_f32 v197, v197
    v_mfma_f32_32x32x16_bf16 v[28:43], v[92:95], v[216:219], v[28:43]
    v_cvt_pk_bf16_f32 v193, v194, v195
    v_exp_f32 v198, v198
    v_exp_f32 v199, v199
    v_cvt_pk_bf16_f32 v194, v196, v197
    buffer_load_dwordx4 v[164:167], v1, s[32:35], s61 offen offset:2048 sc1
    v_mfma_f32_32x32x16_bf16 v[208:223], v[152:155], v[24:27], v[60:75]
    v_exp_f32 v200, v200
    v_exp_f32 v201, v201
    v_cvt_pk_bf16_f32 v195, v198, v199
    v_exp_f32 v202, v202
    v_exp_f32 v203, v203
    s_add_u32 m0, s58, 33040
    v_cvt_pk_bf16_f32 v200, v200, v201
    buffer_load_dwordx4 v1, s[32:35], s61 offen offset:3072 sc1 lds
    v_exp_f32 v204, v204
    v_exp_f32 v205, v205
    v_cvt_pk_bf16_f32 v201, v202, v203
    v_exp_f32 v206, v206
    v_exp_f32 v207, v207
    v_cvt_pk_bf16_f32 v202, v204, v205
    v_exp_f32 v208, v208
    buffer_load_dwordx4 v[156:159], v1, s[32:35], s62 offen offset:2048 sc1
    v_exp_f32 v209, v209
    v_cvt_pk_bf16_f32 v203, v206, v207
    v_mfma_f32_32x32x16_bf16 v[44:59], v[88:91], v[192:195], v[44:59]
    ds_read_b128 v[88:91], v14 offset:4128
    v_exp_f32 v210, v210
    s_add_u32 m0, s58, 35104
    v_exp_f32 v211, v211
    buffer_load_dwordx4 v1, s[32:35], s62 offen offset:3072 sc1 lds
    v_cvt_pk_bf16_f32 v208, v208, v209
    v_exp_f32 v212, v212
    v_exp_f32 v213, v213
    v_mfma_f32_32x32x16_bf16 v[44:59], v[92:95], v[200:203], v[44:59]
    ds_read_b128 v[92:95], v15 offset:4128
    v_cvt_pk_bf16_f32 v209, v210, v211
    v_exp_f32 v214, v214
    buffer_load_dwordx4 v[148:151], v1, s[32:35], s63 offen offset:2048 sc1
    v_exp_f32 v215, v215
    v_cvt_pk_bf16_f32 v210, v212, v213
    v_mfma_f32_32x32x16_bf16 v[192:207], v[152:155], v[20:23], v[128:143]
L_pad9:
    s_cbranch_execz L_warm2
    v_exp_f32 v216, v216
    v_exp_f32 v217, v217
    v_cvt_pk_bf16_f32 v211, v214, v215
    s_add_u32 m0, s58, 37168
    v_exp_f32 v218, v218
    buffer_load_dwordx4 v1, s[32:35], s63 offen offset:3072 sc1 lds
    v_exp_f32 v219, v219
    v_cvt_pk_bf16_f32 v216, v216, v217
    v_exp_f32 v220, v220
    v_exp_f32 v221, v221
    v_cvt_pk_bf16_f32 v217, v218, v219
    v_exp_f32 v222, v222
    v_exp_f32 v223, v223
    v_cvt_pk_bf16_f32 v218, v220, v221
    buffer_store_dwordx4 v[96:99], v100, s[32:35], s3 offen sc1
    v_exp_f32 v192, v192
    v_exp_f32 v193, v193
    v_cvt_pk_bf16_f32 v219, v222, v223
    s_waitcnt lgkmcnt(0)
    v_mfma_f32_32x32x16_bf16 v[44:59], v[88:91], v[208:211], v[44:59]
    v_exp_f32 v194, v194
    v_exp_f32 v195, v195
    v_cvt_pk_bf16_f32 v192, v192, v193
    v_exp_f32 v196, v196
    v_exp_f32 v197, v197
    v_mfma_f32_32x32x16_bf16 v[44:59], v[92:95], v[216:219], v[44:59]
    v_cvt_pk_bf16_f32 v193, v194, v195
    v_exp_f32 v198, v198
    v_exp_f32 v199, v199
    v_cvt_pk_bf16_f32 v194, v196, v197
    v_mfma_f32_32x32x16_bf16 v[208:223], v[144:147], v[20:23], v[128:143]
    v_exp_f32 v200, v200
    v_exp_f32 v201, v201
    v_cvt_pk_bf16_f32 v195, v198, v199
    v_exp_f32 v202, v202
    v_exp_f32 v203, v203
    v_cvt_pk_bf16_f32 v200, v200, v201
    v_exp_f32 v204, v204
    v_exp_f32 v205, v205
    v_cvt_pk_bf16_f32 v201, v202, v203
    v_exp_f32 v206, v206
    v_exp_f32 v207, v207
    v_cvt_pk_bf16_f32 v202, v204, v205
    v_exp_f32 v208, v208
    v_exp_f32 v209, v209
    v_cvt_pk_bf16_f32 v203, v206, v207
    v_mfma_f32_32x32x16_bf16 v[28:43], v[88:91], v[192:195], v[28:43]
    ds_read_b128 v[88:91], v14 offset:6192
    v_exp_f32 v210, v210
    v_exp_f32 v211, v211
    v_cndmask_b32 v208, v208, 0, s[64:65]
    v_cndmask_b32 v209, v209, 0, s[66:67]
    v_cvt_pk_bf16_f32 v208, v208, v209
    v_exp_f32 v212, v212
    v_exp_f32 v213, v213
    v_mfma_f32_32x32x16_bf16 v[28:43], v[92:95], v[200:203], v[28:43]
    ds_read_b128 v[92:95], v15 offset:6192
    v_cndmask_b32 v210, v210, 0, s[68:69]
    v_cndmask_b32 v211, v211, 0, s[70:71]
    v_cvt_pk_bf16_f32 v209, v210, v211
    v_exp_f32 v214, v214
    v_exp_f32 v215, v215
    v_cndmask_b32 v212, v212, 0, s[72:73]
    v_cndmask_b32 v213, v213, 0, s[74:75]
    v_cvt_pk_bf16_f32 v210, v212, v213
    s_waitcnt vmcnt(8)
    v_mfma_f32_32x32x16_bf16 v[192:207], v[172:175], v[20:23], v[128:143]
    v_exp_f32 v216, v216
    v_exp_f32 v217, v217
    v_cndmask_b32 v214, v214, 0, s[76:77]
    v_cndmask_b32 v215, v215, 0, s[78:79]
    v_cvt_pk_bf16_f32 v211, v214, v215
    v_exp_f32 v218, v218
    v_exp_f32 v219, v219
    v_cndmask_b32 v216, v216, 0, s[80:81]
    v_cndmask_b32 v217, v217, 0, s[82:83]
    v_cvt_pk_bf16_f32 v216, v216, v217
    v_exp_f32 v220, v220
    v_exp_f32 v221, v221
    v_cndmask_b32 v218, v218, 0, s[84:85]
    v_cndmask_b32 v219, v219, 0, s[86:87]
    v_cvt_pk_bf16_f32 v217, v218, v219
    v_exp_f32 v222, v222
    v_exp_f32 v223, v223
    v_cndmask_b32 v220, v220, 0, s[88:89]
    v_cndmask_b32 v221, v221, 0, s[90:91]
    v_cvt_pk_bf16_f32 v218, v220, v221
    v_exp_f32 v192, v192
    v_exp_f32 v193, v193
    v_cndmask_b32 v222, v222, 0, s[92:93]
    v_cndmask_b32 v223, v223, 0, s[94:95]
    v_cvt_pk_bf16_f32 v219, v222, v223
    s_waitcnt vmcnt(7) lgkmcnt(0)
    v_mfma_f32_32x32x16_bf16 v[28:43], v[88:91], v[208:211], v[28:43]
    ds_read_b128 v[88:91], v14 offset:33024
    v_exp_f32 v194, v194
    v_exp_f32 v195, v195
    v_cvt_pk_bf16_f32 v192, v192, v193
    v_exp_f32 v196, v196
    v_exp_f32 v197, v197
    v_mfma_f32_32x32x16_bf16 v[28:43], v[92:95], v[216:219], v[28:43]
    ds_read_b128 v[92:95], v15 offset:33024
    v_cvt_pk_bf16_f32 v193, v194, v195
    v_exp_f32 v198, v198
    v_exp_f32 v199, v199
    v_cvt_pk_bf16_f32 v194, v196, v197
    v_mfma_f32_32x32x16_bf16 v[208:223], v[172:175], v[24:27], v[60:75]
    v_exp_f32 v200, v200
    v_exp_f32 v201, v201
    v_cvt_pk_bf16_f32 v195, v198, v199
    v_exp_f32 v202, v202
    v_exp_f32 v203, v203
    v_cvt_pk_bf16_f32 v200, v200, v201
    v_exp_f32 v204, v204
    v_exp_f32 v205, v205
    v_cvt_pk_bf16_f32 v201, v202, v203
    v_exp_f32 v206, v206
    v_exp_f32 v207, v207
    v_cvt_pk_bf16_f32 v202, v204, v205
    v_exp_f32 v208, v208
    v_exp_f32 v209, v209
    v_cvt_pk_bf16_f32 v203, v206, v207
    s_waitcnt lgkmcnt(0)
    v_mfma_f32_32x32x16_bf16 v[28:43], v[88:91], v[192:195], v[28:43]
    v_exp_f32 v210, v210
    v_exp_f32 v211, v211
    v_cvt_pk_bf16_f32 v208, v208, v209
    v_exp_f32 v212, v212
    v_exp_f32 v213, v213
    v_mfma_f32_32x32x16_bf16 v[28:43], v[92:95], v[200:203], v[28:43]
    v_cvt_pk_bf16_f32 v209, v210, v211
    v_exp_f32 v214, v214
    v_exp_f32 v215, v215
    v_cvt_pk_bf16_f32 v210, v212, v213
    s_waitcnt vmcnt(6)
    v_mfma_f32_32x32x16_bf16 v[192:207], v[164:167], v[24:27], v[60:75]
    v_exp_f32 v216, v216
    v_exp_f32 v217, v217
    v_cvt_pk_bf16_f32 v211, v214, v215
    v_exp_f32 v218, v218
    v_exp_f32 v219, v219
    v_cvt_pk_bf16_f32 v216, v216, v217
    v_exp_f32 v220, v220
    v_exp_f32 v221, v221
    v_cvt_pk_bf16_f32 v217, v218, v219
    v_exp_f32 v222, v222
    v_exp_f32 v223, v223
    v_cvt_pk_bf16_f32 v218, v220, v221
    v_exp_f32 v192, v192
    v_exp_f32 v193, v193
    v_cvt_pk_bf16_f32 v219, v222, v223
    s_waitcnt vmcnt(5)
    v_mfma_f32_32x32x16_bf16 v[44:59], v[88:91], v[208:211], v[44:59]
    ds_read_b128 v[88:91], v14 offset:35088
    v_exp_f32 v194, v194
    v_exp_f32 v195, v195
    v_cvt_pk_bf16_f32 v192, v192, v193
    v_exp_f32 v196, v196
    v_exp_f32 v197, v197
    v_mfma_f32_32x32x16_bf16 v[44:59], v[92:95], v[216:219], v[44:59]
    ds_read_b128 v[92:95], v15 offset:35088
    v_cvt_pk_bf16_f32 v193, v194, v195
    v_exp_f32 v198, v198
    v_exp_f32 v199, v199
    v_cvt_pk_bf16_f32 v194, v196, v197
    v_mfma_f32_32x32x16_bf16 v[208:223], v[164:167], v[20:23], v[128:143]
    v_exp_f32 v200, v200
    v_exp_f32 v201, v201
    v_cvt_pk_bf16_f32 v195, v198, v199
    v_exp_f32 v202, v202
    v_exp_f32 v203, v203
    v_cvt_pk_bf16_f32 v200, v200, v201
    v_exp_f32 v204, v204
    v_exp_f32 v205, v205
    v_cvt_pk_bf16_f32 v201, v202, v203
    v_exp_f32 v206, v206
    v_exp_f32 v207, v207
    v_cvt_pk_bf16_f32 v202, v204, v205
    v_exp_f32 v208, v208
    v_exp_f32 v209, v209
    v_cvt_pk_bf16_f32 v203, v206, v207
    s_waitcnt lgkmcnt(0)
    v_mfma_f32_32x32x16_bf16 v[44:59], v[88:91], v[192:195], v[44:59]
    v_exp_f32 v210, v210
    v_exp_f32 v211, v211
    v_cvt_pk_bf16_f32 v208, v208, v209
    v_exp_f32 v212, v212
    v_exp_f32 v213, v213
    v_mfma_f32_32x32x16_bf16 v[44:59], v[92:95], v[200:203], v[44:59]
    v_cvt_pk_bf16_f32 v209, v210, v211
    v_exp_f32 v214, v214
    v_exp_f32 v215, v215
    v_cvt_pk_bf16_f32 v210, v212, v213
    s_waitcnt vmcnt(4)
    v_mfma_f32_32x32x16_bf16 v[192:207], v[156:159], v[20:23], v[128:143]
    v_exp_f32 v216, v216
    v_exp_f32 v217, v217
    v_cvt_pk_bf16_f32 v211, v214, v215
    v_exp_f32 v218, v218
    v_exp_f32 v219, v219
    v_cvt_pk_bf16_f32 v216, v216, v217
    v_exp_f32 v220, v220
    v_exp_f32 v221, v221
    v_cvt_pk_bf16_f32 v217, v218, v219
    v_exp_f32 v222, v222
    v_exp_f32 v223, v223
    v_cvt_pk_bf16_f32 v218, v220, v221
    v_exp_f32 v192, v192
    v_exp_f32 v193, v193
    v_cvt_pk_bf16_f32 v219, v222, v223
    s_waitcnt vmcnt(3)
    v_mfma_f32_32x32x16_bf16 v[28:43], v[88:91], v[208:211], v[28:43]
    ds_read_b128 v[88:91], v14 offset:37152
    v_exp_f32 v194, v194
    v_exp_f32 v195, v195
    v_cvt_pk_bf16_f32 v192, v192, v193
    v_exp_f32 v196, v196
    v_exp_f32 v197, v197
    v_mfma_f32_32x32x16_bf16 v[28:43], v[92:95], v[216:219], v[28:43]
    ds_read_b128 v[92:95], v15 offset:37152
    v_cvt_pk_bf16_f32 v193, v194, v195
    v_exp_f32 v198, v198
    v_exp_f32 v199, v199
    v_cvt_pk_bf16_f32 v194, v196, v197
    v_mfma_f32_32x32x16_bf16 v[208:223], v[156:159], v[24:27], v[60:75]
    v_exp_f32 v200, v200
    v_exp_f32 v201, v201
    v_cvt_pk_bf16_f32 v195, v198, v199
    v_exp_f32 v202, v202
    v_exp_f32 v203, v203
    v_cvt_pk_bf16_f32 v200, v200, v201
    v_exp_f32 v204, v204
    v_exp_f32 v205, v205
    v_cvt_pk_bf16_f32 v201, v202, v203
    v_exp_f32 v206, v206
    v_exp_f32 v207, v207
    v_cvt_pk_bf16_f32 v202, v204, v205
    v_exp_f32 v208, v208
    v_exp_f32 v209, v209
    v_cvt_pk_bf16_f32 v203, v206, v207
    s_waitcnt lgkmcnt(0)
    v_mfma_f32_32x32x16_bf16 v[28:43], v[88:91], v[192:195], v[28:43]
    v_exp_f32 v210, v210
    v_exp_f32 v211, v211
    v_cvt_pk_bf16_f32 v208, v208, v209
    v_exp_f32 v212, v212
    v_exp_f32 v213, v213
    v_mfma_f32_32x32x16_bf16 v[28:43], v[92:95], v[200:203], v[28:43]
    v_cvt_pk_bf16_f32 v209, v210, v211
    v_exp_f32 v214, v214
    v_exp_f32 v215, v215
    v_cvt_pk_bf16_f32 v210, v212, v213
    s_waitcnt vmcnt(2)
    v_mfma_f32_32x32x16_bf16 v[192:207], v[148:151], v[20:23], v[128:143]
    v_exp_f32 v216, v216
    v_exp_f32 v217, v217
    v_cvt_pk_bf16_f32 v211, v214, v215
    v_exp_f32 v218, v218
    v_exp_f32 v219, v219
    v_cvt_pk_bf16_f32 v216, v216, v217
    v_exp_f32 v220, v220
    v_exp_f32 v221, v221
    v_cvt_pk_bf16_f32 v217, v218, v219
    v_exp_f32 v222, v222
    v_exp_f32 v223, v223
    v_cvt_pk_bf16_f32 v218, v220, v221
    v_exp_f32 v192, v192
    v_exp_f32 v193, v193
    v_cvt_pk_bf16_f32 v219, v222, v223
    s_waitcnt vmcnt(1)
    v_mfma_f32_32x32x16_bf16 v[44:59], v[88:91], v[208:211], v[44:59]
    ds_read_b128 v[88:91], v14 offset:39216
    v_exp_f32 v194, v194
    v_exp_f32 v195, v195
    v_cvt_pk_bf16_f32 v192, v192, v193
    v_exp_f32 v196, v196
    v_exp_f32 v197, v197
    v_mfma_f32_32x32x16_bf16 v[44:59], v[92:95], v[216:219], v[44:59]
    ds_read_b128 v[92:95], v15 offset:39216
    v_cvt_pk_bf16_f32 v193, v194, v195
    v_exp_f32 v198, v198
    v_exp_f32 v199, v199
    v_cvt_pk_bf16_f32 v194, v196, v197
    v_mfma_f32_32x32x16_bf16 v[208:223], v[148:151], v[24:27], v[60:75]
    v_exp_f32 v200, v200
    v_exp_f32 v201, v201
    v_cvt_pk_bf16_f32 v195, v198, v199
    v_exp_f32 v202, v202
    v_exp_f32 v203, v203
    v_cvt_pk_bf16_f32 v200, v200, v201
    v_exp_f32 v204, v204
    v_exp_f32 v205, v205
    v_cvt_pk_bf16_f32 v201, v202, v203
    v_exp_f32 v206, v206
    v_exp_f32 v207, v207
    v_cvt_pk_bf16_f32 v202, v204, v205
    v_exp_f32 v208, v208
    v_exp_f32 v209, v209
    v_cvt_pk_bf16_f32 v203, v206, v207
    s_waitcnt lgkmcnt(0)
    v_mfma_f32_32x32x16_bf16 v[28:43], v[88:91], v[192:195], v[28:43]
    v_exp_f32 v210, v210
    v_exp_f32 v211, v211
    v_cndmask_b32 v208, v208, 0, s[64:65]
    v_cndmask_b32 v209, v209, 0, s[66:67]
    v_cvt_pk_bf16_f32 v208, v208, v209
    v_exp_f32 v212, v212
    v_exp_f32 v213, v213
    v_mfma_f32_32x32x16_bf16 v[28:43], v[92:95], v[200:203], v[28:43]
    v_cndmask_b32 v210, v210, 0, s[68:69]
    v_cndmask_b32 v211, v211, 0, s[70:71]
    v_cvt_pk_bf16_f32 v209, v210, v211
    v_exp_f32 v214, v214
    v_exp_f32 v215, v215
    v_cndmask_b32 v212, v212, 0, s[72:73]
    v_cndmask_b32 v213, v213, 0, s[74:75]
    v_cvt_pk_bf16_f32 v210, v212, v213
    v_exp_f32 v216, v216
    v_exp_f32 v217, v217
    v_cndmask_b32 v214, v214, 0, s[76:77]
    v_cndmask_b32 v215, v215, 0, s[78:79]
    v_cvt_pk_bf16_f32 v211, v214, v215
    v_exp_f32 v218, v218
    v_exp_f32 v219, v219
    v_cndmask_b32 v216, v216, 0, s[80:81]
    v_cndmask_b32 v217, v217, 0, s[82:83]
    v_cvt_pk_bf16_f32 v216, v216, v217
    v_exp_f32 v220, v220
    v_exp_f32 v221, v221
    v_mfma_f32_32x32x16_bf16 v[44:59], v[88:91], v[208:211], v[44:59]
    v_cndmask_b32 v218, v218, 0, s[84:85]
    v_cndmask_b32 v219, v219, 0, s[86:87]
    v_cvt_pk_bf16_f32 v217, v218, v219
    v_exp_f32 v222, v222
    v_exp_f32 v223, v223
    v_cndmask_b32 v220, v220, 0, s[88:89]
    v_cndmask_b32 v221, v221, 0, s[90:91]
    v_cvt_pk_bf16_f32 v218, v220, v221
    s_add_u32 s4, s41, 2097152
    v_maximum3_f32 v84, abs(v28), abs(v29), v36
    v_rcp_f32 v36, v36
    v_maximum3_f32 v84, abs(v30), abs(v31), v84
    v_maximum3_f32 v84, abs(v32), abs(v33), v84
    v_maximum3_f32 v84, abs(v34), abs(v35), v84
    v_mul_f32 v28, v28, v36
    v_mul_f32 v29, v29, v36
    v_mul_f32 v30, v30, v36
    v_mul_f32 v31, v31, v36
    v_mul_f32 v32, v32, v36
    v_mul_f32 v33, v33, v36
    v_mul_f32 v34, v34, v36
    v_mul_f32 v35, v35, v36
    s_cmp_eq_u32 s53, 0
    v_cvt_pk_bf16_f32 v38, v28, v29
    v_cvt_pk_bf16_f32 v39, v30, v31
    v_cvt_pk_bf16_f32 v40, v32, v33
    v_cvt_pk_bf16_f32 v41, v34, v35
    s_cbranch_scc1 L_slow_82
    buffer_store_dwordx4 v[38:41], v7, s[32:35], s4 offen
L_back_83:
    v_cndmask_b32 v222, v222, 0, s[92:93]
    v_cndmask_b32 v223, v223, 0, s[94:95]
    v_cvt_pk_bf16_f32 v219, v222, v223
    s_nop 1
    v_mfma_f32_32x32x16_bf16 v[44:59], v[92:95], v[216:219], v[44:59]
    s_add_u32 s5, s4, 32768
    s_mov_b32 s40, 3
    s_cmp_eq_u32 s53, 0
    v_mov_b32 v70, s39
    v_min_u32 v71, 1, v0
    v_lshlrev_b32 v71, 26, v71
    s_nop 5
    v_rcp_f32 v52, v52
    s_nop 0
    v_pk_mul_f32 v[44:45], v[44:45], v[52:53] op_sel:[0,0] op_sel_hi:[1,0]
    v_pk_mul_f32 v[46:47], v[46:47], v[52:53] op_sel:[0,0] op_sel_hi:[1,0]
    v_pk_mul_f32 v[48:49], v[48:49], v[52:53] op_sel:[0,0] op_sel_hi:[1,0]
    v_pk_mul_f32 v[50:51], v[50:51], v[52:53] op_sel:[0,0] op_sel_hi:[1,0]
    v_cvt_pk_bf16_f32 v54, v44, v45
    v_cvt_pk_bf16_f32 v55, v46, v47
    v_cvt_pk_bf16_f32 v56, v48, v49
    v_cvt_pk_bf16_f32 v57, v50, v51
    s_cbranch_scc1 L_slow_84
    buffer_store_dwordx4 v[54:57], v7, s[32:35], s5 offen
L_back_85:
    v_maximum3_f32 v76, abs(v44), abs(v45), v84
    v_maximum3_f32 v77, abs(v46), abs(v47), v53
    v_maximum3_f32 v76, abs(v48), abs(v49), v76
    v_maximum3_f32 v77, abs(v50), abs(v51), v77
    v_maximum3_f32 v76, v76, v77, v77
    v_cmp_nlt_f32 vcc, v76, abs(v18)
    s_cbranch_vccnz L_fallback
L_fbdone3:
    s_lshl_b32 s6, s38, 11
    s_add_u32 s6, s6, 150144
    v_add_u32 v14, s6, v1
    ds_read_b128 v[60:63], v14
    ds_read_b128 v[64:67], v14 offset:1024
    v_xor_b32 v124, 32, v10
    v_xor_b32 v125, 64, v10
    v_xor_b32 v126, 96, v10
    s_add_u32 s6, s49, 2097152
    v_mov_b32 v15, v71
    v_mov_b32 v16, 0x3f803f80
    s_waitcnt lgkmcnt(1)
    v_permlane16_swap_b32 v60, v62
    v_permlane16_swap_b32 v61, v63
    s_waitcnt lgkmcnt(0)
    v_permlane16_swap_b32 v64, v66
    v_permlane16_swap_b32 v65, v67
    v_lshlrev_b32 v20, 16, v60
    v_and_b32 v21, 0xffff0000, v60
    v_lshlrev_b32 v22, 16, v61
    v_and_b32 v23, 0xffff0000, v61
    v_lshlrev_b32 v24, 16, v62
    v_and_b32 v25, 0xffff0000, v62
    v_lshlrev_b32 v26, 16, v63
    v_and_b32 v27, 0xffff0000, v63
    v_lshlrev_b32 v28, 16, v64
    v_and_b32 v29, 0xffff0000, v64
    v_lshlrev_b32 v30, 16, v65
    v_and_b32 v31, 0xffff0000, v65
    v_lshlrev_b32 v32, 16, v66
    v_and_b32 v33, 0xffff0000, v66
    v_lshlrev_b32 v34, 16, v67
    v_and_b32 v35, 0xffff0000, v67
    s_cmp_eq_u32 s53, 0
    s_waitcnt vmcnt(0)
    s_barrier
    s_cbranch_scc1 L_slow_86
    buffer_store_dword v70, v71, s[32:35], s52 offen offset:96
L_back_87:
    s_xor_b32 s5, s6, 0
    buffer_load_dwordx4 v[36:39], v1, s[32:35], s5 offen offset:0 sc1
    buffer_load_dwordx4 v[40:43], v1, s[32:35], s5 offen offset:1024 sc1
    ds_read_b64_tr_b16 v[120:121], v124 offset:12288
    ds_read_b64_tr_b16 v[122:123], v124 offset:12544
    ds_read_b64_tr_b16 v[116:117], v10 offset:12288
    ds_read_b64_tr_b16 v[118:119], v10 offset:12544
    ds_read_b64_tr_b16 v[112:113], v126 offset:8192
    ds_read_b64_tr_b16 v[114:115], v126 offset:8448
    ds_read_b64_tr_b16 v[108:109], v125 offset:8192
    ds_read_b64_tr_b16 v[110:111], v125 offset:8448
    ds_read_b64_tr_b16 v[104:105], v124 offset:8192
    ds_read_b64_tr_b16 v[106:107], v124 offset:8448
    ds_read_b64_tr_b16 v[100:101], v10 offset:8192
    ds_read_b64_tr_b16 v[102:103], v10 offset:8448
    ds_read_b64_tr_b16 v[96:97], v126 offset:4096
    ds_read_b64_tr_b16 v[98:99], v126 offset:4352
    buffer_load_dword v127, v8, s[32:35], s51 offen offset:96 sc1
    ds_read_b64_tr_b16 v[92:93], v125 offset:4096
    ds_read_b64_tr_b16 v[94:95], v125 offset:4352
    ds_read_b64_tr_b16 v[88:89], v124 offset:4096
    ds_read_b64_tr_b16 v[90:91], v124 offset:4352
    ds_read_b64_tr_b16 v[84:85], v10 offset:4096
    ds_read_b64_tr_b16 v[86:87], v10 offset:4352
    ds_read_b64_tr_b16 v[80:81], v126 offset:0
    ds_read_b64_tr_b16 v[82:83], v126 offset:256
    ds_read_b64_tr_b16 v[76:77], v125 offset:0
    ds_read_b64_tr_b16 v[78:79], v125 offset:256
    ds_read_b64_tr_b16 v[72:73], v124 offset:0
    ds_read_b64_tr_b16 v[74:75], v124 offset:256
    ds_read_b64_tr_b16 v[68:69], v10 offset:0
    ds_read_b64_tr_b16 v[70:71], v10 offset:256
    buffer_load_dword v17, v8, s[32:35], s51 offen offset:96 sc1
L_mp_88:
    s_waitcnt vmcnt(1)
    v_cmp_ne_u32 vcc, s39, v127
    s_cbranch_vccz L_md_89
    buffer_load_dword v127, v8, s[32:35], s51 offen offset:96 sc1
    s_waitcnt vmcnt(1)
    v_cmp_ne_u32 vcc, s39, v17
    s_cbranch_vccz L_md_90
    buffer_load_dword v17, v8, s[32:35], s51 offen offset:96 sc1
    s_add_u32 s43, s43, 1
    s_cmp_lt_u32 s43, 0x20000
    s_cbranch_scc1 L_mp_88
    s_endpgm
L_md_89:
L_md_90:
    s_xor_b32 s5, s6, 2048
    buffer_load_dwordx4 v[44:47], v1, s[32:35], s5 offen offset:0 sc1
    buffer_load_dwordx4 v[48:51], v1, s[32:35], s5 offen offset:1024 sc1
    s_barrier
    s_xor_b32 s5, s6, 4096
    buffer_load_dwordx4 v[52:55], v1, s[32:35], s5 offen offset:0 sc1
    buffer_load_dwordx4 v[56:59], v1, s[32:35], s5 offen offset:1024 sc1
    s_barrier
    s_xor_b32 s5, s6, 6144
    buffer_load_dwordx4 v[60:63], v1, s[32:35], s5 offen offset:0 sc1
    buffer_load_dwordx4 v[64:67], v1, s[32:35], s5 offen offset:1024 sc1
    s_waitcnt lgkmcnt(0)
    v_mfma_f32_16x16x32_bf16 v[20:23], v[68:71], v[36:39], v[20:23]
    ds_read_b64_tr_b16 v[68:69], v125 offset:12288
    ds_read_b64_tr_b16 v[70:71], v125 offset:12544
    v_mfma_f32_16x16x32_bf16 v[24:27], v[72:75], v[36:39], v[24:27]
    ds_read_b64_tr_b16 v[72:73], v126 offset:12288
    ds_read_b64_tr_b16 v[74:75], v126 offset:12544
    v_mfma_f32_16x16x32_bf16 v[28:31], v[76:79], v[36:39], v[28:31]
    ds_read_b64_tr_b16 v[76:77], v10 offset:16384
    ds_read_b64_tr_b16 v[78:79], v10 offset:16640
    v_mfma_f32_16x16x32_bf16 v[32:35], v[80:83], v[36:39], v[32:35]
    ds_read_b64_tr_b16 v[80:81], v124 offset:16384
    ds_read_b64_tr_b16 v[82:83], v124 offset:16640
    s_xor_b32 s5, s6, 8192
    buffer_load_dwordx4 v[36:39], v1, s[32:35], s5 offen offset:0 sc1
    v_mfma_f32_16x16x32_bf16 v[20:23], v[84:87], v[40:43], v[20:23]
    ds_read_b64_tr_b16 v[84:85], v125 offset:16384
    ds_read_b64_tr_b16 v[86:87], v125 offset:16640
    v_mfma_f32_16x16x32_bf16 v[24:27], v[88:91], v[40:43], v[24:27]
    ds_read_b64_tr_b16 v[88:89], v126 offset:16384
    ds_read_b64_tr_b16 v[90:91], v126 offset:16640
    v_mfma_f32_16x16x32_bf16 v[28:31], v[92:95], v[40:43], v[28:31]
    ds_read_b64_tr_b16 v[92:93], v10 offset:20480
    ds_read_b64_tr_b16 v[94:95], v10 offset:20736
    v_mfma_f32_16x16x32_bf16 v[32:35], v[96:99], v[40:43], v[32:35]
    ds_read_b64_tr_b16 v[96:97], v124 offset:20480
    ds_read_b64_tr_b16 v[98:99], v124 offset:20736
    buffer_load_dwordx4 v[40:43], v1, s[32:35], s5 offen offset:1024 sc1
    s_waitcnt vmcnt(7)
    v_mfma_f32_16x16x32_bf16 v[20:23], v[100:103], v[44:47], v[20:23]
    ds_read_b64_tr_b16 v[100:101], v125 offset:20480
    ds_read_b64_tr_b16 v[102:103], v125 offset:20736
    v_mfma_f32_16x16x32_bf16 v[24:27], v[104:107], v[44:47], v[24:27]
    ds_read_b64_tr_b16 v[104:105], v126 offset:20480
    ds_read_b64_tr_b16 v[106:107], v126 offset:20736
    v_mfma_f32_16x16x32_bf16 v[28:31], v[108:111], v[44:47], v[28:31]
    ds_read_b64_tr_b16 v[108:109], v10 offset:24576
    ds_read_b64_tr_b16 v[110:111], v10 offset:24832
    v_mfma_f32_16x16x32_bf16 v[32:35], v[112:115], v[44:47], v[32:35]
    ds_read_b64_tr_b16 v[112:113], v124 offset:24576
    ds_read_b64_tr_b16 v[114:115], v124 offset:24832
    s_xor_b32 s5, s6, 10240
    buffer_load_dwordx4 v[44:47], v1, s[32:35], s5 offen offset:0 sc1
    s_waitcnt vmcnt(7) lgkmcnt(14)
    v_mfma_f32_16x16x32_bf16 v[20:23], v[116:119], v[48:51], v[20:23]
    ds_read_b64_tr_b16 v[116:117], v125 offset:24576
    ds_read_b64_tr_b16 v[118:119], v125 offset:24832
    v_mfma_f32_16x16x32_bf16 v[24:27], v[120:123], v[48:51], v[24:27]
    ds_read_b64_tr_b16 v[120:121], v126 offset:24576
    ds_read_b64_tr_b16 v[122:123], v126 offset:24832
    v_mfma_f32_16x16x32_bf16 v[28:31], v[68:71], v[48:51], v[28:31]
    ds_read_b64_tr_b16 v[68:69], v10 offset:28672
    ds_read_b64_tr_b16 v[70:71], v10 offset:28928
    v_mfma_f32_16x16x32_bf16 v[32:35], v[72:75], v[48:51], v[32:35]
    ds_read_b64_tr_b16 v[72:73], v124 offset:28672
    ds_read_b64_tr_b16 v[74:75], v124 offset:28928
    buffer_load_dwordx4 v[48:51], v1, s[32:35], s5 offen offset:1024 sc1
    s_waitcnt vmcnt(7) lgkmcnt(14)
    v_mfma_f32_16x16x32_bf16 v[20:23], v[76:79], v[52:55], v[20:23]
    ds_read_b64_tr_b16 v[76:77], v125 offset:28672
    ds_read_b64_tr_b16 v[78:79], v125 offset:28928
    v_mfma_f32_16x16x32_bf16 v[24:27], v[80:83], v[52:55], v[24:27]
    ds_read_b64_tr_b16 v[80:81], v126 offset:28672
    ds_read_b64_tr_b16 v[82:83], v126 offset:28928
    v_mfma_f32_16x16x32_bf16 v[28:31], v[84:87], v[52:55], v[28:31]
    ds_read_b64_tr_b16 v[84:85], v10 offset:32768
    ds_read_b64_tr_b16 v[86:87], v10 offset:33024
    v_mfma_f32_16x16x32_bf16 v[32:35], v[88:91], v[52:55], v[32:35]
    ds_read_b64_tr_b16 v[88:89], v124 offset:32768
    ds_read_b64_tr_b16 v[90:91], v124 offset:33024
    s_xor_b32 s5, s6, 12288
    buffer_load_dwordx4 v[52:55], v1, s[32:35], s5 offen offset:0 sc1
    s_waitcnt vmcnt(7) lgkmcnt(14)
    v_mfma_f32_16x16x32_bf16 v[20:23], v[92:95], v[56:59], v[20:23]
    ds_read_b64_tr_b16 v[92:93], v125 offset:32768
    ds_read_b64_tr_b16 v[94:95], v125 offset:33024
    v_mfma_f32_16x16x32_bf16 v[24:27], v[96:99], v[56:59], v[24:27]
    ds_read_b64_tr_b16 v[96:97], v126 offset:32768
    ds_read_b64_tr_b16 v[98:99], v126 offset:33024
    v_mfma_f32_16x16x32_bf16 v[28:31], v[100:103], v[56:59], v[28:31]
    ds_read_b64_tr_b16 v[100:101], v10 offset:36864
    ds_read_b64_tr_b16 v[102:103], v10 offset:37120
    v_mfma_f32_16x16x32_bf16 v[32:35], v[104:107], v[56:59], v[32:35]
    ds_read_b64_tr_b16 v[104:105], v124 offset:36864
    ds_read_b64_tr_b16 v[106:107], v124 offset:37120
    buffer_load_dwordx4 v[56:59], v1, s[32:35], s5 offen offset:1024 sc1
    s_waitcnt vmcnt(7) lgkmcnt(14)
    v_mfma_f32_16x16x32_bf16 v[20:23], v[108:111], v[60:63], v[20:23]
    ds_read_b64_tr_b16 v[108:109], v125 offset:36864
    ds_read_b64_tr_b16 v[110:111], v125 offset:37120
    v_mfma_f32_16x16x32_bf16 v[24:27], v[112:115], v[60:63], v[24:27]
    ds_read_b64_tr_b16 v[112:113], v126 offset:36864
    ds_read_b64_tr_b16 v[114:115], v126 offset:37120
    v_mfma_f32_16x16x32_bf16 v[28:31], v[116:119], v[60:63], v[28:31]
    ds_read_b64_tr_b16 v[116:117], v10 offset:40960
    ds_read_b64_tr_b16 v[118:119], v10 offset:41216
    v_mfma_f32_16x16x32_bf16 v[32:35], v[120:123], v[60:63], v[32:35]
    ds_read_b64_tr_b16 v[120:121], v124 offset:40960
    ds_read_b64_tr_b16 v[122:123], v124 offset:41216
    s_xor_b32 s5, s6, 14336
    buffer_load_dwordx4 v[60:63], v1, s[32:35], s5 offen offset:0 sc1
    s_waitcnt vmcnt(7) lgkmcnt(14)
    v_mfma_f32_16x16x32_bf16 v[20:23], v[68:71], v[64:67], v[20:23]
    ds_read_b64_tr_b16 v[68:69], v125 offset:40960
    ds_read_b64_tr_b16 v[70:71], v125 offset:41216
    v_mfma_f32_16x16x32_bf16 v[24:27], v[72:75], v[64:67], v[24:27]
    ds_read_b64_tr_b16 v[72:73], v126 offset:40960
    ds_read_b64_tr_b16 v[74:75], v126 offset:41216
    v_mfma_f32_16x16x32_bf16 v[28:31], v[76:79], v[64:67], v[28:31]
    ds_read_b64_tr_b16 v[76:77], v10 offset:45056
    ds_read_b64_tr_b16 v[78:79], v10 offset:45312
    v_mfma_f32_16x16x32_bf16 v[32:35], v[80:83], v[64:67], v[32:35]
    ds_read_b64_tr_b16 v[80:81], v124 offset:45056
    ds_read_b64_tr_b16 v[82:83], v124 offset:45312
    buffer_load_dwordx4 v[64:67], v1, s[32:35], s5 offen offset:1024 sc1
    s_waitcnt vmcnt(7) lgkmcnt(14)
    v_mfma_f32_16x16x32_bf16 v[20:23], v[84:87], v[36:39], v[20:23]
    ds_read_b64_tr_b16 v[84:85], v125 offset:45056
    ds_read_b64_tr_b16 v[86:87], v125 offset:45312
    v_mfma_f32_16x16x32_bf16 v[24:27], v[88:91], v[36:39], v[24:27]
    ds_read_b64_tr_b16 v[88:89], v126 offset:45056
    ds_read_b64_tr_b16 v[90:91], v126 offset:45312
    v_mfma_f32_16x16x32_bf16 v[28:31], v[92:95], v[36:39], v[28:31]
    ds_read_b64_tr_b16 v[92:93], v10 offset:49152
    ds_read_b64_tr_b16 v[94:95], v10 offset:49408
    v_mfma_f32_16x16x32_bf16 v[32:35], v[96:99], v[36:39], v[32:35]
    ds_read_b64_tr_b16 v[96:97], v124 offset:49152
    ds_read_b64_tr_b16 v[98:99], v124 offset:49408
    s_waitcnt vmcnt(6) lgkmcnt(14)
    v_mfma_f32_16x16x32_bf16 v[20:23], v[100:103], v[40:43], v[20:23]
    ds_read_b64_tr_b16 v[100:101], v10 offset:53248
    ds_read_b64_tr_b16 v[102:103], v10 offset:53504
    v_mfma_f32_16x16x32_bf16 v[24:27], v[104:107], v[40:43], v[24:27]
    ds_read_b64_tr_b16 v[104:105], v124 offset:53248
    ds_read_b64_tr_b16 v[106:107], v124 offset:53504
    v_mfma_f32_16x16x32_bf16 v[28:31], v[108:111], v[40:43], v[28:31]
    ds_read_b64_tr_b16 v[108:109], v10 offset:57344
    ds_read_b64_tr_b16 v[110:111], v10 offset:57600
    v_mfma_f32_16x16x32_bf16 v[32:35], v[112:115], v[40:43], v[32:35]
    ds_read_b64_tr_b16 v[112:113], v124 offset:57344
    ds_read_b64_tr_b16 v[114:115], v124 offset:57600
    s_waitcnt vmcnt(5) lgkmcnt(14)
    v_mfma_f32_16x16x32_bf16 v[20:23], v[116:119], v[44:47], v[20:23]
    ds_read_b64_tr_b16 v[116:117], v10 offset:61440
    ds_read_b64_tr_b16 v[118:119], v10 offset:61696
    v_mfma_f32_16x16x32_bf16 v[24:27], v[120:123], v[44:47], v[24:27]
    ds_read_b64_tr_b16 v[120:121], v124 offset:61440
    ds_read_b64_tr_b16 v[122:123], v124 offset:61696
    v_mfma_f32_16x16x32_bf16 v[28:31], v[68:71], v[44:47], v[28:31]
    ds_read_b64_tr_b16 v[68:69], v125 offset:49152
    ds_read_b64_tr_b16 v[70:71], v125 offset:49408
    v_mfma_f32_16x16x32_bf16 v[32:35], v[72:75], v[44:47], v[32:35]
L_pad10:
    s_cbranch_execz L_warm2
    ds_read_b64_tr_b16 v[72:73], v126 offset:49152
    ds_read_b64_tr_b16 v[74:75], v126 offset:49408
    s_waitcnt vmcnt(4) lgkmcnt(14)
    v_mfma_f32_16x16x32_bf16 v[20:23], v[76:79], v[48:51], v[20:23]
    ds_read_b64_tr_b16 v[76:77], v125 offset:53248
    ds_read_b64_tr_b16 v[78:79], v125 offset:53504
    v_mfma_f32_16x16x32_bf16 v[24:27], v[80:83], v[48:51], v[24:27]
    ds_read_b64_tr_b16 v[80:81], v126 offset:53248
    ds_read_b64_tr_b16 v[82:83], v126 offset:53504
    v_mfma_f32_16x16x32_bf16 v[28:31], v[84:87], v[48:51], v[28:31]
    ds_read_b64_tr_b16 v[84:85], v125 offset:57344
    ds_read_b64_tr_b16 v[86:87], v125 offset:57600
    v_mfma_f32_16x16x32_bf16 v[32:35], v[88:91], v[48:51], v[32:35]
    ds_read_b64_tr_b16 v[88:89], v126 offset:57344
    ds_read_b64_tr_b16 v[90:91], v126 offset:57600
    s_waitcnt vmcnt(2) lgkmcnt(14)
    v_mfma_f32_16x16x32_bf16 v[20:23], v[92:95], v[52:55], v[20:23]
    ds_read_b64_tr_b16 v[92:93], v125 offset:61440
    ds_read_b64_tr_b16 v[94:95], v125 offset:61696
    v_mfma_f32_16x16x32_bf16 v[24:27], v[96:99], v[52:55], v[24:27]
    ds_read_b64_tr_b16 v[96:97], v126 offset:61440
    ds_read_b64_tr_b16 v[98:99], v126 offset:61696
    v_mfma_f32_16x16x32_bf16 v[20:23], v[100:103], v[56:59], v[20:23]
    v_and_b32 v16, 15, v0
    v_lshrrev_b32 v17, 8, v11
    v_mfma_f32_16x16x32_bf16 v[24:27], v[104:107], v[56:59], v[24:27]
    v_and_b32 v18, 7, v0
    v_xor_b32 v17, v17, v18
    s_waitcnt vmcnt(0) lgkmcnt(14)
    v_mfma_f32_16x16x32_bf16 v[20:23], v[108:111], v[60:63], v[20:23]
    v_lshlrev_b32 v17, 4, v17
    v_lshl_add_u32 v16, v16, 7, v17
    v_mfma_f32_16x16x32_bf16 v[24:27], v[112:115], v[60:63], v[24:27]
    v_sub_u32 v17, v14, v1
    v_add_u32 v16, v16, v17
    v_mfma_f32_16x16x32_bf16 v[20:23], v[116:119], v[64:67], v[20:23]
    v_xor_b32 v17, 64, v16
    v_lshrrev_b32 v19, 3, v0
    v_mfma_f32_16x16x32_bf16 v[24:27], v[120:123], v[64:67], v[24:27]
    v_xor_b32 v18, v18, v19
    v_lshlrev_b32 v18, 4, v18
    s_waitcnt lgkmcnt(8)
    v_mfma_f32_16x16x32_bf16 v[28:31], v[68:71], v[52:55], v[28:31]
    v_lshl_add_u32 v18, v19, 10, v18
    s_add_u32 s3, s50, 8192
    v_mfma_f32_16x16x32_bf16 v[32:35], v[72:75], v[52:55], v[32:35]
    v_mfma_f32_16x16x32_bf16 v[28:31], v[76:79], v[56:59], v[28:31]
    v_cvt_pk_bf16_f32 v36, v20, v21
    v_cvt_pk_bf16_f32 v37, v22, v23
    v_mfma_f32_16x16x32_bf16 v[32:35], v[80:83], v[56:59], v[32:35]
    v_cvt_pk_bf16_f32 v38, v24, v25
    v_cvt_pk_bf16_f32 v39, v26, v27
    s_waitcnt lgkmcnt(0)
    v_mfma_f32_16x16x32_bf16 v[28:31], v[84:87], v[60:63], v[28:31]
    s_cmp_eq_u32 s53, 0
    v_permlane16_swap_b32 v36, v38
    v_mfma_f32_16x16x32_bf16 v[32:35], v[88:91], v[60:63], v[32:35]
    v_permlane16_swap_b32 v37, v39
    ds_write_b128 v16, v[36:39]
    v_mfma_f32_16x16x32_bf16 v[28:31], v[92:95], v[64:67], v[28:31]
    v_mfma_f32_16x16x32_bf16 v[32:35], v[96:99], v[64:67], v[32:35]
    s_nop 6
    v_cvt_pk_bf16_f32 v40, v28, v29
    v_cvt_pk_bf16_f32 v41, v30, v31
    v_cvt_pk_bf16_f32 v42, v32, v33
    v_cvt_pk_bf16_f32 v43, v34, v35
    s_cmp_eq_u32 s53, 0
    v_permlane16_swap_b32 v40, v42
    v_permlane16_swap_b32 v41, v43
    ds_write_b128 v17, v[40:43]
    ds_read_b128 v[44:47], v14
    ds_read_b128 v[48:51], v14 offset:1024
    s_waitcnt lgkmcnt(1)
    buffer_store_dwordx4 v[44:47], v18, s[28:31], s50 offen
    s_waitcnt lgkmcnt(0)
    buffer_store_dwordx4 v[48:51], v18, s[28:31], s3 offen
    s_or_b32 s3, s2, s38
    s_cmp_eq_u32 s3, 0
    s_cselect_b32 s3, 0, 67108864
    v_mov_b32 v52, s42
    buffer_store_dword v52, v15, s[32:35], s3 offen sc1
L_end:
    s_endpgm
L_pad11:
    s_branch L_warm2
L_rty:
L_retry_1:
    s_mov_b64 exec, vcc
L_again_3:
    buffer_load_dwordx4 v[104:107], v116, s[32:35], s4 offen offset:0 sc1
    s_add_u32 s43, s43, 1
    s_cmp_ge_u32 s43, 0x20000
    s_cbranch_scc1 L_end
    s_waitcnt vmcnt(0)
    v_cmp_ne_u32 vcc, s39, v107
    s_and_b64 exec, exec, vcc
    s_cbranch_scc1 L_again_3
    s_mov_b64 exec, -1
    s_branch L_back_2
L_retry_4:
    s_mov_b64 exec, vcc
L_again_6:
    buffer_load_dword v252, v248, s[32:35], s99 offen offset:128 sc1
    s_add_u32 s43, s43, 1
    s_cmp_ge_u32 s43, 0x20000
    s_cbranch_scc1 L_end
    s_waitcnt vmcnt(0)
    v_subrev_u32 v120, s39, v252
    v_cmp_lt_u32 vcc, 15, v120
    s_and_b64 exec, exec, vcc
    s_cbranch_scc1 L_again_6
    s_mov_b64 exec, -1
    s_branch L_back_5
L_retry_7:
    s_mov_b64 exec, vcc
L_again_9:
    buffer_load_dwordx4 v[96:99], v1, s[32:35], s98 offen offset:0 sc1
    s_add_u32 s43, s43, 1
    s_cmp_ge_u32 s43, 0x20000
    s_cbranch_scc1 L_end
    s_waitcnt vmcnt(0)
    v_cmp_ne_u32 vcc, s39, v99
    s_and_b64 exec, exec, vcc
    s_cbranch_scc1 L_again_9
    s_mov_b64 exec, -1
    s_branch L_back_8
L_retry_19:
    s_mov_b64 exec, vcc
L_again_21:
    buffer_load_dword v79, v19, s[32:35], s57 offen offset:0 sc1
    s_add_u32 s43, s43, 1
    s_cmp_ge_u32 s43, 0x20000
    s_cbranch_scc1 L_end
    s_waitcnt vmcnt(0)
    v_cmp_ne_u32 vcc, s39, v79
    s_and_b64 exec, exec, vcc
    s_cbranch_scc1 L_again_21
    s_mov_b64 exec, -1
    s_branch L_back_20
L_retry_22:
    s_mov_b64 exec, vcc
L_again_24:
    buffer_load_dword v8, v19, s[32:35], s5 offen offset:0 sc1
    s_add_u32 s43, s43, 1
    s_cmp_ge_u32 s43, 0x20000
    s_cbranch_scc1 L_end
    s_waitcnt vmcnt(0)
    v_cmp_ne_u32 vcc, s39, v8
    s_and_b64 exec, exec, vcc
    s_cbranch_scc1 L_again_24
    s_mov_b64 exec, -1
    s_branch L_back_23
L_retry_44:
    s_mov_b64 exec, vcc
L_again_46:
    buffer_load_dwordx4 v[104:107], v116, s[32:35], s4 offen offset:0 sc1
    s_add_u32 s43, s43, 1
    s_cmp_ge_u32 s43, 0x20000
    s_cbranch_scc1 L_end
    s_waitcnt vmcnt(0)
    v_cmp_ne_u32 vcc, s39, v107
    s_and_b64 exec, exec, vcc
    s_cbranch_scc1 L_again_46
    s_mov_b64 exec, -1
    s_branch L_back_45
L_retry_48:
L_again_49:
    s_add_u32 s43, s43, 1
    s_cmp_ge_u32 s43, 0x20000
    s_cbranch_scc1 L_end
    s_mov_b32 s7, 0
    v_cmp_ne_u32 vcc, s39, v47
    s_cbranch_vccz L_skip_51
    s_xor_b32 s99, s98, 7168
    buffer_load_dwordx4 v[44:47], v1, s[32:35], s99 offen offset:0 sc1
    s_mov_b32 s7, 1
L_skip_51:
    v_cmp_ne_u32 vcc, s39, v51
    s_cbranch_vccz L_skip_52
    s_xor_b32 s99, s98, 6144
    buffer_load_dwordx4 v[48:51], v1, s[32:35], s99 offen offset:0 sc1
    s_mov_b32 s7, 1
L_skip_52:
    v_cmp_ne_u32 vcc, s39, v55
    s_cbranch_vccz L_skip_53
    s_xor_b32 s99, s98, 5120
    buffer_load_dwordx4 v[52:55], v1, s[32:35], s99 offen offset:0 sc1
    s_mov_b32 s7, 1
L_skip_53:
    v_cmp_ne_u32 vcc, s39, v59
    s_cbranch_vccz L_skip_54
    s_xor_b32 s99, s98, 4096
    buffer_load_dwordx4 v[56:59], v1, s[32:35], s99 offen offset:0 sc1
    s_mov_b32 s7, 1
L_skip_54:
    v_cmp_ne_u32 vcc, s39, v63
    s_cbranch_vccz L_skip_55
    s_xor_b32 s99, s98, 3072
    buffer_load_dwordx4 v[60:63], v1, s[32:35], s99 offen offset:0 sc1
    s_mov_b32 s7, 1
L_skip_55:
    v_cmp_ne_u32 vcc, s39, v67
    s_cbranch_vccz L_skip_56
    s_xor_b32 s99, s98, 2048
    buffer_load_dwordx4 v[64:67], v1, s[32:35], s99 offen offset:0 sc1
    s_mov_b32 s7, 1
L_skip_56:
    v_cmp_ne_u32 vcc, s39, v71
    s_cbranch_vccz L_skip_57
    s_xor_b32 s99, s98, 1024
    buffer_load_dwordx4 v[68:71], v1, s[32:35], s99 offen offset:0 sc1
    s_mov_b32 s7, 1
L_skip_57:
    v_cmp_ne_u32 vcc, s39, v75
    s_cbranch_vccz L_skip_58
    s_xor_b32 s99, s98, 0
    buffer_load_dwordx4 v[72:75], v1, s[32:35], s99 offen offset:0 sc1
    s_mov_b32 s7, 1
L_skip_58:
    s_cmp_eq_u32 s7, 0
    s_cbranch_scc1 L_sum_47
    s_waitcnt vmcnt(0)
    s_branch L_again_49
L_retry_76:
    s_mov_b64 exec, vcc
L_again_78:
    buffer_load_dword v118, v19, s[32:35], s57 offen offset:0 sc1
    s_add_u32 s43, s43, 1
    s_cmp_ge_u32 s43, 0x20000
    s_cbranch_scc1 L_end
    s_waitcnt vmcnt(0)
    v_cmp_ne_u32 vcc, s39, v118
    s_and_b64 exec, exec, vcc
    s_cbranch_scc1 L_again_78
    s_mov_b64 exec, -1
    s_branch L_back_77
L_retry_79:
    s_mov_b64 exec, vcc
L_again_81:
    buffer_load_dword v3, v19, s[32:35], s5 offen offset:0 sc1
    s_add_u32 s43, s43, 1
    s_cmp_ge_u32 s43, 0x20000
    s_cbranch_scc1 L_end
    s_waitcnt vmcnt(0)
    v_cmp_ne_u32 vcc, s39, v3
    s_and_b64 exec, exec, vcc
    s_cbranch_scc1 L_again_81
    s_mov_b64 exec, -1
    s_branch L_back_80
L_retry_91:
    s_mov_b64 exec, vcc
L_again_93:
    buffer_load_dword v79, v19, s[32:35], s3 offen offset:0 sc1
    s_add_u32 s43, s43, 1
    s_cmp_ge_u32 s43, 0x20000
    s_cbranch_scc1 L_end
    s_waitcnt vmcnt(0)
    v_cmp_ne_u32 vcc, s39, v79
    s_and_b64 exec, exec, vcc
    s_cbranch_scc1 L_again_93
    s_mov_b64 exec, -1
    s_branch L_back_92
L_codeend:
L_slow_10:
    buffer_store_dword v70, v71, s[32:35], s52 offen offset:0 sc1
    s_branch L_back_11
L_slow_15:
    buffer_store_dwordx4 v[44:47], v18, s[32:35], s1 offen sc1
    s_branch L_back_16
L_slow_25:
    buffer_store_dwordx4 v[38:41], v7, s[32:35], s4 offen sc1
    s_branch L_back_26
L_slow_27:
    buffer_store_dwordx4 v[54:57], v7, s[32:35], s5 offen sc1
    s_branch L_back_28
L_slow_29:
    buffer_store_dword v70, v71, s[32:35], s52 offen offset:32 sc1
    s_branch L_back_30
L_slow_34:
    buffer_store_dwordx4 v[36:39], v11, s[32:35], s4 offen offset:0 sc1
    s_branch L_back_35
L_slow_36:
    buffer_store_dwordx4 v[40:43], v11, s[32:35], s4 offen offset:1024 sc1
    s_branch L_back_37
L_slow_38:
    buffer_store_dwordx4 v[44:47], v18, s[32:35], s1 offen sc1
    s_branch L_back_39
L_slow_42:
    buffer_store_dwordx4 v[98:101], v7, s[32:35], s5 offen sc1
    s_branch L_back_43
L_slow_59:
    buffer_store_dwordx4 v[38:41], v7, s[32:35], s4 offen sc1
    s_branch L_back_60
L_slow_61:
    buffer_store_dwordx4 v[54:57], v7, s[32:35], s5 offen sc1
    s_branch L_back_62
L_slow_63:
    buffer_store_dword v70, v71, s[32:35], s52 offen offset:64 sc1
    s_branch L_back_64
L_slow_68:
    buffer_store_dwordx4 v[36:39], v11, s[32:35], s4 offen offset:0 sc1
    s_branch L_back_69
L_slow_70:
    buffer_store_dwordx4 v[40:43], v11, s[32:35], s4 offen offset:1024 sc1
    s_branch L_back_71
L_slow_72:
    buffer_store_dwordx4 v[44:47], v18, s[32:35], s1 offen sc1
    s_branch L_back_73
L_slow_82:
    buffer_store_dwordx4 v[38:41], v7, s[32:35], s4 offen sc1
    s_branch L_back_83
L_slow_84:
    buffer_store_dwordx4 v[54:57], v7, s[32:35], s5 offen sc1
    s_branch L_back_85
L_slow_86:
    buffer_store_dword v70, v71, s[32:35], s52 offen offset:96 sc1
    s_branch L_back_87
L_fallback:
    s_nop 15
    s_add_u32 s3, s57, 0x40000
    buffer_load_dword v79, v19, s[32:35], s3 offen offset:0 sc1
    s_waitcnt vmcnt(0)
    v_cmp_ne_u32 vcc, s39, v79
    s_cbranch_vccnz L_retry_91
L_back_92:
    s_add_u32 m0, s58, 0
    s_nop 0
    buffer_load_dwordx4 v1, s[32:35], s60 offen offset:0 sc1 lds
    buffer_load_dwordx4 v1, s[32:35], s60 offen offset:1024 sc1 lds
    s_add_u32 m0, s58, 2064
    s_nop 0
    buffer_load_dwordx4 v1, s[32:35], s61 offen offset:0 sc1 lds
    buffer_load_dwordx4 v1, s[32:35], s61 offen offset:1024 sc1 lds
    s_add_u32 m0, s58, 4128
    s_nop 0
    buffer_load_dwordx4 v1, s[32:35], s62 offen offset:0 sc1 lds
    buffer_load_dwordx4 v1, s[32:35], s62 offen offset:1024 sc1 lds
    s_add_u32 m0, s58, 6192
    s_nop 0
    buffer_load_dwordx4 v1, s[32:35], s63 offen offset:0 sc1 lds
    buffer_load_dwordx4 v1, s[32:35], s63 offen offset:1024 sc1 lds
    s_add_u32 m0, s58, 30976
    s_nop 0
    buffer_load_dwordx4 v1, s[32:35], s60 offen offset:2048 sc1 lds
    buffer_load_dwordx4 v1, s[32:35], s60 offen offset:3072 sc1 lds
    s_add_u32 m0, s58, 33040
    s_nop 0
    buffer_load_dwordx4 v1, s[32:35], s61 offen offset:2048 sc1 lds
    buffer_load_dwordx4 v1, s[32:35], s61 offen offset:3072 sc1 lds
    s_add_u32 m0, s58, 35104
    s_nop 0
    buffer_load_dwordx4 v1, s[32:35], s62 offen offset:2048 sc1 lds
    buffer_load_dwordx4 v1, s[32:35], s62 offen offset:3072 sc1 lds
    s_add_u32 m0, s58, 37168
    s_nop 0
    buffer_load_dwordx4 v1, s[32:35], s63 offen offset:2048 sc1 lds
    buffer_load_dwordx4 v1, s[32:35], s63 offen offset:3072 sc1 lds
    s_add_u32 m0, s59, 0
    s_nop 0
    buffer_load_dwordx4 v1, s[32:35], s56 offen offset:0 sc1 lds
    s_add_u32 m0, s59, 16
    s_nop 0
    buffer_load_dwordx4 v1, s[32:35], s56 offen offset:2048 sc1 lds
    s_waitcnt vmcnt(0)
    s_lshl_b32 s3, s36, 1
    s_sub_i32 s96, 8, s3
    s_max_i32 s96, s96, 0
    s_sub_u32 s97, s59, s58
    s_max_i32 s98, s96, 0
    v_mov_b32 v16, v18
L_fb1_94:
    s_and_b32 s3, s98, 1
    s_lshr_b32 s7, s98, 1
    s_sub_u32 s7, 3, s7
    s_lshl4_add_u32 s7, s3, s7
    s_cmp_ge_u32 s98, 8
    s_cselect_b32 s3, s3, s7
    s_cselect_b32 s7, s97, 0
    s_mul_i32 s3, s3, 2064
    s_add_u32 s3, s3, s7
    v_add_u32 v112, s3, v13
    v_add_u32 v113, s3, v14
    v_add_u32 v114, s3, v15
    ds_read_b128 v[76:79], v112
    s_waitcnt lgkmcnt(0)
    v_mfma_f32_32x32x16_bf16 v[96:111], v[76:79], v[20:23], 0
    s_nop 15
    s_cmp_lg_u32 s98, 8
    s_cbranch_scc1 L_m_95
    v_cndmask_b32 v96, v18, v96, s[64:65]
    v_cndmask_b32 v97, v18, v97, s[66:67]
    v_cndmask_b32 v98, v18, v98, s[68:69]
    v_cndmask_b32 v99, v18, v99, s[70:71]
    v_cndmask_b32 v100, v18, v100, s[72:73]
    v_cndmask_b32 v101, v18, v101, s[74:75]
    v_cndmask_b32 v102, v18, v102, s[76:77]
    v_cndmask_b32 v103, v18, v103, s[78:79]
    v_cndmask_b32 v104, v18, v104, s[80:81]
    v_cndmask_b32 v105, v18, v105, s[82:83]
    v_cndmask_b32 v106, v18, v106, s[84:85]
    v_cndmask_b32 v107, v18, v107, s[86:87]
    v_cndmask_b32 v108, v18, v108, s[88:89]
    v_cndmask_b32 v109, v18, v109, s[90:91]
    v_cndmask_b32 v110, v18, v110, s[92:93]
    v_cndmask_b32 v111, v18, v111, s[94:95]
L_m_95:
    s_cmp_lg_u32 s98, 0
    s_cbranch_scc1 L_m_96
    v_cndmask_b32 v96, v96, v18, s[64:65]
    v_cndmask_b32 v97, v97, v18, s[66:67]
    v_cndmask_b32 v98, v98, v18, s[68:69]
    v_cndmask_b32 v99, v99, v18, s[70:71]
    v_cndmask_b32 v100, v100, v18, s[72:73]
    v_cndmask_b32 v101, v101, v18, s[74:75]
    v_cndmask_b32 v102, v102, v18, s[76:77]
    v_cndmask_b32 v103, v103, v18, s[78:79]
    v_cndmask_b32 v104, v104, v18, s[80:81]
    v_cndmask_b32 v105, v105, v18, s[82:83]
    v_cndmask_b32 v106, v106, v18, s[84:85]
    v_cndmask_b32 v107, v107, v18, s[86:87]
    v_cndmask_b32 v108, v108, v18, s[88:89]
    v_cndmask_b32 v109, v109, v18, s[90:91]
    v_cndmask_b32 v110, v110, v18, s[92:93]
    v_cndmask_b32 v111, v111, v18, s[94:95]
L_m_96:
    v_max3_f32 v16, v16, v96, v97
    v_max3_f32 v16, v16, v98, v99
    v_max3_f32 v16, v16, v100, v101
    v_max3_f32 v16, v16, v102, v103
    v_max3_f32 v16, v16, v104, v105
    v_max3_f32 v16, v16, v106, v107
    v_max3_f32 v16, v16, v108, v109
    v_max3_f32 v16, v16, v110, v111
    s_add_u32 s98, s98, 1
    s_cmp_le_u32 s98, 8
    s_cbranch_scc1 L_fb1_94
    v_mov_b32 v115, v16
    s_nop 1
    v_permlane32_swap_b32 v16, v115
    v_max_f32 v16, v16, v115
    v_mov_b32 v28, 0
    v_mov_b32 v29, 0
    v_mov_b32 v30, 0
    v_mov_b32 v31, 0
    v_mov_b32 v32, 0
    v_mov_b32 v33, 0
    v_mov_b32 v34, 0
    v_mov_b32 v35, 0
    v_mov_b32 v36, 0
    v_mov_b32 v37, 0
    v_mov_b32 v38, 0
    v_mov_b32 v39, 0
    v_mov_b32 v40, 0
    v_mov_b32 v41, 0
    v_mov_b32 v42, 0
    v_mov_b32 v43, 0
    s_max_i32 s98, s96, 0
L_fb2_97:
    s_and_b32 s3, s98, 1
    s_lshr_b32 s7, s98, 1
    s_sub_u32 s7, 3, s7
    s_lshl4_add_u32 s7, s3, s7
    s_cmp_ge_u32 s98, 8
    s_cselect_b32 s3, s3, s7
    s_cselect_b32 s7, s97, 0
    s_mul_i32 s3, s3, 2064
    s_add_u32 s3, s3, s7
    v_add_u32 v112, s3, v13
    v_add_u32 v113, s3, v14
    v_add_u32 v114, s3, v15
    ds_read_b128 v[76:79], v112
    s_waitcnt lgkmcnt(0)
    v_mfma_f32_32x32x16_bf16 v[96:111], v[76:79], v[20:23], 0
    s_nop 15
    s_cmp_lg_u32 s98, 8
    s_cbranch_scc1 L_m_98
    v_cndmask_b32 v96, v18, v96, s[64:65]
    v_cndmask_b32 v97, v18, v97, s[66:67]
    v_cndmask_b32 v98, v18, v98, s[68:69]
    v_cndmask_b32 v99, v18, v99, s[70:71]
    v_cndmask_b32 v100, v18, v100, s[72:73]
    v_cndmask_b32 v101, v18, v101, s[74:75]
    v_cndmask_b32 v102, v18, v102, s[76:77]
    v_cndmask_b32 v103, v18, v103, s[78:79]
    v_cndmask_b32 v104, v18, v104, s[80:81]
    v_cndmask_b32 v105, v18, v105, s[82:83]
    v_cndmask_b32 v106, v18, v106, s[84:85]
    v_cndmask_b32 v107, v18, v107, s[86:87]
    v_cndmask_b32 v108, v18, v108, s[88:89]
    v_cndmask_b32 v109, v18, v109, s[90:91]
    v_cndmask_b32 v110, v18, v110, s[92:93]
    v_cndmask_b32 v111, v18, v111, s[94:95]
L_m_98:
    s_cmp_lg_u32 s98, 0
    s_cbranch_scc1 L_m_99
    v_cndmask_b32 v96, v96, v18, s[64:65]
    v_cndmask_b32 v97, v97, v18, s[66:67]
    v_cndmask_b32 v98, v98, v18, s[68:69]
    v_cndmask_b32 v99, v99, v18, s[70:71]
    v_cndmask_b32 v100, v100, v18, s[72:73]
    v_cndmask_b32 v101, v101, v18, s[74:75]
    v_cndmask_b32 v102, v102, v18, s[76:77]
    v_cndmask_b32 v103, v103, v18, s[78:79]
    v_cndmask_b32 v104, v104, v18, s[80:81]
    v_cndmask_b32 v105, v105, v18, s[82:83]
    v_cndmask_b32 v106, v106, v18, s[84:85]
    v_cndmask_b32 v107, v107, v18, s[86:87]
    v_cndmask_b32 v108, v108, v18, s[88:89]
    v_cndmask_b32 v109, v109, v18, s[90:91]
    v_cndmask_b32 v110, v110, v18, s[92:93]
    v_cndmask_b32 v111, v111, v18, s[94:95]
L_m_99:
    ds_read_b128 v[88:91], v113
    ds_read_b128 v[92:95], v114
    v_sub_f32 v96, v96, v16
    v_sub_f32 v97, v97, v16
    v_sub_f32 v98, v98, v16
    v_sub_f32 v99, v99, v16
    v_sub_f32 v100, v100, v16
    v_sub_f32 v101, v101, v16
    v_sub_f32 v102, v102, v16
    v_sub_f32 v103, v103, v16
    v_sub_f32 v104, v104, v16
    v_sub_f32 v105, v105, v16
    v_sub_f32 v106, v106, v16
    v_sub_f32 v107, v107, v16
    v_sub_f32 v108, v108, v16
    v_sub_f32 v109, v109, v16
    v_sub_f32 v110, v110, v16
    v_sub_f32 v111, v111, v16
    s_waitcnt lgkmcnt(0)
    v_exp_f32 v96, v96
    v_exp_f32 v97, v97
    v_exp_f32 v98, v98
    v_exp_f32 v99, v99
    v_exp_f32 v100, v100
    v_exp_f32 v101, v101
    v_exp_f32 v102, v102
    v_exp_f32 v103, v103
    v_cvt_pk_bf16_f32 v96, v96, v97
    v_cvt_pk_bf16_f32 v97, v98, v99
    v_cvt_pk_bf16_f32 v98, v100, v101
    v_cvt_pk_bf16_f32 v99, v102, v103
    s_nop 1
    v_mfma_f32_32x32x16_bf16 v[28:43], v[88:91], v[96:99], v[28:43]
    v_exp_f32 v104, v104
    v_exp_f32 v105, v105
    v_exp_f32 v106, v106
    v_exp_f32 v107, v107
    v_exp_f32 v108, v108
    v_exp_f32 v109, v109
    v_exp_f32 v110, v110
    v_exp_f32 v111, v111
    v_cvt_pk_bf16_f32 v104, v104, v105
    v_cvt_pk_bf16_f32 v105, v106, v107
    v_cvt_pk_bf16_f32 v106, v108, v109
    v_cvt_pk_bf16_f32 v107, v110, v111
    s_nop 1
    v_mfma_f32_32x32x16_bf16 v[28:43], v[92:95], v[104:107], v[28:43]
    s_nop 15
    s_add_u32 s98, s98, 1
    s_cmp_le_u32 s98, 8
    s_cbranch_scc1 L_fb2_97
    s_max_i32 s98, s96, 1
    v_mov_b32 v17, v18
L_fb1_100:
    s_and_b32 s3, s98, 1
    s_lshr_b32 s7, s98, 1
    s_sub_u32 s7, 3, s7
    s_lshl4_add_u32 s7, s3, s7
    s_cmp_ge_u32 s98, 8
    s_cselect_b32 s3, s3, s7
    s_cselect_b32 s7, s97, 0
    s_mul_i32 s3, s3, 2064
    s_add_u32 s3, s3, s7
    v_add_u32 v112, s3, v13
    v_add_u32 v113, s3, v14
    v_add_u32 v114, s3, v15
    ds_read_b128 v[76:79], v112
    s_waitcnt lgkmcnt(0)
    v_mfma_f32_32x32x16_bf16 v[96:111], v[76:79], v[24:27], 0
    s_nop 15
    s_cmp_lg_u32 s98, 9
    s_cbranch_scc1 L_m_101
    v_cndmask_b32 v96, v18, v96, s[64:65]
    v_cndmask_b32 v97, v18, v97, s[66:67]
    v_cndmask_b32 v98, v18, v98, s[68:69]
    v_cndmask_b32 v99, v18, v99, s[70:71]
    v_cndmask_b32 v100, v18, v100, s[72:73]
    v_cndmask_b32 v101, v18, v101, s[74:75]
    v_cndmask_b32 v102, v18, v102, s[76:77]
    v_cndmask_b32 v103, v18, v103, s[78:79]
    v_cndmask_b32 v104, v18, v104, s[80:81]
    v_cndmask_b32 v105, v18, v105, s[82:83]
    v_cndmask_b32 v106, v18, v106, s[84:85]
    v_cndmask_b32 v107, v18, v107, s[86:87]
    v_cndmask_b32 v108, v18, v108, s[88:89]
    v_cndmask_b32 v109, v18, v109, s[90:91]
    v_cndmask_b32 v110, v18, v110, s[92:93]
    v_cndmask_b32 v111, v18, v111, s[94:95]
L_m_101:
    s_cmp_lg_u32 s98, 1
    s_cbranch_scc1 L_m_102
    v_cndmask_b32 v96, v96, v18, s[64:65]
    v_cndmask_b32 v97, v97, v18, s[66:67]
    v_cndmask_b32 v98, v98, v18, s[68:69]
    v_cndmask_b32 v99, v99, v18, s[70:71]
    v_cndmask_b32 v100, v100, v18, s[72:73]
    v_cndmask_b32 v101, v101, v18, s[74:75]
    v_cndmask_b32 v102, v102, v18, s[76:77]
    v_cndmask_b32 v103, v103, v18, s[78:79]
    v_cndmask_b32 v104, v104, v18, s[80:81]
    v_cndmask_b32 v105, v105, v18, s[82:83]
    v_cndmask_b32 v106, v106, v18, s[84:85]
    v_cndmask_b32 v107, v107, v18, s[86:87]
    v_cndmask_b32 v108, v108, v18, s[88:89]
    v_cndmask_b32 v109, v109, v18, s[90:91]
    v_cndmask_b32 v110, v110, v18, s[92:93]
    v_cndmask_b32 v111, v111, v18, s[94:95]
L_m_102:
    v_max3_f32 v17, v17, v96, v97
    v_max3_f32 v17, v17, v98, v99
    v_max3_f32 v17, v17, v100, v101
    v_max3_f32 v17, v17, v102, v103
    v_max3_f32 v17, v17, v104, v105
    v_max3_f32 v17, v17, v106, v107
    v_max3_f32 v17, v17, v108, v109
    v_max3_f32 v17, v17, v110, v111
    s_add_u32 s98, s98, 1
    s_cmp_le_u32 s98, 9
    s_cbranch_scc1 L_fb1_100
    v_mov_b32 v115, v17
    s_nop 1
    v_permlane32_swap_b32 v17, v115
    v_max_f32 v17, v17, v115
    v_mov_b32 v44, 0
    v_mov_b32 v45, 0
    v_mov_b32 v46, 0
    v_mov_b32 v47, 0
    v_mov_b32 v48, 0
    v_mov_b32 v49, 0
    v_mov_b32 v50, 0
    v_mov_b32 v51, 0
    v_mov_b32 v52, 0
    v_mov_b32 v53, 0
    v_mov_b32 v54, 0
    v_mov_b32 v55, 0
    v_mov_b32 v56, 0
    v_mov_b32 v57, 0
    v_mov_b32 v58, 0
    v_mov_b32 v59, 0
    s_max_i32 s98, s96, 1
L_fb2_103:
    s_and_b32 s3, s98, 1
    s_lshr_b32 s7, s98, 1
    s_sub_u32 s7, 3, s7
    s_lshl4_add_u32 s7, s3, s7
    s_cmp_ge_u32 s98, 8
    s_cselect_b32 s3, s3, s7
    s_cselect_b32 s7, s97, 0
    s_mul_i32 s3, s3, 2064
    s_add_u32 s3, s3, s7
    v_add_u32 v112, s3, v13
    v_add_u32 v113, s3, v14
    v_add_u32 v114, s3, v15
    ds_read_b128 v[76:79], v112
    s_waitcnt lgkmcnt(0)
    v_mfma_f32_32x32x16_bf16 v[96:111], v[76:79], v[24:27], 0
    s_nop 15
    s_cmp_lg_u32 s98, 9
    s_cbranch_scc1 L_m_104
    v_cndmask_b32 v96, v18, v96, s[64:65]
    v_cndmask_b32 v97, v18, v97, s[66:67]
    v_cndmask_b32 v98, v18, v98, s[68:69]
    v_cndmask_b32 v99, v18, v99, s[70:71]
    v_cndmask_b32 v100, v18, v100, s[72:73]
    v_cndmask_b32 v101, v18, v101, s[74:75]
    v_cndmask_b32 v102, v18, v102, s[76:77]
    v_cndmask_b32 v103, v18, v103, s[78:79]
    v_cndmask_b32 v104, v18, v104, s[80:81]
    v_cndmask_b32 v105, v18, v105, s[82:83]
    v_cndmask_b32 v106, v18, v106, s[84:85]
    v_cndmask_b32 v107, v18, v107, s[86:87]
    v_cndmask_b32 v108, v18, v108, s[88:89]
    v_cndmask_b32 v109, v18, v109, s[90:91]
    v_cndmask_b32 v110, v18, v110, s[92:93]
    v_cndmask_b32 v111, v18, v111, s[94:95]
L_m_104:
    s_cmp_lg_u32 s98, 1
    s_cbranch_scc1 L_m_105
    v_cndmask_b32 v96, v96, v18, s[64:65]
    v_cndmask_b32 v97, v97, v18, s[66:67]
    v_cndmask_b32 v98, v98, v18, s[68:69]
    v_cndmask_b32 v99, v99, v18, s[70:71]
    v_cndmask_b32 v100, v100, v18, s[72:73]
    v_cndmask_b32 v101, v101, v18, s[74:75]
    v_cndmask_b32 v102, v102, v18, s[76:77]
    v_cndmask_b32 v103, v103, v18, s[78:79]
    v_cndmask_b32 v104, v104, v18, s[80:81]
    v_cndmask_b32 v105, v105, v18, s[82:83]
    v_cndmask_b32 v106, v106, v18, s[84:85]
    v_cndmask_b32 v107, v107, v18, s[86:87]
    v_cndmask_b32 v108, v108, v18, s[88:89]
    v_cndmask_b32 v109, v109, v18, s[90:91]
    v_cndmask_b32 v110, v110, v18, s[92:93]
    v_cndmask_b32 v111, v111, v18, s[94:95]
L_m_105:
    ds_read_b128 v[88:91], v113
    ds_read_b128 v[92:95], v114
    v_sub_f32 v96, v96, v17
    v_sub_f32 v97, v97, v17
    v_sub_f32 v98, v98, v17
    v_sub_f32 v99, v99, v17
    v_sub_f32 v100, v100, v17
    v_sub_f32 v101, v101, v17
    v_sub_f32 v102, v102, v17
    v_sub_f32 v103, v103, v17
    v_sub_f32 v104, v104, v17
    v_sub_f32 v105, v105, v17
    v_sub_f32 v106, v106, v17
    v_sub_f32 v107, v107, v17
    v_sub_f32 v108, v108, v17
    v_sub_f32 v109, v109, v17
    v_sub_f32 v110, v110, v17
    v_sub_f32 v111, v111, v17
    s_waitcnt lgkmcnt(0)
    v_exp_f32 v96, v96
    v_exp_f32 v97, v97
    v_exp_f32 v98, v98
    v_exp_f32 v99, v99
    v_exp_f32 v100, v100
    v_exp_f32 v101, v101
    v_exp_f32 v102, v102
    v_exp_f32 v103, v103
    v_cvt_pk_bf16_f32 v96, v96, v97
    v_cvt_pk_bf16_f32 v97, v98, v99
    v_cvt_pk_bf16_f32 v98, v100, v101
    v_cvt_pk_bf16_f32 v99, v102, v103
    s_nop 1
    v_mfma_f32_32x32x16_bf16 v[44:59], v[88:91], v[96:99], v[44:59]
    v_exp_f32 v104, v104
    v_exp_f32 v105, v105
    v_exp_f32 v106, v106
    v_exp_f32 v107, v107
    v_exp_f32 v108, v108
    v_exp_f32 v109, v109
    v_exp_f32 v110, v110
    v_exp_f32 v111, v111
    v_cvt_pk_bf16_f32 v104, v104, v105
    v_cvt_pk_bf16_f32 v105, v106, v107
    v_cvt_pk_bf16_f32 v106, v108, v109
    v_cvt_pk_bf16_f32 v107, v110, v111
    s_nop 1
    v_mfma_f32_32x32x16_bf16 v[44:59], v[92:95], v[104:107], v[44:59]
    s_nop 15
    s_add_u32 s98, s98, 1
    s_cmp_le_u32 s98, 9
    s_cbranch_scc1 L_fb2_103
    v_rcp_f32 v36, v36
    s_nop 0
    v_pk_mul_f32 v[28:29], v[28:29], v[36:37] op_sel:[0,0] op_sel_hi:[1,0]
    v_pk_mul_f32 v[30:31], v[30:31], v[36:37] op_sel:[0,0] op_sel_hi:[1,0]
    v_pk_mul_f32 v[32:33], v[32:33], v[36:37] op_sel:[0,0] op_sel_hi:[1,0]
    v_pk_mul_f32 v[34:35], v[34:35], v[36:37] op_sel:[0,0] op_sel_hi:[1,0]
    v_cvt_pk_bf16_f32 v38, v28, v29
    v_cvt_pk_bf16_f32 v39, v30, v31
    v_cvt_pk_bf16_f32 v40, v32, v33
    v_cvt_pk_bf16_f32 v41, v34, v35
    buffer_store_dwordx4 v[38:41], v7, s[32:35], s4 offen sc1
    v_rcp_f32 v52, v52
    s_nop 0
    v_pk_mul_f32 v[44:45], v[44:45], v[52:53] op_sel:[0,0] op_sel_hi:[1,0]
    v_pk_mul_f32 v[46:47], v[46:47], v[52:53] op_sel:[0,0] op_sel_hi:[1,0]
    v_pk_mul_f32 v[48:49], v[48:49], v[52:53] op_sel:[0,0] op_sel_hi:[1,0]
    v_pk_mul_f32 v[50:51], v[50:51], v[52:53] op_sel:[0,0] op_sel_hi:[1,0]
    v_cvt_pk_bf16_f32 v54, v44, v45
    v_cvt_pk_bf16_f32 v55, v46, v47
    v_cvt_pk_bf16_f32 v56, v48, v49
    v_cvt_pk_bf16_f32 v57, v50, v51
    buffer_store_dwordx4 v[54:57], v7, s[32:35], s5 offen sc1
    s_waitcnt vmcnt(0)
    s_cmp_eq_u32 s40, 1
    s_cbranch_scc1 L_fbr1
    s_cmp_eq_u32 s53, 0
    s_branch L_fbdone3
L_fbr1:
    s_cmp_eq_u32 s53, 0
    s_branch L_fbdone1
L_textend:
.section .rodata,"a"
.p2align 6
.amdhsa_kernel interleave_layers__linear_attn_block__sliding_block__prompt_kernel
  .amdhsa_next_free_vgpr 512
  .amdhsa_next_free_sgpr 102
  .amdhsa_accum_offset 256
  .amdhsa_group_segment_fixed_size 0
  .amdhsa_kernarg_size 72
  .amdhsa_user_sgpr_count 2
  .amdhsa_user_sgpr_kernarg_segment_ptr 1
  .amdhsa_system_sgpr_workgroup_id_x 1
.end_amdhsa_kernel
```
